```python
import torch

def _softmax(x, axis=-1):
    return torch.softmax(x, dim=axis)
def _gelu(x):
    return torch.nn.functional.gelu(x, approximate="tanh")
def _silu(x):
    return torch.nn.functional.silu(x)
def _sigmoid(x):
    return torch.sigmoid(x)
def _layernorm(x, axis=-1, eps=1e-5):
    m = x.mean(dim=axis, keepdim=True)
    v = x.var(dim=axis, keepdim=True, unbiased=False)
    return (x - m) / torch.sqrt(v + eps)
def _scatter_add(tgt, idx, src, axis=0):
    return tgt.clone().index_add_(axis, idx, src)
def _segment_sum(src, seg, n):
    out = torch.zeros((n,) + src.shape[1:], dtype=src.dtype)
    return out.index_add_(0, seg, src)
def _pad(x, pw):
    flat = tuple(v for pair in reversed(pw) for v in pair)
    return torch.nn.functional.pad(x, flat)

kernel_name = 'gated_mix__grouped_kv_mqa__geglu_ffn__prompt'

def setup_inputs():

    _w = (lambda a: (lambda t: t.to(torch.bfloat16) if t.is_floating_point() else t)(torch.as_tensor(a)))
    def _A_setup():
        B, S, D, H = 1, 2048, 512, 32
        Dh = D // H
        return {
            "x": _w((lambda *s: torch.randn(*s, dtype=torch.bfloat16) * 0.05)(B, S, D)),
            "wq": _w((lambda *s: torch.randn(*s, dtype=torch.bfloat16) * 0.8)(D, H * Dh)),
            "wk": _w((lambda *s: torch.randn(*s, dtype=torch.bfloat16) * 0.8)(D, Dh)),
            "wv": _w((lambda *s: torch.randn(*s, dtype=torch.bfloat16) * 0.05)(D, Dh)),
            "wo": _w((lambda *s: torch.randn(*s, dtype=torch.bfloat16) * 0.05)(H * Dh, D)),
        }
    _A_in = _A_setup()

    def _B_setup():
        B, S, D, F = 1, 2048, 512, 1376
        return {
            "x": _w((lambda *s: torch.randn(*s, dtype=torch.bfloat16) * 0.05)(B, S, D)),
            "w_gate": _w((lambda *s: torch.randn(*s, dtype=torch.bfloat16) * 0.05)(D, F)),
            "w_up": _w((lambda *s: torch.randn(*s, dtype=torch.bfloat16) * 0.05)(D, F)),
            "w_down": _w((lambda *s: torch.randn(*s, dtype=torch.bfloat16) * 0.05)(F, D)),
        }
    _B_in = _B_setup()

    return {
        "A_x": _A_in["x"],
        "A_wq": _A_in["wq"],
        "A_wk": _A_in["wk"],
        "A_wv": _A_in["wv"],
        "A_wo": _A_in["wo"],
        "B_x": _B_in["x"],
        "B_w_gate": _B_in["w_gate"],
        "B_w_up": _B_in["w_up"],
        "B_w_down": _B_in["w_down"],
        "gate_w": _w((lambda *s: torch.randn(*s, dtype=torch.bfloat16) * 0.05)(512) * 16.0),
    }

def reference(A_x, A_wq, A_wk, A_wv, A_wo, B_x, B_w_gate, B_w_up, B_w_down, gate_w):
    def _A_ref(x, wq, wk, wv, wo):
        B, S, D = x.shape
        H = 32
        Dh = D // H
        q = (lambda x, *d: x.permute(*d))((x @ wq).reshape(B, S, H, Dh), 0, 2, 1, 3)
        k = x @ wk
        v = x @ wv
        scores = torch.einsum("bhqd,bkd->bhqk", q, k) * (Dh ** -0.5)
        p = _softmax(scores, axis=-1)
        o = torch.einsum("bhqk,bkd->bhqd", p, v)
        return (lambda x, *d: x.permute(*d))(o, 0, 2, 1, 3).reshape(B, S, H * Dh) @ wo

    def _B_ref(x, w_gate, w_up, w_down):
        return (_gelu(x @ w_gate) * (x @ w_up)) @ w_down

    x = A_x
    g = _sigmoid((x * gate_w).sum(-1, keepdims=True))
    a = _A_ref(x, A_wq, A_wk, A_wv, A_wo)
    b = _B_ref(x, B_w_gate, B_w_up, B_w_down)
    return g * a + (1 - g) * b
```

```asm
; @launch grid=(256,1,1) block=(512,1,1) lds=163840
.amdgcn_target "amdgcn-amd-amdhsa--gfx950"
.text
.globl gated_mix__grouped_kv_mqa__geglu_ffn__prompt_kernel
.p2align 8
.type gated_mix__grouped_kv_mqa__geglu_ffn__prompt_kernel,@function
gated_mix__grouped_kv_mqa__geglu_ffn__prompt_kernel:
    s_cmp_ge_u32 s2, 256
    s_cbranch_scc1 L_end
    s_load_dwordx16 s[52:67], s[0:1], 0
    s_load_dwordx8 s[68:75], s[0:1], 64
    s_load_dwordx2 s[76:77], s[0:1], 96
    s_getpc_b64 s[4:5]
L_pc:
    s_and_b32 s3, s2, 0xf8
    v_and_b32 v28, 15, v0
    v_lshl_add_u32 v28, s3, 1, v28
    v_lshlrev_b32 v28, 7, v28
    v_min_u32 v28, L_hot_end-L_pc, v28
    global_load_dword v252, v28, s[4:5]
    v_lshrrev_b32 v29, 6, v0
    v_and_b32 v224, 63, v0
    v_readfirstlane_b32 s78, v29
    v_lshlrev_b32 v225, 4, v224
    s_bfe_u32 s3, s2, 0x30003
    s_and_b32 s79, s2, 1
    s_lshl3_add_u32 s79, s79, s3
    s_bfe_u32 s80, s2, 0x20001
    s_lshr_b32 s3, s2, 6
    s_lshl2_add_u32 s80, s80, s3
    s_xor_b32 s80, s80, 15
    s_and_b32 s82, s78, 3
    s_cmp_lt_u32 s78, 4
    s_cbranch_scc0 L_roleB
    v_and_b32 v28, 31, v224
    v_lshrrev_b32 v29, 5, v224
    v_bfe_u32 v30, v224, 1, 3
    v_xor_b32 v30, v30, v29
    v_lshlrev_b32 v30, 4, v30
    v_lshl_add_u32 v30, v28, 7, v30
    s_lshl_b32 s3, s82, 12
    v_add_u32 v232, s3, v30
    v_xor_b32 v233, 32, v232
    v_xor_b32 v234, 64, v232
    v_xor_b32 v235, 96, v232
    v_bfe_u32 v31, v224, 2, 2
    v_lshl_add_u32 v220, v29, 3, v31
    v_and_b32 v28, 17, v224
    v_and_b32 v29, 2, v224
    v_mul_u32_u24 v28, 18, v28
    v_and_b32 v28, 0x30, v28
    v_lshl_add_u32 v221, v29, 2, v28
    s_cmp_eq_u32 s80, 15
    s_cbranch_scc1 L_roleKV
    v_mul_u32_u24 v31, 192, v220
    s_and_b32 s3, s78, 1
    s_lshl_b32 s6, s3, 7
    s_add_u32 s6, s6, 16384
    v_add3_u32 v236, v31, v221, s6
    s_mul_i32 s6, s3, 12288
    s_add_u32 s6, s6, 16448
    v_add3_u32 v237, v31, v221, s6
    s_lshl_b32 s3, s3, 12
    v_subrev_u32 v232, s3, v232
    v_subrev_u32 v233, s3, v233
    v_subrev_u32 v234, s3, v234
    v_subrev_u32 v235, s3, v235
    s_waitcnt lgkmcnt(0)
    s_xor_b32 s3, s2, 64
    s_or_b32 s3, s3, s78
    s_cbranch_scc1 L_notag
    s_load_dword s81, s[76:77], 0
    s_mov_b32 s20, s76
    s_and_b32 s21, s77, 0xffff
    s_mov_b32 s22, 0x1000000
    s_mov_b32 s23, 0x20000
    s_mov_b32 s48, s74
    s_and_b32 s49, s75, 0xffff
    s_mov_b32 s50, 0x100
    s_mov_b32 s51, 0x20000
    v_mov_b32 v28, 0x80000000
    v_writelane_b32 v28, 0, 0
    s_waitcnt lgkmcnt(0)
    s_add_u32 s81, s81, 1
    v_mov_b32 v29, s81
    v_or_b32 v30, 0x80000000, v29
    buffer_store_dword v30, v28, s[48:51], 0 offen sc1
    buffer_store_dword v29, v28, s[20:23], 0 offen offset:0 sc1
L_notag:
    s_barrier
    ds_read_b128 v[192:195], v232
    ds_read_b64_tr_b16 v[200:201], v236 offset:0
    ds_read_b64_tr_b16 v[202:203], v236 offset:768
    ds_read_b128 v[196:199], v232 offset:4096
    ds_read_b64_tr_b16 v[204:205], v236 offset:12288
    ds_read_b64_tr_b16 v[206:207], v236 offset:13056
    ds_read_b64_tr_b16 v[208:209], v237 offset:0
    ds_read_b64_tr_b16 v[210:211], v237 offset:768
    s_waitcnt lgkmcnt(5)
    v_mfma_f32_32x32x16_bf16 v[96:111], v[200:203], v[192:195], 0
    ds_read_b128 v[0:3], v233
    ds_read_b64_tr_b16 v[8:9], v236 offset:3072
    ds_read_b64_tr_b16 v[10:11], v236 offset:3840
    s_and_b32 s6, s2, 7
    s_bfe_u32 s7, s2, 0x20003
    s_lshl2_add_u32 s85, s6, s7
    s_waitcnt lgkmcnt(7)
    v_mfma_f32_32x32x16_bf16 v[112:127], v[200:203], v[196:199], 0
    ds_read_b128 v[4:7], v233 offset:4096
    s_lshr_b32 s86, s2, 5
    s_mov_b32 s20, s76
    s_and_b32 s21, s77, 0xffff
    s_waitcnt lgkmcnt(6)
    v_mfma_f32_32x32x16_bf16 v[128:143], v[204:207], v[192:195], 0
    ds_read_b64_tr_b16 v[12:13], v236 offset:15360
    ds_read_b64_tr_b16 v[14:15], v236 offset:16128
    s_mov_b32 s22, 0x1000000
    s_mov_b32 s23, 0x20000
    s_mov_b32 s48, s74
    v_mfma_f32_32x32x16_bf16 v[144:159], v[204:207], v[196:199], 0
    s_and_b32 s49, s75, 0xffff
    s_mov_b32 s50, 0x100
    s_mov_b32 s51, 0x20000
    s_waitcnt lgkmcnt(6)
    v_mfma_f32_32x32x16_bf16 v[160:175], v[208:211], v[192:195], 0
    ds_read_b64_tr_b16 v[16:17], v237 offset:3072
    ds_read_b64_tr_b16 v[18:19], v237 offset:3840
    v_lshlrev_b32 v239, 2, v224
    v_mov_b32 v247, 0
    v_mfma_f32_32x32x16_bf16 v[176:191], v[208:211], v[196:199], 0
    s_waitcnt lgkmcnt(5)
    v_mfma_f32_32x32x16_bf16 v[96:111], v[8:11], v[0:3], v[96:111]
    ds_read_b128 v[192:195], v234
    ds_read_b64_tr_b16 v[200:201], v236 offset:6144
    ds_read_b64_tr_b16 v[202:203], v236 offset:6912
    v_and_b32 v222, 11, v224
    v_cmp_eq_u32 vcc, 0, v222
    v_mov_b32 v223, 0x3f803f80
    s_waitcnt lgkmcnt(7)
    v_mfma_f32_32x32x16_bf16 v[112:127], v[8:11], v[4:7], v[112:127]
    ds_read_b128 v[196:199], v234 offset:4096
    s_nop 0
    v_cndmask_b32 v242, 0, v223, vcc
    v_mov_b32 v32, v242
    s_waitcnt lgkmcnt(6)
    v_mfma_f32_32x32x16_bf16 v[128:143], v[12:15], v[0:3], v[128:143]
    ds_read_b64_tr_b16 v[204:205], v236 offset:18432
    ds_read_b64_tr_b16 v[206:207], v236 offset:19200
    v_mov_b32 v33, v242
    v_mov_b32 v34, v242
    v_mov_b32 v35, v242
    v_mfma_f32_32x32x16_bf16 v[144:159], v[12:15], v[4:7], v[144:159]
    v_mov_b32 v36, v242
    v_mov_b32 v37, v242
    v_mov_b32 v38, v242
    s_waitcnt lgkmcnt(6)
    v_mfma_f32_32x32x16_bf16 v[160:175], v[16:19], v[0:3], v[160:175]
    ds_read_b64_tr_b16 v[208:209], v237 offset:6144
    ds_read_b64_tr_b16 v[210:211], v237 offset:6912
    v_mov_b32 v39, v242
    v_mov_b32 v40, v242
    v_mfma_f32_32x32x16_bf16 v[176:191], v[16:19], v[4:7], v[176:191]
    s_waitcnt lgkmcnt(5)
    v_mfma_f32_32x32x16_bf16 v[96:111], v[200:203], v[192:195], v[96:111]
    ds_read_b128 v[0:3], v235
    ds_read_b64_tr_b16 v[8:9], v236 offset:9216
    ds_read_b64_tr_b16 v[10:11], v236 offset:9984
    s_waitcnt lgkmcnt(7)
    v_mfma_f32_32x32x16_bf16 v[112:127], v[200:203], v[196:199], v[112:127]
    ds_read_b128 v[4:7], v235 offset:4096
    s_waitcnt lgkmcnt(6)
    v_mfma_f32_32x32x16_bf16 v[128:143], v[204:207], v[192:195], v[128:143]
    ds_read_b64_tr_b16 v[12:13], v236 offset:21504
    ds_read_b64_tr_b16 v[14:15], v236 offset:22272
    v_mfma_f32_32x32x16_bf16 v[144:159], v[204:207], v[196:199], v[144:159]
    s_waitcnt lgkmcnt(6)
    v_mfma_f32_32x32x16_bf16 v[160:175], v[208:211], v[192:195], v[160:175]
    ds_read_b64_tr_b16 v[16:17], v237 offset:9216
    ds_read_b64_tr_b16 v[18:19], v237 offset:9984
    v_mfma_f32_32x32x16_bf16 v[176:191], v[208:211], v[196:199], v[176:191]
    v_add_u32 v232, 0xb000, v232
    v_add_u32 v233, 0xb000, v233
    v_add_u32 v234, 0xb000, v234
    v_add_u32 v235, 0xb000, v235
    v_add_u32 v236, 0xb000, v236
    v_add_u32 v237, 0xb000, v237
    s_waitcnt lgkmcnt(0)
    s_barrier
    s_cmp_eq_u32 s78, 0
    s_cselect_b32 s6, 0, 0x80000000
    buffer_load_dword v244, v247, s[48:51], s6 offen sc1
    v_mfma_f32_32x32x16_bf16 v[96:111], v[8:11], v[0:3], v[96:111]
    ds_read_b128 v[192:195], v232
    ds_read_b64_tr_b16 v[200:201], v236 offset:0
    ds_read_b64_tr_b16 v[202:203], v236 offset:768
    v_mfma_f32_32x32x16_bf16 v[112:127], v[8:11], v[4:7], v[112:127]
    ds_read_b128 v[196:199], v232 offset:4096
    v_mfma_f32_32x32x16_bf16 v[128:143], v[12:15], v[0:3], v[128:143]
    ds_read_b64_tr_b16 v[204:205], v236 offset:12288
    ds_read_b64_tr_b16 v[206:207], v236 offset:13056
    v_mfma_f32_32x32x16_bf16 v[144:159], v[12:15], v[4:7], v[144:159]
    v_mfma_f32_32x32x16_bf16 v[160:175], v[16:19], v[0:3], v[160:175]
    ds_read_b64_tr_b16 v[208:209], v237 offset:0
    ds_read_b64_tr_b16 v[210:211], v237 offset:768
    v_mfma_f32_32x32x16_bf16 v[176:191], v[16:19], v[4:7], v[176:191]
    s_waitcnt lgkmcnt(5)
    v_mfma_f32_32x32x16_bf16 v[96:111], v[200:203], v[192:195], v[96:111]
    ds_read_b128 v[0:3], v233
    ds_read_b64_tr_b16 v[8:9], v236 offset:3072
    ds_read_b64_tr_b16 v[10:11], v236 offset:3840
    s_add_u32 s7, s78, 7
    s_bfe_u32 s6, s7, 0x20001
    s_waitcnt lgkmcnt(7)
    v_mfma_f32_32x32x16_bf16 v[112:127], v[200:203], v[196:199], v[112:127]
    ds_read_b128 v[4:7], v233 offset:4096
    s_lshl2_add_u32 s6, s79, s6
    s_mul_i32 s6, s6, 120832
    s_waitcnt lgkmcnt(6)
    v_mfma_f32_32x32x16_bf16 v[128:143], v[204:207], v[192:195], v[128:143]
    ds_read_b64_tr_b16 v[12:13], v236 offset:15360
    ds_read_b64_tr_b16 v[14:15], v236 offset:16128
    s_and_b32 s7, s7, 1
    s_lshl1_add_u32 s7, s80, s7
    v_mfma_f32_32x32x16_bf16 v[144:159], v[204:207], v[196:199], v[144:159]
    s_lshl_b32 s7, s7, 10
    s_add_u32 s6, s6, s7
    s_waitcnt lgkmcnt(6)
    v_mfma_f32_32x32x16_bf16 v[160:175], v[208:211], v[192:195], v[160:175]
    ds_read_b64_tr_b16 v[16:17], v237 offset:3072
    ds_read_b64_tr_b16 v[18:19], v237 offset:3840
    s_add_u32 s99, s6, 262144
    v_mfma_f32_32x32x16_bf16 v[176:191], v[208:211], v[196:199], v[176:191]
    s_waitcnt lgkmcnt(5)
    v_mfma_f32_32x32x16_bf16 v[96:111], v[8:11], v[0:3], v[96:111]
    ds_read_b128 v[192:195], v234
    ds_read_b64_tr_b16 v[200:201], v236 offset:6144
    ds_read_b64_tr_b16 v[202:203], v236 offset:6912
    v_lshlrev_b32 v249, 7, v224
    v_mov_b32 v41, v242
    s_waitcnt lgkmcnt(7)
    v_mfma_f32_32x32x16_bf16 v[112:127], v[8:11], v[4:7], v[112:127]
    ds_read_b128 v[196:199], v234 offset:4096
    v_mov_b32 v42, v242
    v_mov_b32 v43, v242
    s_waitcnt lgkmcnt(6)
    v_mfma_f32_32x32x16_bf16 v[128:143], v[12:15], v[0:3], v[128:143]
    ds_read_b64_tr_b16 v[204:205], v236 offset:18432
    ds_read_b64_tr_b16 v[206:207], v236 offset:19200
    v_mov_b32 v44, v242
    v_mov_b32 v45, v242
    v_mfma_f32_32x32x16_bf16 v[144:159], v[12:15], v[4:7], v[144:159]
    v_mov_b32 v46, v242
    v_mov_b32 v47, v242
    s_waitcnt lgkmcnt(6)
    v_mfma_f32_32x32x16_bf16 v[160:175], v[16:19], v[0:3], v[160:175]
    ds_read_b64_tr_b16 v[208:209], v237 offset:6144
    ds_read_b64_tr_b16 v[210:211], v237 offset:6912
    v_mov_b32 v48, v242
    v_mov_b32 v49, v242
    v_mfma_f32_32x32x16_bf16 v[176:191], v[16:19], v[4:7], v[176:191]
    s_waitcnt lgkmcnt(5)
    v_mfma_f32_32x32x16_bf16 v[96:111], v[200:203], v[192:195], v[96:111]
    ds_read_b128 v[0:3], v235
    ds_read_b64_tr_b16 v[8:9], v236 offset:9216
    ds_read_b64_tr_b16 v[10:11], v236 offset:9984
    s_waitcnt lgkmcnt(7)
    v_mfma_f32_32x32x16_bf16 v[112:127], v[200:203], v[196:199], v[112:127]
    ds_read_b128 v[4:7], v235 offset:4096
    s_waitcnt lgkmcnt(6)
    v_mfma_f32_32x32x16_bf16 v[128:143], v[204:207], v[192:195], v[128:143]
    ds_read_b64_tr_b16 v[12:13], v236 offset:21504
    ds_read_b64_tr_b16 v[14:15], v236 offset:22272
    v_mfma_f32_32x32x16_bf16 v[144:159], v[204:207], v[196:199], v[144:159]
    s_waitcnt lgkmcnt(6)
    v_mfma_f32_32x32x16_bf16 v[160:175], v[208:211], v[192:195], v[160:175]
    ds_read_b64_tr_b16 v[16:17], v237 offset:9216
    ds_read_b64_tr_b16 v[18:19], v237 offset:9984
    v_mfma_f32_32x32x16_bf16 v[176:191], v[208:211], v[196:199], v[176:191]
    v_add_u32 v232, 0xb000, v232
    v_add_u32 v233, 0xb000, v233
    v_add_u32 v234, 0xb000, v234
    v_add_u32 v235, 0xb000, v235
    v_add_u32 v236, 0xb000, v236
    v_add_u32 v237, 0xb000, v237
    s_waitcnt lgkmcnt(0)
    s_barrier
    v_mfma_f32_32x32x16_bf16 v[96:111], v[8:11], v[0:3], v[96:111]
    ds_read_b128 v[192:195], v232
    ds_read_b64_tr_b16 v[200:201], v236 offset:0
    ds_read_b64_tr_b16 v[202:203], v236 offset:768
    v_mfma_f32_32x32x16_bf16 v[112:127], v[8:11], v[4:7], v[112:127]
    ds_read_b128 v[196:199], v232 offset:4096
    v_mfma_f32_32x32x16_bf16 v[128:143], v[12:15], v[0:3], v[128:143]
    ds_read_b64_tr_b16 v[204:205], v236 offset:12288
    ds_read_b64_tr_b16 v[206:207], v236 offset:13056
    v_mfma_f32_32x32x16_bf16 v[144:159], v[12:15], v[4:7], v[144:159]
    v_mfma_f32_32x32x16_bf16 v[160:175], v[16:19], v[0:3], v[160:175]
    ds_read_b64_tr_b16 v[208:209], v237 offset:0
    ds_read_b64_tr_b16 v[210:211], v237 offset:768
    v_mfma_f32_32x32x16_bf16 v[176:191], v[16:19], v[4:7], v[176:191]
    s_waitcnt lgkmcnt(5)
    v_mfma_f32_32x32x16_bf16 v[96:111], v[200:203], v[192:195], v[96:111]
    ds_read_b128 v[0:3], v233
    ds_read_b64_tr_b16 v[8:9], v236 offset:3072
    ds_read_b64_tr_b16 v[10:11], v236 offset:3840
    s_mov_b32 s24, s68
    s_and_b32 s25, s69, 0xffff
    s_waitcnt lgkmcnt(7)
    v_mfma_f32_32x32x16_bf16 v[112:127], v[200:203], v[196:199], v[112:127]
    ds_read_b128 v[4:7], v233 offset:4096
    s_mov_b32 s26, 0x158000
    s_mov_b32 s27, 0x20000
    s_waitcnt lgkmcnt(6)
    v_mfma_f32_32x32x16_bf16 v[128:143], v[204:207], v[192:195], v[128:143]
    ds_read_b64_tr_b16 v[12:13], v236 offset:15360
    ds_read_b64_tr_b16 v[14:15], v236 offset:16128
    s_mov_b32 s28, s60
    s_and_b32 s29, s61, 0xffff
    v_mfma_f32_32x32x16_bf16 v[144:159], v[204:207], v[196:199], v[144:159]
    s_mov_b32 s30, 0x80000
    s_mov_b32 s31, 0x20000
    s_waitcnt lgkmcnt(6)
    v_mfma_f32_32x32x16_bf16 v[160:175], v[208:211], v[192:195], v[160:175]
    ds_read_b64_tr_b16 v[16:17], v237 offset:3072
    ds_read_b64_tr_b16 v[18:19], v237 offset:3840
    s_mov_b32 s32, s72
    s_and_b32 s33, s73, 0xffff
    v_mfma_f32_32x32x16_bf16 v[176:191], v[208:211], v[196:199], v[176:191]
    s_mov_b32 s34, 0x200000
    s_mov_b32 s35, 0x20000
    s_waitcnt lgkmcnt(5)
    v_mfma_f32_32x32x16_bf16 v[96:111], v[8:11], v[0:3], v[96:111]
    ds_read_b128 v[192:195], v234
    ds_read_b64_tr_b16 v[200:201], v236 offset:6144
    ds_read_b64_tr_b16 v[202:203], v236 offset:6912
    v_mov_b32 v243, 0x80000000
    v_mov_b32 v245, 163328
    s_waitcnt lgkmcnt(7)
    v_mfma_f32_32x32x16_bf16 v[112:127], v[8:11], v[4:7], v[112:127]
    ds_read_b128 v[196:199], v234 offset:4096
    v_writelane_b32 v243, 0, 0
    v_mov_b32 v50, v242
    s_waitcnt lgkmcnt(6)
    v_mfma_f32_32x32x16_bf16 v[128:143], v[12:15], v[0:3], v[128:143]
    ds_read_b64_tr_b16 v[204:205], v236 offset:18432
    ds_read_b64_tr_b16 v[206:207], v236 offset:19200
    v_mov_b32 v51, v242
    v_mov_b32 v52, v242
    v_mfma_f32_32x32x16_bf16 v[144:159], v[12:15], v[4:7], v[144:159]
    v_mov_b32 v53, v242
    v_mov_b32 v54, v242
    s_waitcnt lgkmcnt(6)
    v_mfma_f32_32x32x16_bf16 v[160:175], v[16:19], v[0:3], v[160:175]
    ds_read_b64_tr_b16 v[208:209], v237 offset:6144
    ds_read_b64_tr_b16 v[210:211], v237 offset:6912
    v_mov_b32 v55, v242
    v_mov_b32 v56, v242
    v_mfma_f32_32x32x16_bf16 v[176:191], v[16:19], v[4:7], v[176:191]
    v_mov_b32 v57, v242
    v_mov_b32 v58, v242
    s_waitcnt lgkmcnt(5)
    v_mfma_f32_32x32x16_bf16 v[96:111], v[200:203], v[192:195], v[96:111]
    ds_read_b128 v[0:3], v235
    ds_read_b64_tr_b16 v[8:9], v236 offset:9216
    ds_read_b64_tr_b16 v[10:11], v236 offset:9984
    s_waitcnt lgkmcnt(7)
    v_mfma_f32_32x32x16_bf16 v[112:127], v[200:203], v[196:199], v[112:127]
    ds_read_b128 v[4:7], v235 offset:4096
    s_waitcnt lgkmcnt(6)
    v_mfma_f32_32x32x16_bf16 v[128:143], v[204:207], v[192:195], v[128:143]
    ds_read_b64_tr_b16 v[12:13], v236 offset:21504
    ds_read_b64_tr_b16 v[14:15], v236 offset:22272
    v_mfma_f32_32x32x16_bf16 v[144:159], v[204:207], v[196:199], v[144:159]
    s_waitcnt lgkmcnt(6)
    v_mfma_f32_32x32x16_bf16 v[160:175], v[208:211], v[192:195], v[160:175]
    ds_read_b64_tr_b16 v[16:17], v237 offset:9216
    ds_read_b64_tr_b16 v[18:19], v237 offset:9984
    v_mfma_f32_32x32x16_bf16 v[176:191], v[208:211], v[196:199], v[176:191]
    v_add_u32 v232, 0xfffea000, v232
    v_add_u32 v233, 0xfffea000, v233
    v_add_u32 v234, 0xfffea000, v234
    v_add_u32 v235, 0xfffea000, v235
    v_add_u32 v236, 0xfffea000, v236
    v_add_u32 v237, 0xfffea000, v237
    s_waitcnt lgkmcnt(0)
    s_barrier
    v_mfma_f32_32x32x16_bf16 v[96:111], v[8:11], v[0:3], v[96:111]
    ds_read_b128 v[192:195], v232
    ds_read_b64_tr_b16 v[200:201], v236 offset:0
    ds_read_b64_tr_b16 v[202:203], v236 offset:768
    v_mfma_f32_32x32x16_bf16 v[112:127], v[8:11], v[4:7], v[112:127]
    ds_read_b128 v[196:199], v232 offset:4096
    v_mfma_f32_32x32x16_bf16 v[128:143], v[12:15], v[0:3], v[128:143]
    ds_read_b64_tr_b16 v[204:205], v236 offset:12288
    ds_read_b64_tr_b16 v[206:207], v236 offset:13056
    v_mfma_f32_32x32x16_bf16 v[144:159], v[12:15], v[4:7], v[144:159]
    v_mfma_f32_32x32x16_bf16 v[160:175], v[16:19], v[0:3], v[160:175]
    ds_read_b64_tr_b16 v[208:209], v237 offset:0
    ds_read_b64_tr_b16 v[210:211], v237 offset:768
    v_mfma_f32_32x32x16_bf16 v[176:191], v[16:19], v[4:7], v[176:191]
    s_waitcnt lgkmcnt(5)
    v_mfma_f32_32x32x16_bf16 v[96:111], v[200:203], v[192:195], v[96:111]
    ds_read_b128 v[0:3], v233
    ds_read_b64_tr_b16 v[8:9], v236 offset:3072
    ds_read_b64_tr_b16 v[10:11], v236 offset:3840
    v_lshrrev_b32 v222, 3, v224
    v_lshlrev_b32 v222, 10, v222
    s_waitcnt lgkmcnt(7)
    v_mfma_f32_32x32x16_bf16 v[112:127], v[200:203], v[196:199], v[112:127]
    ds_read_b128 v[4:7], v233 offset:4096
    v_and_b32 v223, 16, v224
    v_lshlrev_b32 v223, 2, v223
    s_waitcnt lgkmcnt(6)
    v_mfma_f32_32x32x16_bf16 v[128:143], v[204:207], v[192:195], v[128:143]
    ds_read_b64_tr_b16 v[12:13], v236 offset:15360
    ds_read_b64_tr_b16 v[14:15], v236 offset:16128
    v_xor_b32 v223, v223, v225
    v_and_b32 v223, 0x70, v223
    v_mfma_f32_32x32x16_bf16 v[144:159], v[204:207], v[196:199], v[144:159]
    s_lshl_b32 s6, s86, 7
    v_add3_u32 v238, v222, v223, s6
    s_waitcnt lgkmcnt(6)
    v_mfma_f32_32x32x16_bf16 v[160:175], v[208:211], v[192:195], v[160:175]
    ds_read_b64_tr_b16 v[16:17], v237 offset:3072
    ds_read_b64_tr_b16 v[18:19], v237 offset:3840
    v_mfma_f32_32x32x16_bf16 v[176:191], v[208:211], v[196:199], v[176:191]
    s_waitcnt lgkmcnt(5)
    v_mfma_f32_32x32x16_bf16 v[96:111], v[8:11], v[0:3], v[96:111]
    ds_read_b128 v[192:195], v234
    ds_read_b64_tr_b16 v[200:201], v236 offset:6144
    ds_read_b64_tr_b16 v[202:203], v236 offset:6912
    v_mov_b32 v59, v242
    v_mov_b32 v60, v242
    s_waitcnt lgkmcnt(7)
    v_mfma_f32_32x32x16_bf16 v[112:127], v[8:11], v[4:7], v[112:127]
    ds_read_b128 v[196:199], v234 offset:4096
    v_mov_b32 v61, v242
    v_mov_b32 v62, v242
    s_waitcnt lgkmcnt(6)
    v_mfma_f32_32x32x16_bf16 v[128:143], v[12:15], v[0:3], v[128:143]
    ds_read_b64_tr_b16 v[204:205], v236 offset:18432
    ds_read_b64_tr_b16 v[206:207], v236 offset:19200
    v_mov_b32 v63, v242
    v_mov_b32 v64, v242
    v_mfma_f32_32x32x16_bf16 v[144:159], v[12:15], v[4:7], v[144:159]
    v_mov_b32 v65, v242
    v_mov_b32 v66, v242
    s_waitcnt lgkmcnt(6)
    v_mfma_f32_32x32x16_bf16 v[160:175], v[16:19], v[0:3], v[160:175]
    ds_read_b64_tr_b16 v[208:209], v237 offset:6144
    ds_read_b64_tr_b16 v[210:211], v237 offset:6912
    v_mov_b32 v67, v242
    v_mfma_f32_32x32x16_bf16 v[176:191], v[16:19], v[4:7], v[176:191]
    s_waitcnt lgkmcnt(5)
    v_mfma_f32_32x32x16_bf16 v[96:111], v[200:203], v[192:195], v[96:111]
    ds_read_b128 v[0:3], v235
    ds_read_b64_tr_b16 v[8:9], v236 offset:9216
    ds_read_b64_tr_b16 v[10:11], v236 offset:9984
    s_waitcnt lgkmcnt(7)
    v_mfma_f32_32x32x16_bf16 v[112:127], v[200:203], v[196:199], v[112:127]
    ds_read_b128 v[4:7], v235 offset:4096
    s_waitcnt lgkmcnt(6)
    v_mfma_f32_32x32x16_bf16 v[128:143], v[204:207], v[192:195], v[128:143]
    ds_read_b64_tr_b16 v[12:13], v236 offset:21504
    ds_read_b64_tr_b16 v[14:15], v236 offset:22272
    v_mfma_f32_32x32x16_bf16 v[144:159], v[204:207], v[196:199], v[144:159]
    s_waitcnt lgkmcnt(6)
    v_mfma_f32_32x32x16_bf16 v[160:175], v[208:211], v[192:195], v[160:175]
    ds_read_b64_tr_b16 v[16:17], v237 offset:9216
    ds_read_b64_tr_b16 v[18:19], v237 offset:9984
    v_mfma_f32_32x32x16_bf16 v[176:191], v[208:211], v[196:199], v[176:191]
    v_add_u32 v232, 0xb000, v232
    v_add_u32 v233, 0xb000, v233
    v_add_u32 v234, 0xb000, v234
    v_add_u32 v235, 0xb000, v235
    v_add_u32 v236, 0xb000, v236
    v_add_u32 v237, 0xb000, v237
    s_waitcnt vmcnt(0)
    s_cmp_eq_u32 s78, 0
    s_cbranch_scc0 L_tg3A
    s_mov_b32 s92, 0
L_tagA:
    v_readfirstlane_b32 s81, v244
    s_cmp_lg_u32 s81, 0
    s_cbranch_scc1 L_tag_okA
    s_add_u32 s92, s92, 1
    s_cmp_gt_u32 s92, 0x100000
    s_cbranch_scc1 L_tag_okA
    s_sleep 4
    buffer_load_dword v244, v247, s[48:51], 0 offen sc1
    s_waitcnt vmcnt(0)
    s_branch L_tagA
L_tag_okA:
    ds_write_b32 v245, v244 offset:40
L_tg3A:
    s_waitcnt lgkmcnt(0)
    s_barrier
    v_mfma_f32_32x32x16_bf16 v[96:111], v[8:11], v[0:3], v[96:111]
    ds_read_b128 v[192:195], v232
    ds_read_b64_tr_b16 v[200:201], v236 offset:0
    ds_read_b64_tr_b16 v[202:203], v236 offset:768
    v_mfma_f32_32x32x16_bf16 v[112:127], v[8:11], v[4:7], v[112:127]
    ds_read_b128 v[196:199], v232 offset:4096
    v_mfma_f32_32x32x16_bf16 v[128:143], v[12:15], v[0:3], v[128:143]
    ds_read_b64_tr_b16 v[204:205], v236 offset:12288
    ds_read_b64_tr_b16 v[206:207], v236 offset:13056
    v_mfma_f32_32x32x16_bf16 v[144:159], v[12:15], v[4:7], v[144:159]
    v_mfma_f32_32x32x16_bf16 v[160:175], v[16:19], v[0:3], v[160:175]
    ds_read_b64_tr_b16 v[208:209], v237 offset:0
    ds_read_b64_tr_b16 v[210:211], v237 offset:768
    v_mfma_f32_32x32x16_bf16 v[176:191], v[16:19], v[4:7], v[176:191]
    s_waitcnt lgkmcnt(5)
    v_mfma_f32_32x32x16_bf16 v[96:111], v[200:203], v[192:195], v[96:111]
    ds_read_b128 v[0:3], v233
    ds_read_b64_tr_b16 v[8:9], v236 offset:3072
    ds_read_b64_tr_b16 v[10:11], v236 offset:3840
    v_and_b32 v222, 1, v224
    v_lshlrev_b32 v222, 5, v222
    s_waitcnt lgkmcnt(7)
    v_mfma_f32_32x32x16_bf16 v[112:127], v[200:203], v[196:199], v[112:127]
    ds_read_b128 v[4:7], v233 offset:4096
    v_and_b32 v223, 16, v224
    v_add_u32 v222, v222, v223
    s_waitcnt lgkmcnt(6)
    v_mfma_f32_32x32x16_bf16 v[128:143], v[204:207], v[192:195], v[128:143]
    ds_read_b64_tr_b16 v[12:13], v236 offset:15360
    ds_read_b64_tr_b16 v[14:15], v236 offset:16128
    v_and_b32 v223, 2, v224
    v_lshl_add_u32 v222, v223, 2, v222
    v_mfma_f32_32x32x16_bf16 v[144:159], v[204:207], v[196:199], v[144:159]
    v_lshl_add_u32 v222, v220, 7, v222
    v_and_b32 v223, 8, v224
    s_waitcnt lgkmcnt(6)
    v_mfma_f32_32x32x16_bf16 v[160:175], v[208:211], v[192:195], v[160:175]
    ds_read_b64_tr_b16 v[16:17], v237 offset:3072
    ds_read_b64_tr_b16 v[18:19], v237 offset:3840
    v_lshl_add_u32 v222, v223, 3, v222
    s_lshr_b32 s6, s78, 1
    v_mfma_f32_32x32x16_bf16 v[176:191], v[208:211], v[196:199], v[176:191]
    s_lshl_b32 s6, s6, 11
    s_waitcnt lgkmcnt(5)
    v_mfma_f32_32x32x16_bf16 v[96:111], v[8:11], v[0:3], v[96:111]
    ds_read_b128 v[192:195], v234
    ds_read_b64_tr_b16 v[200:201], v236 offset:6144
    ds_read_b64_tr_b16 v[202:203], v236 offset:6912
    v_add_u32 v240, s6, v222
    v_xor_b32 v241, 64, v240
    s_waitcnt lgkmcnt(7)
    v_mfma_f32_32x32x16_bf16 v[112:127], v[8:11], v[4:7], v[112:127]
    ds_read_b128 v[196:199], v234 offset:4096
    v_mov_b32 v68, v242
    v_mov_b32 v69, v242
    s_waitcnt lgkmcnt(6)
    v_mfma_f32_32x32x16_bf16 v[128:143], v[12:15], v[0:3], v[128:143]
    ds_read_b64_tr_b16 v[204:205], v236 offset:18432
    ds_read_b64_tr_b16 v[206:207], v236 offset:19200
    v_mov_b32 v70, v242
    v_mov_b32 v71, v242
    v_mfma_f32_32x32x16_bf16 v[144:159], v[12:15], v[4:7], v[144:159]
    v_mov_b32 v72, v242
    v_mov_b32 v73, v242
    s_waitcnt lgkmcnt(6)
    v_mfma_f32_32x32x16_bf16 v[160:175], v[16:19], v[0:3], v[160:175]
    ds_read_b64_tr_b16 v[208:209], v237 offset:6144
    ds_read_b64_tr_b16 v[210:211], v237 offset:6912
    v_mov_b32 v74, v242
    v_mov_b32 v75, v242
    v_mfma_f32_32x32x16_bf16 v[176:191], v[16:19], v[4:7], v[176:191]
    v_mov_b32 v76, v242
    s_waitcnt lgkmcnt(5)
    v_mfma_f32_32x32x16_bf16 v[96:111], v[200:203], v[192:195], v[96:111]
    ds_read_b128 v[0:3], v235
    ds_read_b64_tr_b16 v[8:9], v236 offset:9216
    ds_read_b64_tr_b16 v[10:11], v236 offset:9984
    s_waitcnt lgkmcnt(7)
    v_mfma_f32_32x32x16_bf16 v[112:127], v[200:203], v[196:199], v[112:127]
    ds_read_b128 v[4:7], v235 offset:4096
    s_waitcnt lgkmcnt(6)
    v_mfma_f32_32x32x16_bf16 v[128:143], v[204:207], v[192:195], v[128:143]
    ds_read_b64_tr_b16 v[12:13], v236 offset:21504
    ds_read_b64_tr_b16 v[14:15], v236 offset:22272
    v_mfma_f32_32x32x16_bf16 v[144:159], v[204:207], v[196:199], v[144:159]
    s_waitcnt lgkmcnt(6)
    v_mfma_f32_32x32x16_bf16 v[160:175], v[208:211], v[192:195], v[160:175]
    ds_read_b64_tr_b16 v[16:17], v237 offset:9216
    ds_read_b64_tr_b16 v[18:19], v237 offset:9984
    v_mfma_f32_32x32x16_bf16 v[176:191], v[208:211], v[196:199], v[176:191]
    v_add_u32 v232, 0xb000, v232
    v_add_u32 v233, 0xb000, v233
    v_add_u32 v234, 0xb000, v234
    v_add_u32 v235, 0xb000, v235
    v_add_u32 v236, 0xb000, v236
    v_add_u32 v237, 0xb000, v237
    ds_read_b32 v244, v245 offset:40
    s_waitcnt lgkmcnt(0)
    s_barrier
    v_mfma_f32_32x32x16_bf16 v[96:111], v[8:11], v[0:3], v[96:111]
    ds_read_b128 v[192:195], v232
    ds_read_b64_tr_b16 v[200:201], v236 offset:0
    ds_read_b64_tr_b16 v[202:203], v236 offset:768
    v_mfma_f32_32x32x16_bf16 v[112:127], v[8:11], v[4:7], v[112:127]
    ds_read_b128 v[196:199], v232 offset:4096
    v_mfma_f32_32x32x16_bf16 v[128:143], v[12:15], v[0:3], v[128:143]
    ds_read_b64_tr_b16 v[204:205], v236 offset:12288
    ds_read_b64_tr_b16 v[206:207], v236 offset:13056
    v_mfma_f32_32x32x16_bf16 v[144:159], v[12:15], v[4:7], v[144:159]
    v_mfma_f32_32x32x16_bf16 v[160:175], v[16:19], v[0:3], v[160:175]
    ds_read_b64_tr_b16 v[208:209], v237 offset:0
    ds_read_b64_tr_b16 v[210:211], v237 offset:768
    v_mfma_f32_32x32x16_bf16 v[176:191], v[16:19], v[4:7], v[176:191]
    s_waitcnt lgkmcnt(5)
    v_mfma_f32_32x32x16_bf16 v[96:111], v[200:203], v[192:195], v[96:111]
    ds_read_b128 v[0:3], v233
    ds_read_b64_tr_b16 v[8:9], v236 offset:3072
    ds_read_b64_tr_b16 v[10:11], v236 offset:3840
    v_readfirstlane_b32 s81, v244
    v_mov_b32 v246, 0xdddddddd
    s_waitcnt lgkmcnt(7)
    v_mfma_f32_32x32x16_bf16 v[112:127], v[200:203], v[196:199], v[112:127]
    ds_read_b128 v[4:7], v233 offset:4096
    v_and_b32 v222, 32, v224
    v_lshlrev_b32 v222, 3, v222
    s_waitcnt lgkmcnt(6)
    v_mfma_f32_32x32x16_bf16 v[128:143], v[204:207], v[192:195], v[128:143]
    ds_read_b64_tr_b16 v[12:13], v236 offset:15360
    ds_read_b64_tr_b16 v[14:15], v236 offset:16128
    v_and_b32 v223, 0xf0, v225
    v_add_u32 v254, v222, v223
    v_mfma_f32_32x32x16_bf16 v[144:159], v[204:207], v[196:199], v[144:159]
    v_and_b32 v248, 0x7c, v239
    v_mov_b32 v77, v242
    s_waitcnt lgkmcnt(6)
    v_mfma_f32_32x32x16_bf16 v[160:175], v[208:211], v[192:195], v[160:175]
    ds_read_b64_tr_b16 v[16:17], v237 offset:3072
    ds_read_b64_tr_b16 v[18:19], v237 offset:3840
    v_mfma_f32_32x32x16_bf16 v[176:191], v[208:211], v[196:199], v[176:191]
    s_waitcnt lgkmcnt(5)
    v_mfma_f32_32x32x16_bf16 v[96:111], v[8:11], v[0:3], v[96:111]
    ds_read_b128 v[192:195], v234
    ds_read_b64_tr_b16 v[200:201], v236 offset:6144
    ds_read_b64_tr_b16 v[202:203], v236 offset:6912
    v_mov_b32 v78, v242
    v_mov_b32 v79, v242
    s_waitcnt lgkmcnt(7)
    v_mfma_f32_32x32x16_bf16 v[112:127], v[8:11], v[4:7], v[112:127]
    ds_read_b128 v[196:199], v234 offset:4096
    v_mov_b32 v80, v242
    v_mov_b32 v81, v242
    s_waitcnt lgkmcnt(6)
    v_mfma_f32_32x32x16_bf16 v[128:143], v[12:15], v[0:3], v[128:143]
    ds_read_b64_tr_b16 v[204:205], v236 offset:18432
    ds_read_b64_tr_b16 v[206:207], v236 offset:19200
    v_mov_b32 v82, v242
    v_mov_b32 v83, v242
    v_mfma_f32_32x32x16_bf16 v[144:159], v[12:15], v[4:7], v[144:159]
    v_mov_b32 v84, v242
    v_mov_b32 v85, v242
    s_waitcnt lgkmcnt(6)
    v_mfma_f32_32x32x16_bf16 v[160:175], v[16:19], v[0:3], v[160:175]
    ds_read_b64_tr_b16 v[208:209], v237 offset:6144
    ds_read_b64_tr_b16 v[210:211], v237 offset:6912
    v_mfma_f32_32x32x16_bf16 v[176:191], v[16:19], v[4:7], v[176:191]
    s_waitcnt lgkmcnt(5)
    v_mfma_f32_32x32x16_bf16 v[96:111], v[200:203], v[192:195], v[96:111]
    ds_read_b128 v[0:3], v235
    ds_read_b64_tr_b16 v[8:9], v236 offset:9216
    ds_read_b64_tr_b16 v[10:11], v236 offset:9984
    s_waitcnt lgkmcnt(7)
    v_mfma_f32_32x32x16_bf16 v[112:127], v[200:203], v[196:199], v[112:127]
    ds_read_b128 v[4:7], v235 offset:4096
    s_waitcnt lgkmcnt(6)
    v_mfma_f32_32x32x16_bf16 v[128:143], v[204:207], v[192:195], v[128:143]
    ds_read_b64_tr_b16 v[12:13], v236 offset:21504
    ds_read_b64_tr_b16 v[14:15], v236 offset:22272
    v_mfma_f32_32x32x16_bf16 v[144:159], v[204:207], v[196:199], v[144:159]
    s_waitcnt lgkmcnt(6)
    v_mfma_f32_32x32x16_bf16 v[160:175], v[208:211], v[192:195], v[160:175]
    ds_read_b64_tr_b16 v[16:17], v237 offset:9216
    ds_read_b64_tr_b16 v[18:19], v237 offset:9984
    v_mfma_f32_32x32x16_bf16 v[176:191], v[208:211], v[196:199], v[176:191]
    v_add_u32 v232, 0xfffea000, v232
    v_add_u32 v233, 0xfffea000, v233
    v_add_u32 v234, 0xfffea000, v234
    v_add_u32 v235, 0xfffea000, v235
    v_add_u32 v236, 0xfffea000, v236
    v_add_u32 v237, 0xfffea000, v237
    s_waitcnt lgkmcnt(0)
    s_barrier
    v_mfma_f32_32x32x16_bf16 v[96:111], v[8:11], v[0:3], v[96:111]
    ds_read_b128 v[192:195], v232
    ds_read_b64_tr_b16 v[200:201], v236 offset:0
    ds_read_b64_tr_b16 v[202:203], v236 offset:768
    v_mfma_f32_32x32x16_bf16 v[112:127], v[8:11], v[4:7], v[112:127]
    ds_read_b128 v[196:199], v232 offset:4096
    v_mfma_f32_32x32x16_bf16 v[128:143], v[12:15], v[0:3], v[128:143]
    ds_read_b64_tr_b16 v[204:205], v236 offset:12288
    ds_read_b64_tr_b16 v[206:207], v236 offset:13056
    v_mfma_f32_32x32x16_bf16 v[144:159], v[12:15], v[4:7], v[144:159]
    v_mfma_f32_32x32x16_bf16 v[160:175], v[16:19], v[0:3], v[160:175]
    ds_read_b64_tr_b16 v[208:209], v237 offset:0
    ds_read_b64_tr_b16 v[210:211], v237 offset:768
    v_mfma_f32_32x32x16_bf16 v[176:191], v[16:19], v[4:7], v[176:191]
    s_waitcnt lgkmcnt(5)
    v_mfma_f32_32x32x16_bf16 v[96:111], v[200:203], v[192:195], v[96:111]
    ds_read_b128 v[0:3], v233
    ds_read_b64_tr_b16 v[8:9], v236 offset:3072
    ds_read_b64_tr_b16 v[10:11], v236 offset:3840
    s_and_b32 s6, s78, 1
    s_lshl1_add_u32 s6, s85, s6
    s_lshl_b32 s40, s6, 7
    s_waitcnt lgkmcnt(7)
    v_mfma_f32_32x32x16_bf16 v[112:127], v[200:203], v[196:199], v[112:127]
    ds_read_b128 v[4:7], v233 offset:4096
    s_add_u32 s40, s40, 16384
    s_mul_i32 s98, s6, 120832
    s_lshr_b32 s6, s78, 1
    s_waitcnt lgkmcnt(6)
    v_mfma_f32_32x32x16_bf16 v[128:143], v[204:207], v[192:195], v[128:143]
    ds_read_b64_tr_b16 v[12:13], v236 offset:15360
    ds_read_b64_tr_b16 v[14:15], v236 offset:16128
    s_lshl_b32 s6, s6, 10
    s_add_u32 s98, s98, s6
    s_add_u32 s98, s98, 262144
    v_mfma_f32_32x32x16_bf16 v[144:159], v[204:207], v[196:199], v[144:159]
    s_lshl_b32 s6, s78, 13
    s_mov_b32 s39, 0
    s_xor_b32 s6, s6, s39
    s_waitcnt lgkmcnt(6)
    v_mfma_f32_32x32x16_bf16 v[160:175], v[208:211], v[192:195], v[160:175]
    ds_read_b64_tr_b16 v[16:17], v237 offset:3072
    ds_read_b64_tr_b16 v[18:19], v237 offset:3840
    s_mov_b32 s36, 0
    v_mfma_f32_32x32x16_bf16 v[176:191], v[208:211], v[196:199], v[176:191]
    s_waitcnt lgkmcnt(5)
    v_mfma_f32_32x32x16_bf16 v[96:111], v[8:11], v[0:3], v[96:111]
    ds_read_b128 v[192:195], v234
    ds_read_b64_tr_b16 v[200:201], v236 offset:6144
    ds_read_b64_tr_b16 v[202:203], v236 offset:6912
    s_add_u32 s37, s6, 32768
    s_add_u32 s38, s6, 98304
    s_mov_b32 s42, 0xffff
    s_waitcnt lgkmcnt(7)
    v_mfma_f32_32x32x16_bf16 v[112:127], v[8:11], v[4:7], v[112:127]
    ds_read_b128 v[196:199], v234 offset:4096
    s_mov_b32 s43, 0xffff
    v_mov_b32 v86, v242
    v_mov_b32 v87, v242
    s_waitcnt lgkmcnt(6)
    v_mfma_f32_32x32x16_bf16 v[128:143], v[12:15], v[0:3], v[128:143]
    ds_read_b64_tr_b16 v[204:205], v236 offset:18432
    ds_read_b64_tr_b16 v[206:207], v236 offset:19200
    v_mov_b32 v88, v242
    v_mov_b32 v89, v242
    v_mov_b32 v90, v242
    v_mfma_f32_32x32x16_bf16 v[144:159], v[12:15], v[4:7], v[144:159]
    v_mov_b32 v91, v242
    v_mov_b32 v92, v242
    v_mov_b32 v93, v242
    s_waitcnt lgkmcnt(6)
    v_mfma_f32_32x32x16_bf16 v[160:175], v[16:19], v[0:3], v[160:175]
    ds_read_b64_tr_b16 v[208:209], v237 offset:6144
    ds_read_b64_tr_b16 v[210:211], v237 offset:6912
    v_mov_b32 v94, v242
    v_mov_b32 v95, v242
    v_mfma_f32_32x32x16_bf16 v[176:191], v[16:19], v[4:7], v[176:191]
    s_waitcnt lgkmcnt(5)
    v_mfma_f32_32x32x16_bf16 v[96:111], v[200:203], v[192:195], v[96:111]
    ds_read_b128 v[0:3], v235
    ds_read_b64_tr_b16 v[8:9], v236 offset:9216
    ds_read_b64_tr_b16 v[10:11], v236 offset:9984
    s_waitcnt lgkmcnt(7)
    v_mfma_f32_32x32x16_bf16 v[112:127], v[200:203], v[196:199], v[112:127]
    ds_read_b128 v[4:7], v235 offset:4096
    s_waitcnt lgkmcnt(6)
    v_mfma_f32_32x32x16_bf16 v[128:143], v[204:207], v[192:195], v[128:143]
    ds_read_b64_tr_b16 v[12:13], v236 offset:21504
    ds_read_b64_tr_b16 v[14:15], v236 offset:22272
    v_mfma_f32_32x32x16_bf16 v[144:159], v[204:207], v[196:199], v[144:159]
    s_waitcnt lgkmcnt(6)
    v_mfma_f32_32x32x16_bf16 v[160:175], v[208:211], v[192:195], v[160:175]
    ds_read_b64_tr_b16 v[16:17], v237 offset:9216
    ds_read_b64_tr_b16 v[18:19], v237 offset:9984
    v_mfma_f32_32x32x16_bf16 v[176:191], v[208:211], v[196:199], v[176:191]
    v_add_u32 v232, 0xb000, v232
    v_add_u32 v233, 0xb000, v233
    v_add_u32 v234, 0xb000, v234
    v_add_u32 v235, 0xb000, v235
    v_add_u32 v236, 0xb000, v236
    v_add_u32 v237, 0xb000, v237
    s_waitcnt lgkmcnt(0)
    s_barrier
    v_mfma_f32_32x32x16_bf16 v[96:111], v[8:11], v[0:3], v[96:111]
    ds_read_b128 v[192:195], v232
    ds_read_b64_tr_b16 v[200:201], v236 offset:0
    ds_read_b64_tr_b16 v[202:203], v236 offset:768
    v_mfma_f32_32x32x16_bf16 v[112:127], v[8:11], v[4:7], v[112:127]
    ds_read_b128 v[196:199], v232 offset:4096
    v_mfma_f32_32x32x16_bf16 v[128:143], v[12:15], v[0:3], v[128:143]
    ds_read_b64_tr_b16 v[204:205], v236 offset:12288
    ds_read_b64_tr_b16 v[206:207], v236 offset:13056
    v_mfma_f32_32x32x16_bf16 v[144:159], v[12:15], v[4:7], v[144:159]
    v_mfma_f32_32x32x16_bf16 v[160:175], v[16:19], v[0:3], v[160:175]
    ds_read_b64_tr_b16 v[208:209], v237 offset:0
    ds_read_b64_tr_b16 v[210:211], v237 offset:768
    v_mfma_f32_32x32x16_bf16 v[176:191], v[16:19], v[4:7], v[176:191]
    s_waitcnt lgkmcnt(5)
    v_mfma_f32_32x32x16_bf16 v[96:111], v[200:203], v[192:195], v[96:111]
    ds_read_b128 v[0:3], v233
    ds_read_b64_tr_b16 v[8:9], v236 offset:3072
    ds_read_b64_tr_b16 v[10:11], v236 offset:3840
    v_mov_b32 v216, 0xc0135761
    v_mov_b32 v217, 0xc0135761
    v_mov_b32 v218, 0xbdd2d3e8
    s_waitcnt lgkmcnt(7)
    v_mfma_f32_32x32x16_bf16 v[112:127], v[200:203], v[196:199], v[112:127]
    ds_read_b128 v[4:7], v233 offset:4096
    v_mov_b32 v219, 0xbdd2d3e8
    v_mov_b32 v220, 0x3f800000
    v_mov_b32 v221, 0x3f800000
    s_waitcnt lgkmcnt(6)
    v_mfma_f32_32x32x16_bf16 v[128:143], v[204:207], v[192:195], v[128:143]
    ds_read_b64_tr_b16 v[12:13], v236 offset:15360
    ds_read_b64_tr_b16 v[14:15], v236 offset:16128
    s_lshr_b32 s3, s78, 1
    s_and_b32 s6, s78, 1
    s_lshl_b32 s7, s3, 14
    v_mfma_f32_32x32x16_bf16 v[144:159], v[204:207], v[196:199], v[144:159]
    s_lshl_b32 s97, s6, 12
    s_add_u32 s97, s97, s7
    v_add_u32 v226, s97, v225
    s_waitcnt lgkmcnt(6)
    v_mfma_f32_32x32x16_bf16 v[160:175], v[208:211], v[192:195], v[160:175]
    ds_read_b64_tr_b16 v[16:17], v237 offset:3072
    ds_read_b64_tr_b16 v[18:19], v237 offset:3840
    s_lshl_b32 s97, s6, 13
    s_add_u32 s97, s97, s7
    v_add_u32 v227, s97, v225
    v_mfma_f32_32x32x16_bf16 v[176:191], v[208:211], v[196:199], v[176:191]
    s_and_b32 s3, s78, 2
    s_waitcnt lgkmcnt(5)
    v_mfma_f32_32x32x16_bf16 v[96:111], v[8:11], v[0:3], v[96:111]
    ds_read_b128 v[192:195], v234
    ds_read_b64_tr_b16 v[200:201], v236 offset:6144
    ds_read_b64_tr_b16 v[202:203], v236 offset:6912
    s_lshl2_add_u32 s3, s79, s3
    s_mul_i32 s3, s3, 120832
    s_mul_i32 s7, s80, 6144
    s_waitcnt lgkmcnt(7)
    v_mfma_f32_32x32x16_bf16 v[112:127], v[8:11], v[4:7], v[112:127]
    ds_read_b128 v[196:199], v234 offset:4096
    s_add_u32 s3, s3, s7
    s_add_u32 s3, s3, 294912
    s_lshl_b32 s7, s6, 12
    s_waitcnt lgkmcnt(6)
    v_mfma_f32_32x32x16_bf16 v[128:143], v[12:15], v[0:3], v[128:143]
    ds_read_b64_tr_b16 v[204:205], v236 offset:18432
    ds_read_b64_tr_b16 v[206:207], v236 offset:19200
    s_add_u32 s44, s3, s7
    s_mul_i32 s7, s6, 120832
    s_add_u32 s46, s3, s7
    v_mfma_f32_32x32x16_bf16 v[144:159], v[12:15], v[4:7], v[144:159]
    s_add_u32 s46, s46, 2048
    s_cmp_lt_u32 s80, 14
    s_cselect_b32 s46, s46, 0x80000000
    s_waitcnt lgkmcnt(6)
    v_mfma_f32_32x32x16_bf16 v[160:175], v[16:19], v[0:3], v[160:175]
    ds_read_b64_tr_b16 v[208:209], v237 offset:6144
    ds_read_b64_tr_b16 v[210:211], v237 offset:6912
    s_add_u32 s7, s80, s6
    s_cmp_lt_u32 s7, 15
    s_cselect_b32 s44, s44, 0x80000000
    v_mfma_f32_32x32x16_bf16 v[176:191], v[16:19], v[4:7], v[176:191]
    s_add_u32 s45, s44, 120832
    s_waitcnt lgkmcnt(5)
    v_mfma_f32_32x32x16_bf16 v[96:111], v[200:203], v[192:195], v[96:111]
    ds_read_b128 v[0:3], v235
    ds_read_b64_tr_b16 v[8:9], v236 offset:9216
    ds_read_b64_tr_b16 v[10:11], v236 offset:9984
    s_waitcnt lgkmcnt(7)
    v_mfma_f32_32x32x16_bf16 v[112:127], v[200:203], v[196:199], v[112:127]
    ds_read_b128 v[4:7], v235 offset:4096
    s_waitcnt lgkmcnt(6)
    v_mfma_f32_32x32x16_bf16 v[128:143], v[204:207], v[192:195], v[128:143]
    ds_read_b64_tr_b16 v[12:13], v236 offset:21504
    ds_read_b64_tr_b16 v[14:15], v236 offset:22272
    v_mfma_f32_32x32x16_bf16 v[144:159], v[204:207], v[196:199], v[144:159]
    s_waitcnt lgkmcnt(6)
    v_mfma_f32_32x32x16_bf16 v[160:175], v[208:211], v[192:195], v[160:175]
    ds_read_b64_tr_b16 v[16:17], v237 offset:9216
    ds_read_b64_tr_b16 v[18:19], v237 offset:9984
    v_mfma_f32_32x32x16_bf16 v[176:191], v[208:211], v[196:199], v[176:191]
    s_waitcnt lgkmcnt(5)
    v_mfma_f32_32x32x16_bf16 v[96:111], v[8:11], v[0:3], v[96:111]
    s_waitcnt lgkmcnt(4)
    v_mfma_f32_32x32x16_bf16 v[112:127], v[8:11], v[4:7], v[112:127]
    s_waitcnt lgkmcnt(2)
    v_mfma_f32_32x32x16_bf16 v[128:143], v[12:15], v[0:3], v[128:143]
    v_mfma_f32_32x32x16_bf16 v[144:159], v[12:15], v[4:7], v[144:159]
    s_waitcnt lgkmcnt(0)
    v_mfma_f32_32x32x16_bf16 v[160:175], v[16:19], v[0:3], v[160:175]
    v_mfma_f32_32x32x16_bf16 v[176:191], v[16:19], v[4:7], v[176:191]
    s_setprio 1
    s_nop 3
    v_pk_mul_f32 v[228:229], v[96:97], v[96:97]
    v_pk_mul_f32 v[230:231], v[98:99], v[98:99]
    v_pk_mul_f32 v[232:233], v[100:101], v[100:101]
    v_pk_mul_f32 v[234:235], v[102:103], v[102:103]
    v_pk_fma_f32 v[228:229], v[228:229], v[218:219], v[216:217]
    v_pk_fma_f32 v[230:231], v[230:231], v[218:219], v[216:217]
    v_pk_fma_f32 v[232:233], v[232:233], v[218:219], v[216:217]
    v_pk_fma_f32 v[234:235], v[234:235], v[218:219], v[216:217]
    v_pk_mul_f32 v[228:229], v[228:229], v[96:97]
    ds_write_b128 v226, v[160:163] offset:0
    v_pk_mul_f32 v[230:231], v[230:231], v[98:99]
    v_pk_mul_f32 v[232:233], v[232:233], v[100:101]
    v_pk_mul_f32 v[234:235], v[234:235], v[102:103]
    v_exp_f32 v228, v228
    v_exp_f32 v229, v229
    ds_write_b128 v226, v[164:167] offset:1024
    v_exp_f32 v230, v230
    v_exp_f32 v231, v231
    v_exp_f32 v232, v232
    v_exp_f32 v233, v233
    ds_write_b128 v226, v[168:171] offset:2048
    v_exp_f32 v234, v234
    v_exp_f32 v235, v235
    v_pk_add_f32 v[228:229], v[228:229], v[220:221]
    v_pk_add_f32 v[230:231], v[230:231], v[220:221]
    v_pk_add_f32 v[232:233], v[232:233], v[220:221]
    ds_write_b128 v226, v[172:175] offset:3072
    v_pk_add_f32 v[234:235], v[234:235], v[220:221]
    v_pk_mul_f32 v[128:129], v[96:97], v[128:129]
    v_pk_mul_f32 v[130:131], v[98:99], v[130:131]
    v_pk_mul_f32 v[132:133], v[100:101], v[132:133]
    ds_write_b128 v226, v[176:179] offset:8192
    v_pk_mul_f32 v[134:135], v[102:103], v[134:135]
    v_rcp_f32 v228, v228
    v_rcp_f32 v229, v229
    v_rcp_f32 v230, v230
    v_rcp_f32 v231, v231
    ds_write_b128 v226, v[180:183] offset:9216
    v_rcp_f32 v232, v232
    v_rcp_f32 v233, v233
    v_rcp_f32 v234, v234
    v_rcp_f32 v235, v235
    v_pk_mul_f32 v[128:129], v[128:129], v[228:229]
    ds_write_b128 v226, v[184:187] offset:10240
    v_pk_mul_f32 v[130:131], v[130:131], v[230:231]
    v_pk_mul_f32 v[132:133], v[132:133], v[232:233]
    v_pk_mul_f32 v[134:135], v[134:135], v[234:235]
    v_cvt_pk_bf16_f32 v192, v128, v129
    ds_write_b128 v226, v[188:191] offset:11264
    v_cvt_pk_bf16_f32 v193, v130, v131
    v_cvt_pk_bf16_f32 v194, v132, v133
    v_cvt_pk_bf16_f32 v195, v134, v135
    v_pk_mul_f32 v[228:229], v[104:105], v[104:105]
    v_pk_mul_f32 v[230:231], v[106:107], v[106:107]
    s_lshl2_add_u32 s7, s78, 163392
    v_mov_b32 v252, 163376
    v_mov_b32 v253, -1
    v_writelane_b32 v252, s7, 0
    ds_write_b32 v252, v253
    v_pk_mul_f32 v[232:233], v[108:109], v[108:109]
    v_pk_mul_f32 v[234:235], v[110:111], v[110:111]
    v_pk_fma_f32 v[228:229], v[228:229], v[218:219], v[216:217]
    v_pk_fma_f32 v[230:231], v[230:231], v[218:219], v[216:217]
    v_pk_fma_f32 v[232:233], v[232:233], v[218:219], v[216:217]
    v_pk_fma_f32 v[234:235], v[234:235], v[218:219], v[216:217]
    v_pk_mul_f32 v[228:229], v[228:229], v[104:105]
    v_pk_mul_f32 v[230:231], v[230:231], v[106:107]
    v_pk_mul_f32 v[232:233], v[232:233], v[108:109]
    v_pk_mul_f32 v[234:235], v[234:235], v[110:111]
    v_exp_f32 v228, v228
    v_exp_f32 v229, v229
    v_exp_f32 v230, v230
    v_exp_f32 v231, v231
    v_exp_f32 v232, v232
    v_exp_f32 v233, v233
    v_exp_f32 v234, v234
    v_exp_f32 v235, v235
    v_pk_add_f32 v[228:229], v[228:229], v[220:221]
    v_pk_add_f32 v[230:231], v[230:231], v[220:221]
    v_pk_add_f32 v[232:233], v[232:233], v[220:221]
    v_pk_add_f32 v[234:235], v[234:235], v[220:221]
    v_pk_mul_f32 v[136:137], v[104:105], v[136:137]
    v_pk_mul_f32 v[138:139], v[106:107], v[138:139]
    v_pk_mul_f32 v[140:141], v[108:109], v[140:141]
    v_pk_mul_f32 v[142:143], v[110:111], v[142:143]
    v_rcp_f32 v228, v228
    v_rcp_f32 v229, v229
    v_rcp_f32 v230, v230
    v_rcp_f32 v231, v231
    v_rcp_f32 v232, v232
    v_rcp_f32 v233, v233
    v_rcp_f32 v234, v234
    v_rcp_f32 v235, v235
    v_pk_mul_f32 v[136:137], v[136:137], v[228:229]
    v_pk_mul_f32 v[138:139], v[138:139], v[230:231]
    v_pk_mul_f32 v[140:141], v[140:141], v[232:233]
    v_pk_mul_f32 v[142:143], v[142:143], v[234:235]
    v_cvt_pk_bf16_f32 v196, v136, v137
    v_cvt_pk_bf16_f32 v197, v138, v139
    v_cvt_pk_bf16_f32 v198, v140, v141
    v_cvt_pk_bf16_f32 v199, v142, v143
    v_pk_mul_f32 v[228:229], v[112:113], v[112:113]
    v_pk_mul_f32 v[230:231], v[114:115], v[114:115]
    v_pk_mul_f32 v[232:233], v[116:117], v[116:117]
    v_pk_mul_f32 v[234:235], v[118:119], v[118:119]
    v_pk_fma_f32 v[228:229], v[228:229], v[218:219], v[216:217]
    v_pk_fma_f32 v[230:231], v[230:231], v[218:219], v[216:217]
    v_pk_fma_f32 v[232:233], v[232:233], v[218:219], v[216:217]
    v_pk_fma_f32 v[234:235], v[234:235], v[218:219], v[216:217]
    v_pk_mul_f32 v[228:229], v[228:229], v[112:113]
    v_pk_mul_f32 v[230:231], v[230:231], v[114:115]
    v_pk_mul_f32 v[232:233], v[232:233], v[116:117]
    v_pk_mul_f32 v[234:235], v[234:235], v[118:119]
    v_exp_f32 v228, v228
    v_exp_f32 v229, v229
    v_exp_f32 v230, v230
    v_exp_f32 v231, v231
    v_exp_f32 v232, v232
    v_exp_f32 v233, v233
    v_exp_f32 v234, v234
    v_exp_f32 v235, v235
    v_pk_add_f32 v[228:229], v[228:229], v[220:221]
    v_pk_add_f32 v[230:231], v[230:231], v[220:221]
    v_pk_add_f32 v[232:233], v[232:233], v[220:221]
    v_pk_add_f32 v[234:235], v[234:235], v[220:221]
    v_pk_mul_f32 v[144:145], v[112:113], v[144:145]
    v_pk_mul_f32 v[146:147], v[114:115], v[146:147]
    v_pk_mul_f32 v[148:149], v[116:117], v[148:149]
    v_pk_mul_f32 v[150:151], v[118:119], v[150:151]
    v_rcp_f32 v228, v228
    v_rcp_f32 v229, v229
    v_rcp_f32 v230, v230
    v_rcp_f32 v231, v231
    v_rcp_f32 v232, v232
    v_rcp_f32 v233, v233
    v_rcp_f32 v234, v234
    v_rcp_f32 v235, v235
    v_pk_mul_f32 v[144:145], v[144:145], v[228:229]
    v_pk_mul_f32 v[146:147], v[146:147], v[230:231]
    v_pk_mul_f32 v[148:149], v[148:149], v[232:233]
    v_pk_mul_f32 v[150:151], v[150:151], v[234:235]
    v_cvt_pk_bf16_f32 v200, v144, v145
    v_cvt_pk_bf16_f32 v201, v146, v147
    v_cvt_pk_bf16_f32 v202, v148, v149
    v_cvt_pk_bf16_f32 v203, v150, v151
    v_pk_mul_f32 v[228:229], v[120:121], v[120:121]
    v_pk_mul_f32 v[230:231], v[122:123], v[122:123]
    v_pk_mul_f32 v[232:233], v[124:125], v[124:125]
    v_pk_mul_f32 v[234:235], v[126:127], v[126:127]
    v_pk_fma_f32 v[228:229], v[228:229], v[218:219], v[216:217]
    v_pk_fma_f32 v[230:231], v[230:231], v[218:219], v[216:217]
    v_pk_fma_f32 v[232:233], v[232:233], v[218:219], v[216:217]
    v_pk_fma_f32 v[234:235], v[234:235], v[218:219], v[216:217]
    v_pk_mul_f32 v[228:229], v[228:229], v[120:121]
    v_pk_mul_f32 v[230:231], v[230:231], v[122:123]
    v_pk_mul_f32 v[232:233], v[232:233], v[124:125]
    v_pk_mul_f32 v[234:235], v[234:235], v[126:127]
    v_exp_f32 v228, v228
    v_exp_f32 v229, v229
    v_exp_f32 v230, v230
    v_exp_f32 v231, v231
    v_exp_f32 v232, v232
    v_exp_f32 v233, v233
    v_exp_f32 v234, v234
    v_exp_f32 v235, v235
    v_pk_add_f32 v[228:229], v[228:229], v[220:221]
    v_pk_add_f32 v[230:231], v[230:231], v[220:221]
    v_pk_add_f32 v[232:233], v[232:233], v[220:221]
    v_pk_add_f32 v[234:235], v[234:235], v[220:221]
    v_pk_mul_f32 v[152:153], v[120:121], v[152:153]
    v_pk_mul_f32 v[154:155], v[122:123], v[154:155]
    v_pk_mul_f32 v[156:157], v[124:125], v[156:157]
    v_pk_mul_f32 v[158:159], v[126:127], v[158:159]
    v_rcp_f32 v228, v228
    v_rcp_f32 v229, v229
    v_rcp_f32 v230, v230
    v_rcp_f32 v231, v231
    v_rcp_f32 v232, v232
    v_rcp_f32 v233, v233
    v_rcp_f32 v234, v234
    v_rcp_f32 v235, v235
    v_pk_mul_f32 v[152:153], v[152:153], v[228:229]
    v_pk_mul_f32 v[154:155], v[154:155], v[230:231]
    v_pk_mul_f32 v[156:157], v[156:157], v[232:233]
    v_pk_mul_f32 v[158:159], v[158:159], v[234:235]
    v_cvt_pk_bf16_f32 v204, v152, v153
    v_cvt_pk_bf16_f32 v205, v154, v155
    v_cvt_pk_bf16_f32 v206, v156, v157
    v_cvt_pk_bf16_f32 v207, v158, v159
    s_lshl_b32 s3, s78, 13
    s_add_u32 s3, s3, 90112
    v_add_u32 v226, s3, v225
    s_add_u32 s3, s3, 32768
    v_add_u32 v236, s3, v254
    s_add_u32 s3, s3, 4096
    s_cmp_eq_u32 s78, 3
    s_cselect_b32 s3, 32768, s3
    v_add_u32 v237, s3, v254
    s_mov_b32 s92, 0
L_awA1:
    ds_read_b128 v[96:99], v245 offset:64
    ds_read_b128 v[100:103], v245 offset:80
    ds_read_b128 v[104:107], v245 offset:96
    s_waitcnt lgkmcnt(0)
    v_and_b32 v96, v96, v97
    v_and_b32 v98, v98, v99
    v_and_b32 v96, v96, v98
    v_and_b32 v100, v100, v101
    v_and_b32 v96, v96, v100
    v_and_b32 v102, v102, v103
    v_and_b32 v96, v96, v102
    v_and_b32 v104, v104, v105
    v_and_b32 v96, v96, v104
    v_and_b32 v106, v106, v107
    v_and_b32 v96, v96, v106
    s_add_u32 s92, s92, 1
    v_readfirstlane_b32 s96, v96
    s_cmp_gt_u32 s92, 0x1000000
    s_cbranch_scc1 L_awA1_ok
    s_cmp_eq_u32 s96, 0
    s_cbranch_scc1 L_awA1
L_awA1_ok:
    ds_read_b128 v[160:163], v227 offset:0
    ds_read_b128 v[164:167], v227 offset:1024
    ds_read_b128 v[168:171], v227 offset:2048
    ds_read_b128 v[172:175], v227 offset:3072
    ds_read_b128 v[176:179], v227 offset:4096
    ds_read_b128 v[180:183], v227 offset:5120
    ds_read_b128 v[184:187], v227 offset:6144
    ds_read_b128 v[188:191], v227 offset:7168
    ds_read_b128 v[0:3], v226 offset:0
    ds_read_b128 v[4:7], v226 offset:1024
    ds_read_b128 v[8:11], v226 offset:2048
    ds_read_b128 v[12:15], v226 offset:3072
    s_waitcnt lgkmcnt(4)
    v_pk_mul_f32 v[228:229], v[160:161], v[160:161]
    v_pk_mul_f32 v[230:231], v[162:163], v[162:163]
    v_pk_mul_f32 v[232:233], v[164:165], v[164:165]
    v_pk_mul_f32 v[234:235], v[166:167], v[166:167]
    v_pk_fma_f32 v[228:229], v[228:229], v[218:219], v[216:217]
    v_pk_fma_f32 v[230:231], v[230:231], v[218:219], v[216:217]
    v_pk_fma_f32 v[232:233], v[232:233], v[218:219], v[216:217]
    ds_read_b128 v[16:19], v226 offset:4096
    v_pk_fma_f32 v[234:235], v[234:235], v[218:219], v[216:217]
    v_pk_mul_f32 v[228:229], v[228:229], v[160:161]
    v_pk_mul_f32 v[230:231], v[230:231], v[162:163]
    v_pk_mul_f32 v[232:233], v[232:233], v[164:165]
    v_pk_mul_f32 v[234:235], v[234:235], v[166:167]
    v_exp_f32 v228, v228
    v_exp_f32 v229, v229
    ds_read_b128 v[20:23], v226 offset:5120
    v_exp_f32 v230, v230
    v_exp_f32 v231, v231
    v_exp_f32 v232, v232
    v_exp_f32 v233, v233
    v_exp_f32 v234, v234
    v_exp_f32 v235, v235
    v_pk_add_f32 v[228:229], v[228:229], v[220:221]
    ds_read_b128 v[24:27], v226 offset:6144
    v_pk_add_f32 v[230:231], v[230:231], v[220:221]
    v_pk_add_f32 v[232:233], v[232:233], v[220:221]
    v_pk_add_f32 v[234:235], v[234:235], v[220:221]
    v_pk_mul_f32 v[176:177], v[160:161], v[176:177]
    v_pk_mul_f32 v[178:179], v[162:163], v[178:179]
    v_pk_mul_f32 v[180:181], v[164:165], v[180:181]
    v_pk_mul_f32 v[182:183], v[166:167], v[182:183]
    ds_read_b128 v[28:31], v226 offset:7168
    v_rcp_f32 v228, v228
    v_rcp_f32 v229, v229
    v_rcp_f32 v230, v230
    v_rcp_f32 v231, v231
    v_rcp_f32 v232, v232
    v_rcp_f32 v233, v233
    s_mov_b64 exec, s[42:43]
    ds_read_b128 v[32:35], v236 offset:0
    ds_read_b128 v[36:39], v236 offset:512
    s_mov_b64 exec, -1
    v_rcp_f32 v234, v234
    v_rcp_f32 v235, v235
    v_pk_mul_f32 v[176:177], v[176:177], v[228:229]
    v_pk_mul_f32 v[178:179], v[178:179], v[230:231]
    v_pk_mul_f32 v[180:181], v[180:181], v[232:233]
    v_pk_mul_f32 v[182:183], v[182:183], v[234:235]
    v_cvt_pk_bf16_f32 v208, v176, v177
    s_mov_b64 exec, s[42:43]
    ds_read_b128 v[40:43], v236 offset:1024
    ds_read_b128 v[44:47], v236 offset:1536
    s_mov_b64 exec, -1
    v_cvt_pk_bf16_f32 v209, v178, v179
    v_cvt_pk_bf16_f32 v210, v180, v181
    v_cvt_pk_bf16_f32 v211, v182, v183
    v_pk_mul_f32 v[228:229], v[168:169], v[168:169]
    v_pk_mul_f32 v[230:231], v[170:171], v[170:171]
    v_pk_mul_f32 v[232:233], v[172:173], v[172:173]
    v_pk_mul_f32 v[234:235], v[174:175], v[174:175]
    s_mov_b64 exec, s[42:43]
    ds_read_b128 v[48:51], v236 offset:2048
    ds_read_b128 v[52:55], v236 offset:2560
    s_mov_b64 exec, -1
    v_pk_fma_f32 v[228:229], v[228:229], v[218:219], v[216:217]
    v_pk_fma_f32 v[230:231], v[230:231], v[218:219], v[216:217]
    v_pk_fma_f32 v[232:233], v[232:233], v[218:219], v[216:217]
    v_pk_fma_f32 v[234:235], v[234:235], v[218:219], v[216:217]
    v_pk_mul_f32 v[228:229], v[228:229], v[168:169]
    v_pk_mul_f32 v[230:231], v[230:231], v[170:171]
    v_pk_mul_f32 v[232:233], v[232:233], v[172:173]
    s_mov_b64 exec, s[42:43]
    ds_read_b128 v[56:59], v236 offset:3072
    ds_read_b128 v[60:63], v236 offset:3584
    s_mov_b64 exec, -1
    v_pk_mul_f32 v[234:235], v[234:235], v[174:175]
    v_exp_f32 v228, v228
    v_exp_f32 v229, v229
    v_exp_f32 v230, v230
    v_exp_f32 v231, v231
    v_exp_f32 v232, v232
    s_mov_b64 exec, s[42:43]
    ds_read_b128 v[64:67], v237 offset:0
    ds_read_b128 v[68:71], v237 offset:512
    s_mov_b64 exec, -1
    v_exp_f32 v233, v233
    v_exp_f32 v234, v234
    v_exp_f32 v235, v235
    v_pk_add_f32 v[228:229], v[228:229], v[220:221]
    v_pk_add_f32 v[230:231], v[230:231], v[220:221]
    v_pk_add_f32 v[232:233], v[232:233], v[220:221]
    v_pk_add_f32 v[234:235], v[234:235], v[220:221]
    s_mov_b64 exec, s[42:43]
    ds_read_b128 v[72:75], v237 offset:1024
    ds_read_b128 v[76:79], v237 offset:1536
    s_mov_b64 exec, -1
    v_pk_mul_f32 v[184:185], v[168:169], v[184:185]
    v_pk_mul_f32 v[186:187], v[170:171], v[186:187]
    v_pk_mul_f32 v[188:189], v[172:173], v[188:189]
    v_pk_mul_f32 v[190:191], v[174:175], v[190:191]
    v_rcp_f32 v228, v228
    v_rcp_f32 v229, v229
    v_rcp_f32 v230, v230
    s_mov_b64 exec, s[42:43]
    ds_read_b128 v[80:83], v237 offset:2048
    ds_read_b128 v[84:87], v237 offset:2560
    s_mov_b64 exec, -1
    v_rcp_f32 v231, v231
    v_rcp_f32 v232, v232
    v_rcp_f32 v233, v233
    v_rcp_f32 v234, v234
    v_rcp_f32 v235, v235
    v_pk_mul_f32 v[184:185], v[184:185], v[228:229]
    v_pk_mul_f32 v[186:187], v[186:187], v[230:231]
    s_mov_b64 exec, s[42:43]
    ds_read_b128 v[88:91], v237 offset:3072
    ds_read_b128 v[92:95], v237 offset:3584
    s_mov_b64 exec, -1
    v_pk_mul_f32 v[188:189], v[188:189], v[232:233]
    v_pk_mul_f32 v[190:191], v[190:191], v[234:235]
    v_cvt_pk_bf16_f32 v212, v184, v185
    v_cvt_pk_bf16_f32 v213, v186, v187
    v_cvt_pk_bf16_f32 v214, v188, v189
    v_cvt_pk_bf16_f32 v215, v190, v191
    s_branch L_p1_done
L_roleB:
    s_setprio 3
    v_lshrrev_b32 v28, 3, v224
    v_lshrrev_b32 v29, 4, v224
    v_and_b32 v30, 7, v224
    v_xor_b32 v29, v29, v30
    v_lshlrev_b32 v28, 10, v28
    v_lshl_add_u32 v226, v29, 4, v28
    v_xor_b32 v227, 64, v226
    v_add_u32 v227, 7168, v227
    s_lshl2_add_u32 s83, s79, s82
    s_lshl_b32 s83, s83, 15
    s_lshl_b32 s87, s82, 12
    v_and_b32 v231, 0x30, v225
    v_and_b32 v28, 0x3c, v224
    v_lshl_add_u32 v231, v28, 8, v231
    s_lshl_b32 s84, s82, 14
    s_lshl_b32 s97, s80, 6
    s_add_u32 s84, s84, s97
    s_lshl_b32 s89, s82, 10
    s_mov_b32 s10, 2097152
    s_mov_b32 s11, 0x20000
    s_mov_b32 s15, 0x20000
    s_mov_b32 s18, 524288
    s_mov_b32 s19, 0x20000
    s_cmp_eq_u32 s80, 15
    s_cbranch_scc1 L_roleB15
    s_mul_i32 s88, s82, 3072
    v_mul_u32_u24 v28, 171, v224
    s_movk_i32 s97, 2560
    v_lshrrev_b32 v29, 11, v28
    v_mad_u32_u24 v228, v29, s97, v225
    v_add_u32 v28, 10944, v28
    v_lshrrev_b32 v30, 11, v28
    v_mad_u32_u24 v229, v30, s97, v225
    v_add_u32 v28, 10944, v28
    v_lshrrev_b32 v31, 11, v28
    v_mad_u32_u24 v230, v31, s97, v225
    s_mul_i32 s101, s82, 44032
    s_mul_i32 s97, s80, 192
    s_add_u32 s101, s101, s97
    s_mov_b32 s43, 0x20000
    s_mov_b32 s14, 1409024
    s_mov_b32 s42, 1409024
    s_cmp_eq_u32 s80, 14
    s_cbranch_scc1 L_special14
L_special14_done:
    s_waitcnt lgkmcnt(0)
    s_mov_b32 s8, s52
    s_and_b32 s9, s53, 0xffff
    s_add_u32 m0, s87, 0
    s_add_u32 s96, s83, 14336
    buffer_load_dwordx4 v226, s[8:11], s83 offen offset:0 lds
    buffer_load_dwordx4 v227, s[8:11], s83 offen offset:1024 lds
    buffer_load_dwordx4 v226, s[8:11], s96 offen offset:2048 lds
    buffer_load_dwordx4 v227, s[8:11], s96 offen offset:3072 lds
    s_mov_b32 s12, s64
    s_and_b32 s13, s65, 0xffff
    s_mov_b32 s40, s66
    s_and_b32 s41, s67, 0xffff
    s_mov_b32 s16, s54
    s_and_b32 s17, s55, 0xffff
    s_add_u32 m0, s88, 16384
    s_nop 0
    buffer_load_dwordx4 v228, s[12:15], s101 offen offset:0 lds
    buffer_load_dwordx4 v229, s[12:15], s101 offen offset:1024 lds
    buffer_load_dwordx4 v230, s[12:15], s101 offen offset:2048 lds
    s_add_u32 m0, s88, 28672
    s_nop 0
    buffer_load_dwordx4 v228, s[40:43], s101 offen offset:0 lds
    buffer_load_dwordx4 v229, s[40:43], s101 offen offset:1024 lds
    buffer_load_dwordx4 v230, s[40:43], s101 offen offset:2048 lds
    s_add_u32 m0, s89, 40960
    s_nop 0
    buffer_load_dwordx4 v231, s[16:19], s84 offen lds
    s_add_u32 s83, s83, 128
    s_add_u32 s84, s84, 65536
    s_add_u32 s101, s101, 176128
    s_add_u32 m0, s87, 45056
    s_add_u32 s96, s83, 14336
    buffer_load_dwordx4 v226, s[8:11], s83 offen offset:0 lds
    buffer_load_dwordx4 v227, s[8:11], s83 offen offset:1024 lds
    buffer_load_dwordx4 v226, s[8:11], s96 offen offset:2048 lds
    buffer_load_dwordx4 v227, s[8:11], s96 offen offset:3072 lds
    s_add_u32 m0, s88, 61440
    s_nop 0
    buffer_load_dwordx4 v228, s[12:15], s101 offen offset:0 lds
    buffer_load_dwordx4 v229, s[12:15], s101 offen offset:1024 lds
    buffer_load_dwordx4 v230, s[12:15], s101 offen offset:2048 lds
    s_add_u32 m0, s88, 73728
    s_nop 0
    buffer_load_dwordx4 v228, s[40:43], s101 offen offset:0 lds
    buffer_load_dwordx4 v229, s[40:43], s101 offen offset:1024 lds
    buffer_load_dwordx4 v230, s[40:43], s101 offen offset:2048 lds
    s_add_u32 m0, s89, 86016
    s_nop 0
    buffer_load_dwordx4 v231, s[16:19], s84 offen lds
    s_add_u32 s83, s83, 128
    s_add_u32 s84, s84, 65536
    s_add_u32 s101, s101, 176128
    v_and_b32 v28, 31, v224
    v_lshrrev_b32 v29, 5, v224
    v_bfe_u32 v30, v224, 1, 3
    v_xor_b32 v30, v30, v29
    v_lshlrev_b32 v30, 4, v30
    v_lshl_add_u32 v30, v28, 7, v30
    s_lshl_b32 s3, s82, 12
    v_add_u32 v232, s3, v30
    v_xor_b32 v233, 32, v232
    v_xor_b32 v234, 64, v232
    v_xor_b32 v235, 96, v232
    v_bfe_u32 v31, v224, 2, 2
    v_lshl_add_u32 v220, v29, 3, v31
    v_and_b32 v28, 17, v224
    v_and_b32 v29, 2, v224
    v_mul_u32_u24 v28, 18, v28
    v_and_b32 v28, 0x30, v28
    v_lshl_add_u32 v221, v29, 2, v28
    v_lshl_add_u32 v31, v220, 6, v221
    v_add_u32 v237, 40960, v31
    v_mov_b32 v28, 0
    v_lshlrev_b32 v29, 2, v224
    v_add_u32 v29, 163328, v29
    ds_write_b32 v29, v28
    s_waitcnt vmcnt(11) lgkmcnt(0)
    s_barrier
    ds_read_b128 v[96:99], v232
    ds_read_b64_tr_b16 v[100:101], v237 offset:0
    ds_read_b64_tr_b16 v[102:103], v237 offset:256
    ds_read_b128 v[104:107], v233
    ds_read_b64_tr_b16 v[108:109], v237 offset:1024
    ds_read_b64_tr_b16 v[110:111], v237 offset:1280
    ds_read_b128 v[112:115], v234
    ds_read_b64_tr_b16 v[116:117], v237 offset:2048
    ds_read_b64_tr_b16 v[118:119], v237 offset:2304
    ds_read_b128 v[120:123], v235
    ds_read_b64_tr_b16 v[124:125], v237 offset:3072
    ds_read_b64_tr_b16 v[126:127], v237 offset:3328
    s_add_u32 m0, s87, 90112
    s_add_u32 s96, s83, 14336
    buffer_load_dwordx4 v226, s[8:11], s83 offen offset:0 lds
    buffer_load_dwordx4 v227, s[8:11], s83 offen offset:1024 lds
    buffer_load_dwordx4 v226, s[8:11], s96 offen offset:2048 lds
    buffer_load_dwordx4 v227, s[8:11], s96 offen offset:3072 lds
    s_add_u32 m0, s88, 106496
    s_nop 0
    buffer_load_dwordx4 v228, s[12:15], s101 offen offset:0 lds
    buffer_load_dwordx4 v229, s[12:15], s101 offen offset:1024 lds
    buffer_load_dwordx4 v230, s[12:15], s101 offen offset:2048 lds
    s_add_u32 m0, s88, 118784
    s_nop 0
    buffer_load_dwordx4 v228, s[40:43], s101 offen offset:0 lds
    buffer_load_dwordx4 v229, s[40:43], s101 offen offset:1024 lds
    buffer_load_dwordx4 v230, s[40:43], s101 offen offset:2048 lds
    s_add_u32 m0, s89, 131072
    s_nop 0
    buffer_load_dwordx4 v231, s[16:19], s84 offen lds
    s_add_u32 s83, s83, 128
    s_add_u32 s84, s84, 65536
    s_add_u32 s101, s101, 176128
    v_add_u32 v232, 0xb000, v232
    v_add_u32 v233, 0xb000, v233
    v_add_u32 v234, 0xb000, v234
    v_add_u32 v235, 0xb000, v235
    v_add_u32 v237, 0xb000, v237
    s_waitcnt lgkmcnt(0)
    v_mfma_f32_32x32x16_bf16 v[128:143], v[100:103], v[96:99], 0
    v_mfma_f32_32x32x16_bf16 v[128:143], v[108:111], v[104:107], v[128:143]
    v_mfma_f32_32x32x16_bf16 v[128:143], v[116:119], v[112:115], v[128:143]
    v_mfma_f32_32x32x16_bf16 v[128:143], v[124:127], v[120:123], v[128:143]
    s_and_b32 s6, s2, 7
    s_bfe_u32 s7, s2, 0x20003
    s_lshl2_add_u32 s85, s6, s7
    s_lshr_b32 s86, s2, 5
    s_mov_b32 s20, s76
    s_and_b32 s21, s77, 0xffff
    s_mov_b32 s22, 0x1000000
    s_mov_b32 s23, 0x20000
    s_mov_b32 s48, s74
    s_and_b32 s49, s75, 0xffff
    s_mov_b32 s50, 0x100
    s_mov_b32 s51, 0x20000
    v_lshlrev_b32 v239, 2, v224
    v_mov_b32 v247, 0
    v_and_b32 v222, 11, v224
    v_cmp_eq_u32 vcc, 0, v222
    v_mov_b32 v223, 0x3f803f80
    s_nop 0
    v_cndmask_b32 v242, 0, v223, vcc
    v_mov_b32 v32, v242
    v_mov_b32 v33, v242
    v_mov_b32 v34, v242
    v_mov_b32 v35, v242
    v_mov_b32 v36, v242
    v_mov_b32 v37, v242
    v_mov_b32 v38, v242
    v_mov_b32 v39, v242
    v_mov_b32 v40, v242
    s_waitcnt vmcnt(11) lgkmcnt(0)
    s_barrier
    ds_read_b128 v[96:99], v232
    ds_read_b64_tr_b16 v[100:101], v237 offset:0
    ds_read_b64_tr_b16 v[102:103], v237 offset:256
    ds_read_b128 v[104:107], v233
    ds_read_b64_tr_b16 v[108:109], v237 offset:1024
    ds_read_b64_tr_b16 v[110:111], v237 offset:1280
    ds_read_b128 v[112:115], v234
    ds_read_b64_tr_b16 v[116:117], v237 offset:2048
    ds_read_b64_tr_b16 v[118:119], v237 offset:2304
    ds_read_b128 v[120:123], v235
    ds_read_b64_tr_b16 v[124:125], v237 offset:3072
    ds_read_b64_tr_b16 v[126:127], v237 offset:3328
    s_add_u32 m0, s87, 0
    s_add_u32 s96, s83, 14336
    buffer_load_dwordx4 v226, s[8:11], s83 offen offset:0 lds
    buffer_load_dwordx4 v227, s[8:11], s83 offen offset:1024 lds
    buffer_load_dwordx4 v226, s[8:11], s96 offen offset:2048 lds
    buffer_load_dwordx4 v227, s[8:11], s96 offen offset:3072 lds
    s_add_u32 m0, s88, 16384
    s_nop 0
    buffer_load_dwordx4 v228, s[12:15], s101 offen offset:0 lds
    buffer_load_dwordx4 v229, s[12:15], s101 offen offset:1024 lds
    buffer_load_dwordx4 v230, s[12:15], s101 offen offset:2048 lds
    s_add_u32 m0, s88, 28672
    s_nop 0
    buffer_load_dwordx4 v228, s[40:43], s101 offen offset:0 lds
    buffer_load_dwordx4 v229, s[40:43], s101 offen offset:1024 lds
    buffer_load_dwordx4 v230, s[40:43], s101 offen offset:2048 lds
    s_add_u32 m0, s89, 40960
    s_nop 0
    buffer_load_dwordx4 v231, s[16:19], s84 offen lds
    s_add_u32 s83, s83, 128
    s_add_u32 s84, s84, 65536
    s_add_u32 s101, s101, 176128
    v_add_u32 v232, 0xb000, v232
    v_add_u32 v233, 0xb000, v233
    v_add_u32 v234, 0xb000, v234
    v_add_u32 v235, 0xb000, v235
    v_add_u32 v237, 0xb000, v237
    s_waitcnt lgkmcnt(0)
    v_mfma_f32_32x32x16_bf16 v[128:143], v[100:103], v[96:99], v[128:143]
    v_mfma_f32_32x32x16_bf16 v[128:143], v[108:111], v[104:107], v[128:143]
    v_mfma_f32_32x32x16_bf16 v[128:143], v[116:119], v[112:115], v[128:143]
    v_mfma_f32_32x32x16_bf16 v[128:143], v[124:127], v[120:123], v[128:143]
    s_add_u32 s7, s78, 7
    s_bfe_u32 s6, s7, 0x20001
    s_lshl2_add_u32 s6, s79, s6
    s_mul_i32 s6, s6, 120832
    s_and_b32 s7, s7, 1
    s_lshl1_add_u32 s7, s80, s7
    s_lshl_b32 s7, s7, 10
    s_add_u32 s6, s6, s7
    s_add_u32 s99, s6, 262144
    v_lshlrev_b32 v249, 7, v224
    v_mov_b32 v41, v242
    v_mov_b32 v42, v242
    v_mov_b32 v43, v242
    v_mov_b32 v44, v242
    v_mov_b32 v45, v242
    v_mov_b32 v46, v242
    v_mov_b32 v47, v242
    v_mov_b32 v48, v242
    v_mov_b32 v49, v242
    s_waitcnt vmcnt(11) lgkmcnt(0)
    s_barrier
    ds_read_b128 v[96:99], v232
    ds_read_b64_tr_b16 v[100:101], v237 offset:0
    ds_read_b64_tr_b16 v[102:103], v237 offset:256
    ds_read_b128 v[104:107], v233
    ds_read_b64_tr_b16 v[108:109], v237 offset:1024
    ds_read_b64_tr_b16 v[110:111], v237 offset:1280
    ds_read_b128 v[112:115], v234
    ds_read_b64_tr_b16 v[116:117], v237 offset:2048
    ds_read_b64_tr_b16 v[118:119], v237 offset:2304
    ds_read_b128 v[120:123], v235
    ds_read_b64_tr_b16 v[124:125], v237 offset:3072
    ds_read_b64_tr_b16 v[126:127], v237 offset:3328
    s_add_u32 m0, s87, 45056
    s_add_u32 s96, s83, 14336
    buffer_load_dwordx4 v226, s[8:11], s83 offen offset:0 lds
    buffer_load_dwordx4 v227, s[8:11], s83 offen offset:1024 lds
    buffer_load_dwordx4 v226, s[8:11], s96 offen offset:2048 lds
    buffer_load_dwordx4 v227, s[8:11], s96 offen offset:3072 lds
    s_add_u32 m0, s88, 61440
    s_nop 0
    buffer_load_dwordx4 v228, s[12:15], s101 offen offset:0 lds
    buffer_load_dwordx4 v229, s[12:15], s101 offen offset:1024 lds
    buffer_load_dwordx4 v230, s[12:15], s101 offen offset:2048 lds
    s_add_u32 m0, s88, 73728
    s_nop 0
    buffer_load_dwordx4 v228, s[40:43], s101 offen offset:0 lds
    buffer_load_dwordx4 v229, s[40:43], s101 offen offset:1024 lds
    buffer_load_dwordx4 v230, s[40:43], s101 offen offset:2048 lds
    s_add_u32 m0, s89, 86016
    s_nop 0
    buffer_load_dwordx4 v231, s[16:19], s84 offen lds
    s_add_u32 s83, s83, 128
    s_add_u32 s84, s84, 65536
    s_add_u32 s101, s101, 176128
    v_add_u32 v232, 0xfffea000, v232
    v_add_u32 v233, 0xfffea000, v233
    v_add_u32 v234, 0xfffea000, v234
    v_add_u32 v235, 0xfffea000, v235
    v_add_u32 v237, 0xfffea000, v237
    s_waitcnt lgkmcnt(0)
    v_mfma_f32_32x32x16_bf16 v[128:143], v[100:103], v[96:99], v[128:143]
    v_mfma_f32_32x32x16_bf16 v[128:143], v[108:111], v[104:107], v[128:143]
    v_mfma_f32_32x32x16_bf16 v[128:143], v[116:119], v[112:115], v[128:143]
    v_mfma_f32_32x32x16_bf16 v[128:143], v[124:127], v[120:123], v[128:143]
    s_mov_b32 s24, s68
    s_and_b32 s25, s69, 0xffff
    s_mov_b32 s26, 0x158000
    s_mov_b32 s27, 0x20000
    s_mov_b32 s28, s60
    s_and_b32 s29, s61, 0xffff
    s_mov_b32 s30, 0x80000
    s_mov_b32 s31, 0x20000
    s_mov_b32 s32, s72
    s_and_b32 s33, s73, 0xffff
    s_mov_b32 s34, 0x200000
    s_mov_b32 s35, 0x20000
    v_mov_b32 v243, 0x80000000
    v_mov_b32 v245, 163328
    v_writelane_b32 v243, 0, 0
    v_mov_b32 v50, v242
    v_mov_b32 v51, v242
    v_mov_b32 v52, v242
    v_mov_b32 v53, v242
    v_mov_b32 v54, v242
    v_mov_b32 v55, v242
    v_mov_b32 v56, v242
    v_mov_b32 v57, v242
    v_mov_b32 v58, v242
    s_waitcnt vmcnt(11) lgkmcnt(0)
    s_barrier
    ds_read_b128 v[96:99], v232
    ds_read_b64_tr_b16 v[100:101], v237 offset:0
    ds_read_b64_tr_b16 v[102:103], v237 offset:256
    ds_read_b128 v[104:107], v233
    ds_read_b64_tr_b16 v[108:109], v237 offset:1024
    ds_read_b64_tr_b16 v[110:111], v237 offset:1280
    ds_read_b128 v[112:115], v234
    ds_read_b64_tr_b16 v[116:117], v237 offset:2048
    ds_read_b64_tr_b16 v[118:119], v237 offset:2304
    ds_read_b128 v[120:123], v235
    ds_read_b64_tr_b16 v[124:125], v237 offset:3072
    ds_read_b64_tr_b16 v[126:127], v237 offset:3328
    s_add_u32 m0, s87, 90112
    s_add_u32 s96, s83, 14336
    buffer_load_dwordx4 v226, s[8:11], s83 offen offset:0 lds
    buffer_load_dwordx4 v227, s[8:11], s83 offen offset:1024 lds
    buffer_load_dwordx4 v226, s[8:11], s96 offen offset:2048 lds
    buffer_load_dwordx4 v227, s[8:11], s96 offen offset:3072 lds
    s_add_u32 m0, s88, 106496
    s_nop 0
    buffer_load_dwordx4 v228, s[12:15], s101 offen offset:0 lds
    buffer_load_dwordx4 v229, s[12:15], s101 offen offset:1024 lds
    buffer_load_dwordx4 v230, s[12:15], s101 offen offset:2048 lds
    s_add_u32 m0, s88, 118784
    s_nop 0
    buffer_load_dwordx4 v228, s[40:43], s101 offen offset:0 lds
    buffer_load_dwordx4 v229, s[40:43], s101 offen offset:1024 lds
    buffer_load_dwordx4 v230, s[40:43], s101 offen offset:2048 lds
    s_add_u32 m0, s89, 131072
    s_nop 0
    buffer_load_dwordx4 v231, s[16:19], s84 offen lds
    s_add_u32 s83, s83, 128
    s_add_u32 s84, s84, 65536
    s_add_u32 s101, s101, 176128
    v_add_u32 v232, 0xb000, v232
    v_add_u32 v233, 0xb000, v233
    v_add_u32 v234, 0xb000, v234
    v_add_u32 v235, 0xb000, v235
    v_add_u32 v237, 0xb000, v237
    s_waitcnt lgkmcnt(0)
    v_mfma_f32_32x32x16_bf16 v[128:143], v[100:103], v[96:99], v[128:143]
    v_mfma_f32_32x32x16_bf16 v[128:143], v[108:111], v[104:107], v[128:143]
    v_mfma_f32_32x32x16_bf16 v[128:143], v[116:119], v[112:115], v[128:143]
    v_mfma_f32_32x32x16_bf16 v[128:143], v[124:127], v[120:123], v[128:143]
    v_lshrrev_b32 v222, 3, v224
    v_lshlrev_b32 v222, 10, v222
    v_and_b32 v223, 16, v224
    v_lshlrev_b32 v223, 2, v223
    v_xor_b32 v223, v223, v225
    v_and_b32 v223, 0x70, v223
    s_lshl_b32 s6, s86, 7
    v_add3_u32 v238, v222, v223, s6
    v_mov_b32 v59, v242
    v_mov_b32 v60, v242
    v_mov_b32 v61, v242
    v_mov_b32 v62, v242
    v_mov_b32 v63, v242
    v_mov_b32 v64, v242
    v_mov_b32 v65, v242
    v_mov_b32 v66, v242
    v_mov_b32 v67, v242
    s_waitcnt vmcnt(11) lgkmcnt(0)
    s_barrier
    ds_read_b128 v[96:99], v232
    ds_read_b64_tr_b16 v[100:101], v237 offset:0
    ds_read_b64_tr_b16 v[102:103], v237 offset:256
    ds_read_b128 v[104:107], v233
    ds_read_b64_tr_b16 v[108:109], v237 offset:1024
    ds_read_b64_tr_b16 v[110:111], v237 offset:1280
    ds_read_b128 v[112:115], v234
    ds_read_b64_tr_b16 v[116:117], v237 offset:2048
    ds_read_b64_tr_b16 v[118:119], v237 offset:2304
    ds_read_b128 v[120:123], v235
    ds_read_b64_tr_b16 v[124:125], v237 offset:3072
    ds_read_b64_tr_b16 v[126:127], v237 offset:3328
    s_add_u32 m0, s87, 0
    s_add_u32 s96, s83, 14336
    buffer_load_dwordx4 v226, s[8:11], s83 offen offset:0 lds
    buffer_load_dwordx4 v227, s[8:11], s83 offen offset:1024 lds
    buffer_load_dwordx4 v226, s[8:11], s96 offen offset:2048 lds
    buffer_load_dwordx4 v227, s[8:11], s96 offen offset:3072 lds
    s_add_u32 m0, s88, 16384
    s_nop 0
    buffer_load_dwordx4 v228, s[12:15], s101 offen offset:0 lds
    buffer_load_dwordx4 v229, s[12:15], s101 offen offset:1024 lds
    buffer_load_dwordx4 v230, s[12:15], s101 offen offset:2048 lds
    s_add_u32 m0, s88, 28672
    s_nop 0
    buffer_load_dwordx4 v228, s[40:43], s101 offen offset:0 lds
    buffer_load_dwordx4 v229, s[40:43], s101 offen offset:1024 lds
    buffer_load_dwordx4 v230, s[40:43], s101 offen offset:2048 lds
    s_add_u32 m0, s89, 40960
    s_nop 0
    buffer_load_dwordx4 v231, s[16:19], s84 offen lds
    s_add_u32 s83, s83, 128
    s_add_u32 s84, s84, 65536
    s_add_u32 s101, s101, 176128
    v_add_u32 v232, 0xb000, v232
    v_add_u32 v233, 0xb000, v233
    v_add_u32 v234, 0xb000, v234
    v_add_u32 v235, 0xb000, v235
    v_add_u32 v237, 0xb000, v237
    s_waitcnt lgkmcnt(0)
    v_mfma_f32_32x32x16_bf16 v[128:143], v[100:103], v[96:99], v[128:143]
    v_mfma_f32_32x32x16_bf16 v[128:143], v[108:111], v[104:107], v[128:143]
    v_mfma_f32_32x32x16_bf16 v[128:143], v[116:119], v[112:115], v[128:143]
    v_mfma_f32_32x32x16_bf16 v[128:143], v[124:127], v[120:123], v[128:143]
    v_and_b32 v222, 1, v224
    v_lshlrev_b32 v222, 5, v222
    v_and_b32 v223, 16, v224
    v_add_u32 v222, v222, v223
    v_and_b32 v223, 2, v224
    v_lshl_add_u32 v222, v223, 2, v222
    v_lshl_add_u32 v222, v220, 7, v222
    v_and_b32 v223, 8, v224
    v_lshl_add_u32 v222, v223, 3, v222
    s_lshr_b32 s6, s78, 1
    s_lshl_b32 s6, s6, 11
    v_add_u32 v240, s6, v222
    v_xor_b32 v241, 64, v240
    v_mov_b32 v68, v242
    v_mov_b32 v69, v242
    v_mov_b32 v70, v242
    v_mov_b32 v71, v242
    v_mov_b32 v72, v242
    v_mov_b32 v73, v242
    v_mov_b32 v74, v242
    v_mov_b32 v75, v242
    v_mov_b32 v76, v242
    ds_read_b32 v244, v245 offset:40
    s_waitcnt vmcnt(11) lgkmcnt(0)
    s_barrier
    s_cmp_eq_u32 s78, 7
    s_mov_b32 s7, 0x80000000
    s_cselect_b32 s6, 196608, s7
    buffer_load_dwordx2 v[250:251], v249, s[20:23], s6 offen sc1
    ds_read_b128 v[96:99], v232
    ds_read_b64_tr_b16 v[100:101], v237 offset:0
    ds_read_b64_tr_b16 v[102:103], v237 offset:256
    ds_read_b128 v[104:107], v233
    ds_read_b64_tr_b16 v[108:109], v237 offset:1024
    ds_read_b64_tr_b16 v[110:111], v237 offset:1280
    ds_read_b128 v[112:115], v234
    ds_read_b64_tr_b16 v[116:117], v237 offset:2048
    ds_read_b64_tr_b16 v[118:119], v237 offset:2304
    ds_read_b128 v[120:123], v235
    ds_read_b64_tr_b16 v[124:125], v237 offset:3072
    ds_read_b64_tr_b16 v[126:127], v237 offset:3328
    s_add_u32 m0, s87, 45056
    s_add_u32 s96, s83, 14336
    buffer_load_dwordx4 v226, s[8:11], s83 offen offset:0 lds
    buffer_load_dwordx4 v227, s[8:11], s83 offen offset:1024 lds
    buffer_load_dwordx4 v226, s[8:11], s96 offen offset:2048 lds
    buffer_load_dwordx4 v227, s[8:11], s96 offen offset:3072 lds
    s_add_u32 m0, s88, 61440
    s_nop 0
    buffer_load_dwordx4 v228, s[12:15], s101 offen offset:0 lds
    buffer_load_dwordx4 v229, s[12:15], s101 offen offset:1024 lds
    buffer_load_dwordx4 v230, s[12:15], s101 offen offset:2048 lds
    s_add_u32 m0, s88, 73728
    s_nop 0
    buffer_load_dwordx4 v228, s[40:43], s101 offen offset:0 lds
    buffer_load_dwordx4 v229, s[40:43], s101 offen offset:1024 lds
    buffer_load_dwordx4 v230, s[40:43], s101 offen offset:2048 lds
    s_add_u32 m0, s89, 86016
    s_nop 0
    buffer_load_dwordx4 v231, s[16:19], s84 offen lds
    v_add_u32 v232, 0xfffea000, v232
    v_add_u32 v233, 0xfffea000, v233
    v_add_u32 v234, 0xfffea000, v234
    v_add_u32 v235, 0xfffea000, v235
    v_add_u32 v237, 0xfffea000, v237
    s_waitcnt lgkmcnt(0)
    v_mfma_f32_32x32x16_bf16 v[128:143], v[100:103], v[96:99], v[128:143]
    v_mfma_f32_32x32x16_bf16 v[128:143], v[108:111], v[104:107], v[128:143]
    v_mfma_f32_32x32x16_bf16 v[128:143], v[116:119], v[112:115], v[128:143]
    v_mfma_f32_32x32x16_bf16 v[128:143], v[124:127], v[120:123], v[128:143]
    v_readfirstlane_b32 s81, v244
    v_mov_b32 v246, 0xdddddddd
    v_and_b32 v222, 32, v224
    v_lshlrev_b32 v222, 3, v222
    v_and_b32 v223, 0xf0, v225
    v_add_u32 v254, v222, v223
    v_and_b32 v248, 0x7c, v239
    v_mov_b32 v77, v242
    v_mov_b32 v78, v242
    v_mov_b32 v79, v242
    v_mov_b32 v80, v242
    v_mov_b32 v81, v242
    v_mov_b32 v82, v242
    v_mov_b32 v83, v242
    v_mov_b32 v84, v242
    v_mov_b32 v85, v242
    s_waitcnt vmcnt(11)
    s_cmp_eq_u32 s78, 7
    s_cbranch_scc0 L_nopollB
    v_cmp_eq_u32 vcc, s81, v250
    s_cmp_eq_u64 vcc, -1
    s_cbranch_scc1 L_fk_okB
    s_mov_b32 s92, 0
    s_mov_b32 s6, 196608
L_fkB:
    buffer_load_dwordx2 v[250:251], v249, s[20:23], s6 offen sc1
    s_waitcnt vmcnt(0)
    v_cmp_eq_u32 vcc, s81, v250
    s_cmp_eq_u64 vcc, -1
    s_cbranch_scc1 L_fk_okB
    s_sleep 2
    s_add_u32 s92, s92, 1
    s_cmp_lt_u32 s92, 0x100000
    s_cbranch_scc1 L_fkB
L_fk_okB:
    s_nop 1
    v_max_f32_dpp v251, v251, v251 row_shr:1
    s_nop 1
    v_max_f32_dpp v251, v251, v251 row_shr:2
    s_nop 1
    v_max_f32_dpp v251, v251, v251 row_shr:4
    s_nop 1
    v_max_f32_dpp v251, v251, v251 row_shr:8
    s_nop 1
    v_max_f32_dpp v251, v251, v251 row_bcast:15 row_mask:0xa
    s_nop 1
    v_max_f32_dpp v251, v251, v251 row_bcast:31 row_mask:0xc
    s_mov_b32 s6, 163360
    v_mov_b32 v250, 163376
    v_writelane_b32 v250, s6, 63
    ds_write_b32 v250, v251
L_nopollB:
    s_waitcnt lgkmcnt(0)
    s_barrier
    ds_read_b128 v[96:99], v232
    ds_read_b64_tr_b16 v[100:101], v237 offset:0
    ds_read_b64_tr_b16 v[102:103], v237 offset:256
    ds_read_b128 v[104:107], v233
    ds_read_b64_tr_b16 v[108:109], v237 offset:1024
    ds_read_b64_tr_b16 v[110:111], v237 offset:1280
    ds_read_b128 v[112:115], v234
    ds_read_b64_tr_b16 v[116:117], v237 offset:2048
    ds_read_b64_tr_b16 v[118:119], v237 offset:2304
    ds_read_b128 v[120:123], v235
    ds_read_b64_tr_b16 v[124:125], v237 offset:3072
    ds_read_b64_tr_b16 v[126:127], v237 offset:3328
    v_add_u32 v232, 0xb000, v232
    v_add_u32 v233, 0xb000, v233
    v_add_u32 v234, 0xb000, v234
    v_add_u32 v235, 0xb000, v235
    v_add_u32 v237, 0xb000, v237
    s_waitcnt lgkmcnt(0)
    v_mfma_f32_32x32x16_bf16 v[128:143], v[100:103], v[96:99], v[128:143]
    v_mfma_f32_32x32x16_bf16 v[128:143], v[108:111], v[104:107], v[128:143]
    v_mfma_f32_32x32x16_bf16 v[128:143], v[116:119], v[112:115], v[128:143]
    v_mfma_f32_32x32x16_bf16 v[128:143], v[124:127], v[120:123], v[128:143]
    s_and_b32 s6, s78, 1
    s_lshl1_add_u32 s6, s85, s6
    s_lshl_b32 s40, s6, 7
    s_add_u32 s40, s40, 16384
    s_mul_i32 s98, s6, 120832
    s_lshr_b32 s6, s78, 1
    s_lshl_b32 s6, s6, 10
    s_add_u32 s98, s98, s6
    s_add_u32 s98, s98, 262144
    s_lshl_b32 s6, s78, 13
    s_mov_b32 s39, 0
    s_xor_b32 s6, s6, s39
    s_mov_b32 s36, 0
    s_add_u32 s37, s6, 32768
    s_add_u32 s38, s6, 98304
    s_mov_b32 s42, 0xffff
    s_mov_b32 s43, 0xffff
    v_mov_b32 v86, v242
    v_mov_b32 v87, v242
    v_mov_b32 v88, v242
    v_mov_b32 v89, v242
    v_mov_b32 v90, v242
    v_mov_b32 v91, v242
    v_mov_b32 v92, v242
    v_mov_b32 v93, v242
    v_mov_b32 v94, v242
    v_mov_b32 v95, v242
    s_lshl_b32 s6, s82, 13
    s_add_u32 s7, s6, s39
    s_add_u32 s7, s7, 32768
    s_add_u32 m0, s6, 90112
    s_add_u32 s96, s7, 0
    buffer_load_dwordx4 v225, s[20:23], s96 offen offset:0 sc1 lds
    buffer_load_dwordx4 v225, s[20:23], s96 offen offset:1024 sc1 lds
    buffer_load_dwordx4 v225, s[20:23], s96 offen offset:2048 sc1 lds
    buffer_load_dwordx4 v225, s[20:23], s96 offen offset:3072 sc1 lds
    s_add_u32 m0, s6, 94208
    s_add_u32 s96, s7, 4096
    buffer_load_dwordx4 v225, s[20:23], s96 offen offset:0 sc1 lds
    buffer_load_dwordx4 v225, s[20:23], s96 offen offset:1024 sc1 lds
    buffer_load_dwordx4 v225, s[20:23], s96 offen offset:2048 sc1 lds
    buffer_load_dwordx4 v225, s[20:23], s96 offen offset:3072 sc1 lds
    s_add_u32 m0, s6, 122880
    s_add_u32 s96, s7, 65536
    buffer_load_dwordx4 v225, s[20:23], s96 offen offset:0 sc1 lds
    buffer_load_dwordx4 v225, s[20:23], s96 offen offset:1024 sc1 lds
    buffer_load_dwordx4 v225, s[20:23], s96 offen offset:2048 sc1 lds
    buffer_load_dwordx4 v225, s[20:23], s96 offen offset:3072 sc1 lds
    s_waitcnt vmcnt(12) lgkmcnt(0)
    s_barrier
    ds_read_b128 v[96:99], v232
    ds_read_b64_tr_b16 v[100:101], v237 offset:0
    ds_read_b64_tr_b16 v[102:103], v237 offset:256
    ds_read_b128 v[104:107], v233
    ds_read_b64_tr_b16 v[108:109], v237 offset:1024
    ds_read_b64_tr_b16 v[110:111], v237 offset:1280
    ds_read_b128 v[112:115], v234
    ds_read_b64_tr_b16 v[116:117], v237 offset:2048
    ds_read_b64_tr_b16 v[118:119], v237 offset:2304
    ds_read_b128 v[120:123], v235
    ds_read_b64_tr_b16 v[124:125], v237 offset:3072
    ds_read_b64_tr_b16 v[126:127], v237 offset:3328
    s_waitcnt lgkmcnt(0)
    v_mfma_f32_32x32x16_bf16 v[128:143], v[100:103], v[96:99], v[128:143]
    v_mfma_f32_32x32x16_bf16 v[128:143], v[108:111], v[104:107], v[128:143]
    v_mfma_f32_32x32x16_bf16 v[128:143], v[116:119], v[112:115], v[128:143]
    v_mfma_f32_32x32x16_bf16 v[128:143], v[124:127], v[120:123], v[128:143]
    s_lshl_b32 s6, s82, 13
    s_add_u32 s96, s6, s39
    s_add_u32 s96, s96, 102400
    s_add_u32 s6, s6, 126976
    s_cmp_eq_u32 s82, 3
    s_cselect_b32 m0, 32768, s6
    s_nop 0
    buffer_load_dwordx4 v225, s[20:23], s96 offen offset:0 sc1 lds
    buffer_load_dwordx4 v225, s[20:23], s96 offen offset:1024 sc1 lds
    buffer_load_dwordx4 v225, s[20:23], s96 offen offset:2048 sc1 lds
    buffer_load_dwordx4 v225, s[20:23], s96 offen offset:3072 sc1 lds
    v_mov_b32 v222, 0x3eb8aa3b
    v_mov_b32 v223, 0x3eb8aa3b
    s_nop 9
    v_pk_mul_f32 v[128:129], v[128:129], v[222:223]
    v_pk_mul_f32 v[130:131], v[130:131], v[222:223]
    v_pk_mul_f32 v[132:133], v[132:133], v[222:223]
    v_pk_mul_f32 v[134:135], v[134:135], v[222:223]
    v_pk_mul_f32 v[136:137], v[136:137], v[222:223]
    v_pk_mul_f32 v[138:139], v[138:139], v[222:223]
    v_pk_mul_f32 v[140:141], v[140:141], v[222:223]
    v_pk_mul_f32 v[142:143], v[142:143], v[222:223]
    v_cvt_pk_bf16_f32 v168, v128, v129
    v_cvt_pk_bf16_f32 v169, v130, v131
    v_cvt_pk_bf16_f32 v170, v132, v133
    v_cvt_pk_bf16_f32 v171, v134, v135
    v_cvt_pk_bf16_f32 v172, v136, v137
    v_cvt_pk_bf16_f32 v173, v138, v139
    v_cvt_pk_bf16_f32 v174, v140, v141
    v_cvt_pk_bf16_f32 v175, v142, v143
    s_lshl_b32 s3, s82, 11
    s_add_u32 s3, s3, 151552
    v_add_u32 v252, s3, v225
    ds_write_b128 v252, v[168:171]
    ds_write_b128 v252, v[172:175] offset:1024
    v_pk_mul_f32 v[160:161], v[128:129], v[128:129]
    v_pk_fma_f32 v[160:161], v[130:131], v[130:131], v[160:161]
    v_pk_fma_f32 v[160:161], v[132:133], v[132:133], v[160:161]
    v_pk_fma_f32 v[160:161], v[134:135], v[134:135], v[160:161]
    v_pk_mul_f32 v[162:163], v[136:137], v[136:137]
    v_pk_fma_f32 v[162:163], v[138:139], v[138:139], v[162:163]
    v_pk_fma_f32 v[162:163], v[140:141], v[140:141], v[162:163]
    v_pk_fma_f32 v[162:163], v[142:143], v[142:143], v[162:163]
    v_add_f32 v160, v160, v161
    v_add_f32 v162, v162, v163
    v_mov_b32 v161, v160
    v_mov_b32 v163, v162
    s_nop 1
    v_permlane32_swap_b32 v160, v161
    v_permlane32_swap_b32 v162, v163
    s_nop 1
    v_add_f32 v160, v160, v161
    v_add_f32 v162, v162, v163
    v_max_f32 v160, v160, v162
    s_nop 1
    v_max_f32_dpp v160, v160, v160 row_shr:1
    s_nop 1
    v_max_f32_dpp v160, v160, v160 row_shr:2
    s_nop 1
    v_max_f32_dpp v160, v160, v160 row_shr:4
    s_nop 1
    v_max_f32_dpp v160, v160, v160 row_shr:8
    s_nop 1
    v_max_f32_dpp v160, v160, v160 row_bcast:15 row_mask:0xa
    s_lshl_b32 s3, s82, 2
    s_add_u32 s3, s3, 163344
    v_mov_b32 v161, 163376
    v_writelane_b32 v161, s3, 31
    ds_write_b32 v161, v160
    s_mov_b32 s44, 0x80000000
    s_mov_b32 s45, 0x80000000
    s_mov_b32 s46, 0x80000000
    s_lshl2_add_u32 s7, s78, 163392
    v_mov_b32 v252, 163376
    v_mov_b32 v253, -1
    v_writelane_b32 v252, s7, 0
    ds_write_b32 v252, v253
    s_setprio 0
    s_add_u32 s96, s36, 0
    s_and_b32 s96, s96, 7
    s_lshl_b32 s96, s96, 10
    s_add_u32 s96, s96, s37
    buffer_load_dwordx4 v[0:3], v225, s[20:23], s96 offen sc1
    s_add_u32 s96, s36, 1
    s_and_b32 s96, s96, 7
    s_lshl_b32 s96, s96, 10
    s_add_u32 s96, s96, s37
    buffer_load_dwordx4 v[4:7], v225, s[20:23], s96 offen sc1
    s_add_u32 s96, s36, 0
    s_and_b32 s96, s96, 7
    s_lshl_b32 s96, s96, 10
    s_add_u32 s96, s96, s38
    s_mov_b64 exec, s[42:43]
    buffer_load_dwordx4 v[32:35], v254, s[20:23], s96 offen offset:0 sc1
    buffer_load_dwordx4 v[36:39], v254, s[20:23], s96 offen offset:512 sc1
    s_mov_b64 exec, -1
    s_add_u32 s96, s36, 2
    s_and_b32 s96, s96, 7
    s_lshl_b32 s96, s96, 10
    s_add_u32 s96, s96, s37
    buffer_load_dwordx4 v[8:11], v225, s[20:23], s96 offen sc1
    s_waitcnt vmcnt(5)
    s_lshl2_add_u32 s7, s82, 163424
    v_mov_b32 v252, 163376
    v_mov_b32 v253, -1
    v_writelane_b32 v252, s7, 0
    ds_write_b32 v252, v253
    s_add_u32 s96, s36, 1
    s_and_b32 s96, s96, 7
    s_lshl_b32 s96, s96, 10
    s_add_u32 s96, s96, s38
    s_mov_b64 exec, s[42:43]
    buffer_load_dwordx4 v[40:43], v254, s[20:23], s96 offen offset:0 sc1
    buffer_load_dwordx4 v[44:47], v254, s[20:23], s96 offen offset:512 sc1
    s_mov_b64 exec, -1
    s_add_u32 s96, s36, 3
    s_and_b32 s96, s96, 7
    s_lshl_b32 s96, s96, 10
    s_add_u32 s96, s96, s37
    buffer_load_dwordx4 v[12:15], v225, s[20:23], s96 offen sc1
    s_add_u32 s96, s36, 2
    s_and_b32 s96, s96, 7
    s_lshl_b32 s96, s96, 10
    s_add_u32 s96, s96, s38
    s_mov_b64 exec, s[42:43]
    buffer_load_dwordx4 v[48:51], v254, s[20:23], s96 offen offset:0 sc1
    buffer_load_dwordx4 v[52:55], v254, s[20:23], s96 offen offset:512 sc1
    s_mov_b64 exec, -1
    s_add_u32 s96, s36, 4
    s_and_b32 s96, s96, 7
    s_lshl_b32 s96, s96, 10
    s_add_u32 s96, s96, s37
    buffer_load_dwordx4 v[16:19], v225, s[20:23], s96 offen sc1
    s_add_u32 s96, s36, 3
    s_and_b32 s96, s96, 7
    s_lshl_b32 s96, s96, 10
    s_add_u32 s96, s96, s38
    s_mov_b64 exec, s[42:43]
    buffer_load_dwordx4 v[56:59], v254, s[20:23], s96 offen offset:0 sc1
    buffer_load_dwordx4 v[60:63], v254, s[20:23], s96 offen offset:512 sc1
    s_mov_b64 exec, -1
    s_add_u32 s96, s36, 5
    s_and_b32 s96, s96, 7
    s_lshl_b32 s96, s96, 10
    s_add_u32 s96, s96, s37
    buffer_load_dwordx4 v[20:23], v225, s[20:23], s96 offen sc1
    s_add_u32 s96, s36, 4
    s_and_b32 s96, s96, 7
    s_lshl_b32 s96, s96, 10
    s_add_u32 s96, s96, s38
    s_mov_b64 exec, s[42:43]
    buffer_load_dwordx4 v[64:67], v254, s[20:23], s96 offen offset:0 sc1
    buffer_load_dwordx4 v[68:71], v254, s[20:23], s96 offen offset:512 sc1
    s_mov_b64 exec, -1
    s_add_u32 s96, s36, 6
    s_and_b32 s96, s96, 7
    s_lshl_b32 s96, s96, 10
    s_add_u32 s96, s96, s37
    buffer_load_dwordx4 v[24:27], v225, s[20:23], s96 offen sc1
    s_add_u32 s96, s36, 5
    s_and_b32 s96, s96, 7
    s_lshl_b32 s96, s96, 10
    s_add_u32 s96, s96, s38
    s_mov_b64 exec, s[42:43]
    buffer_load_dwordx4 v[72:75], v254, s[20:23], s96 offen offset:0 sc1
    buffer_load_dwordx4 v[76:79], v254, s[20:23], s96 offen offset:512 sc1
    s_mov_b64 exec, -1
    s_add_u32 s96, s36, 7
    s_and_b32 s96, s96, 7
    s_lshl_b32 s96, s96, 10
    s_add_u32 s96, s96, s37
    buffer_load_dwordx4 v[28:31], v225, s[20:23], s96 offen sc1
    s_add_u32 s96, s36, 6
    s_and_b32 s96, s96, 7
    s_lshl_b32 s96, s96, 10
    s_add_u32 s96, s96, s38
    s_mov_b64 exec, s[42:43]
    buffer_load_dwordx4 v[80:83], v254, s[20:23], s96 offen offset:0 sc1
    buffer_load_dwordx4 v[84:87], v254, s[20:23], s96 offen offset:512 sc1
    s_mov_b64 exec, -1
    s_add_u32 s96, s36, 7
    s_and_b32 s96, s96, 7
    s_lshl_b32 s96, s96, 10
    s_add_u32 s96, s96, s38
    s_mov_b64 exec, s[42:43]
    buffer_load_dwordx4 v[88:91], v254, s[20:23], s96 offen offset:0 sc1
    buffer_load_dwordx4 v[92:95], v254, s[20:23], s96 offen offset:512 sc1
    s_mov_b64 exec, -1
    s_mov_b32 s92, 0
L_awB1:
    ds_read_b128 v[96:99], v245 offset:80
    s_waitcnt lgkmcnt(0)
    v_and_b32 v96, v96, v97
    v_and_b32 v98, v98, v99
    v_and_b32 v96, v96, v98
    s_add_u32 s92, s92, 1
    v_readfirstlane_b32 s96, v96
    s_cmp_gt_u32 s92, 0x1000000
    s_cbranch_scc1 L_awB1_ok
    s_cmp_eq_u32 s96, 0
    s_cbranch_scc1 L_awB1
L_awB1_ok:
L_p1_done:
    s_lshl_b32 s3, s78, 10
    s_add_u32 s3, s3, 151552
    v_add_u32 v230, s3, v225
    ds_read_b128 v[216:219], v230
    ds_read_b128 v[96:99], v245 offset:16
    ds_read_b32 v100, v245 offset:32
    ds_read_b128 v[128:131], v245
    ds_read_b128 v[144:147], v245
    ds_read_b128 v[132:135], v245
    ds_read_b128 v[148:151], v245
    ds_read_b32 v136, v245
    ds_read_b32 v152, v245
    s_waitcnt lgkmcnt(6)
    v_max3_f32 v96, v96, v97, v98
    v_max_f32 v96, v96, v99
    v_mul_f32 v96, v96, v100
    v_cmp_gt_f32 vcc, 0x457afafb, v96
    s_cmp_eq_u64 vcc, -1
    s_cbranch_scc0 L_slow
    s_waitcnt vmcnt(23)
    v_mfma_f32_32x32x16_bf16 v[96:111], v[0:3], v[216:219], 0
    s_nop 11
    v_exp_f32 v96, v96
    v_exp_f32 v97, v97
    v_exp_f32 v98, v98
    v_exp_f32 v99, v99
    v_exp_f32 v100, v100
    v_exp_f32 v101, v101
    s_waitcnt vmcnt(22)
    v_mfma_f32_32x32x16_bf16 v[112:127], v[4:7], v[216:219], 0
    v_exp_f32 v102, v102
    v_exp_f32 v103, v103
    v_exp_f32 v104, v104
    v_exp_f32 v105, v105
    s_waitcnt lgkmcnt(0)
    s_waitcnt vmcnt(20)
    v_smfmac_f32_32x32x32_bf16 v[128:143], v[32:35], v[96:103], v246
    v_exp_f32 v106, v106
    v_exp_f32 v107, v107
    v_exp_f32 v108, v108
    v_exp_f32 v109, v109
    s_nop 0
    v_mov_b32 v160, -1
    v_mov_b32 v161, -1
    v_mov_b32 v162, -1
    v_mov_b32 v163, -1
    buffer_store_dwordx4 v[160:163], v225, s[20:23], s99 offen sc1
    v_exp_f32 v110, v110
    v_exp_f32 v111, v111
    v_exp_f32 v112, v112
    v_exp_f32 v113, v113
    v_smfmac_f32_32x32x32_bf16 v[128:143], v[36:39], v[104:111], v246
    v_exp_f32 v114, v114
    v_exp_f32 v115, v115
    v_exp_f32 v116, v116
    v_exp_f32 v117, v117
    s_waitcnt vmcnt(20)
    v_mfma_f32_32x32x16_bf16 v[96:111], v[8:11], v[216:219], 0
    v_exp_f32 v118, v118
    v_exp_f32 v119, v119
    v_exp_f32 v120, v120
    v_exp_f32 v121, v121
    s_waitcnt vmcnt(18)
    v_smfmac_f32_32x32x32_bf16 v[128:143], v[40:43], v[112:119], v246
    buffer_store_dwordx4 v[192:195], v225, s[20:23], s44 offen offset:0 sc1
    v_exp_f32 v122, v122
    v_exp_f32 v123, v123
    v_exp_f32 v124, v124
    v_exp_f32 v125, v125
    s_nop 0
    v_exp_f32 v126, v126
    v_exp_f32 v127, v127
    v_exp_f32 v96, v96
    v_exp_f32 v97, v97
    v_smfmac_f32_32x32x32_bf16 v[128:143], v[44:47], v[120:127], v246
    v_exp_f32 v98, v98
    v_exp_f32 v99, v99
    v_exp_f32 v100, v100
    v_exp_f32 v101, v101
    s_waitcnt vmcnt(18)
    v_mfma_f32_32x32x16_bf16 v[112:127], v[12:15], v[216:219], 0
    v_exp_f32 v102, v102
    v_exp_f32 v103, v103
    v_exp_f32 v104, v104
    v_exp_f32 v105, v105
    s_waitcnt vmcnt(16)
    v_smfmac_f32_32x32x32_bf16 v[128:143], v[48:51], v[96:103], v246
    buffer_store_dwordx4 v[196:199], v225, s[20:23], s44 offen offset:1024 sc1
    v_exp_f32 v106, v106
    v_exp_f32 v107, v107
    v_exp_f32 v108, v108
    v_exp_f32 v109, v109
    s_nop 0
    v_exp_f32 v110, v110
    v_exp_f32 v111, v111
    v_exp_f32 v112, v112
    v_exp_f32 v113, v113
    v_smfmac_f32_32x32x32_bf16 v[128:143], v[52:55], v[104:111], v246
    v_exp_f32 v114, v114
    v_exp_f32 v115, v115
    v_exp_f32 v116, v116
    v_exp_f32 v117, v117
    s_waitcnt vmcnt(16)
    v_mfma_f32_32x32x16_bf16 v[96:111], v[16:19], v[216:219], 0
    v_exp_f32 v118, v118
    v_exp_f32 v119, v119
    v_exp_f32 v120, v120
    v_exp_f32 v121, v121
    s_waitcnt vmcnt(14)
    v_smfmac_f32_32x32x32_bf16 v[128:143], v[56:59], v[112:119], v246
    buffer_store_dwordx4 v[200:203], v225, s[20:23], s45 offen offset:0 sc1
    v_exp_f32 v122, v122
    v_exp_f32 v123, v123
    v_exp_f32 v124, v124
    v_exp_f32 v125, v125
    s_nop 0
    v_exp_f32 v126, v126
    v_exp_f32 v127, v127
    v_exp_f32 v96, v96
    v_exp_f32 v97, v97
    v_smfmac_f32_32x32x32_bf16 v[128:143], v[60:63], v[120:127], v246
    v_exp_f32 v98, v98
    v_exp_f32 v99, v99
    v_exp_f32 v100, v100
    v_exp_f32 v101, v101
    s_waitcnt vmcnt(14)
    v_mfma_f32_32x32x16_bf16 v[112:127], v[20:23], v[216:219], 0
    v_exp_f32 v102, v102
    v_exp_f32 v103, v103
    v_exp_f32 v104, v104
    v_exp_f32 v105, v105
    s_waitcnt vmcnt(12)
    v_smfmac_f32_32x32x32_bf16 v[128:143], v[64:67], v[96:103], v246
    buffer_store_dwordx4 v[204:207], v225, s[20:23], s45 offen offset:1024 sc1
    s_add_u32 s3, s78, 1
    s_and_b32 s3, s3, 7
    s_lshl_b32 s3, s3, 10
    s_add_u32 s3, s3, 151552
    v_add_u32 v230, s3, v225
    ds_read_b128 v[220:223], v230
    v_exp_f32 v106, v106
    v_exp_f32 v107, v107
    v_exp_f32 v108, v108
    v_exp_f32 v109, v109
    s_nop 0
    v_exp_f32 v110, v110
    v_exp_f32 v111, v111
    v_exp_f32 v112, v112
    v_exp_f32 v113, v113
    v_smfmac_f32_32x32x32_bf16 v[128:143], v[68:71], v[104:111], v246
    v_exp_f32 v114, v114
    v_exp_f32 v115, v115
    v_exp_f32 v116, v116
    v_exp_f32 v117, v117
    s_waitcnt vmcnt(12)
    v_mfma_f32_32x32x16_bf16 v[96:111], v[24:27], v[216:219], 0
    v_exp_f32 v118, v118
    v_exp_f32 v119, v119
    v_exp_f32 v120, v120
    v_exp_f32 v121, v121
    s_waitcnt vmcnt(10)
    v_smfmac_f32_32x32x32_bf16 v[128:143], v[72:75], v[112:119], v246
    buffer_store_dwordx4 v[208:211], v225, s[20:23], s46 offen offset:0 sc1
    v_exp_f32 v122, v122
    v_exp_f32 v123, v123
    v_exp_f32 v124, v124
    v_exp_f32 v125, v125
    s_nop 0
    s_add_u32 s3, s78, 0
    s_and_b32 s3, s3, 7
    s_mul_i32 s3, s3, 2304
    s_add_u32 s3, s3, 98304
    v_add_u32 v226, s3, v225
    v_add_u32 v228, s3, v239
    v_exp_f32 v126, v126
    v_exp_f32 v127, v127
    v_exp_f32 v96, v96
    v_exp_f32 v97, v97
    v_smfmac_f32_32x32x32_bf16 v[128:143], v[76:79], v[120:127], v246
    v_exp_f32 v98, v98
    v_exp_f32 v99, v99
    v_exp_f32 v100, v100
    v_exp_f32 v101, v101
    s_waitcnt vmcnt(10)
    v_mfma_f32_32x32x16_bf16 v[112:127], v[28:31], v[216:219], 0
    v_exp_f32 v102, v102
    v_exp_f32 v103, v103
    v_exp_f32 v104, v104
    v_exp_f32 v105, v105
    s_waitcnt vmcnt(8)
    v_smfmac_f32_32x32x32_bf16 v[128:143], v[80:83], v[96:103], v246
    buffer_store_dwordx4 v[212:215], v225, s[20:23], s46 offen offset:1024 sc1
    v_exp_f32 v106, v106
    v_exp_f32 v107, v107
    v_exp_f32 v108, v108
    v_exp_f32 v109, v109
    s_nop 0
    s_add_u32 s3, s78, 1
    s_and_b32 s3, s3, 7
    s_mul_i32 s3, s3, 2304
    s_add_u32 s3, s3, 116736
    v_add_u32 v227, s3, v225
    v_add_u32 v229, s3, v239
    v_exp_f32 v110, v110
    v_exp_f32 v111, v111
    s_setprio 3
    v_exp_f32 v112, v112
    v_exp_f32 v113, v113
    v_smfmac_f32_32x32x32_bf16 v[128:143], v[84:87], v[104:111], v246
    s_waitcnt lgkmcnt(0)
    s_barrier
    v_exp_f32 v114, v114
    v_exp_f32 v115, v115
    v_exp_f32 v116, v116
    v_exp_f32 v117, v117
    v_mfma_f32_32x32x16_bf16 v[96:111], v[0:3], v[220:223], 0
    v_exp_f32 v118, v118
    v_exp_f32 v119, v119
    v_exp_f32 v120, v120
    v_exp_f32 v121, v121
    s_waitcnt vmcnt(7)
    v_smfmac_f32_32x32x32_bf16 v[128:143], v[88:91], v[112:119], v246
    v_exp_f32 v122, v122
    v_exp_f32 v123, v123
    v_exp_f32 v124, v124
    v_exp_f32 v125, v125
    s_nop 0
    v_exp_f32 v126, v126
    v_exp_f32 v127, v127
    v_exp_f32 v96, v96
    v_exp_f32 v97, v97
    v_smfmac_f32_32x32x32_bf16 v[128:143], v[92:95], v[120:127], v246
    v_exp_f32 v98, v98
    v_exp_f32 v99, v99
    v_exp_f32 v100, v100
    v_exp_f32 v101, v101
    v_mfma_f32_32x32x16_bf16 v[112:127], v[4:7], v[220:223], 0
    v_exp_f32 v102, v102
    v_exp_f32 v103, v103
    v_exp_f32 v104, v104
    v_exp_f32 v105, v105
    v_smfmac_f32_32x32x32_bf16 v[144:159], v[32:35], v[96:103], v246
    s_lshl_b32 s3, s78, 12
    s_add_u32 m0, s3, 65536
    s_lshl_b32 s3, s78, 15
    s_add_u32 s3, s3, 262144
    buffer_load_dwordx4 v238, s[28:31], s3 offen lds
    v_exp_f32 v106, v106
    v_exp_f32 v107, v107
    v_exp_f32 v108, v108
    v_exp_f32 v109, v109
    s_nop 0
    v_exp_f32 v110, v110
    v_exp_f32 v111, v111
    v_exp_f32 v112, v112
    v_exp_f32 v113, v113
    v_smfmac_f32_32x32x32_bf16 v[144:159], v[36:39], v[104:111], v246
    ds_write_b128 v226, v[128:131] offset:0
    v_exp_f32 v114, v114
    v_exp_f32 v115, v115
    v_exp_f32 v116, v116
    v_exp_f32 v117, v117
    v_mfma_f32_32x32x16_bf16 v[96:111], v[8:11], v[220:223], 0
    ds_write_b128 v226, v[132:135] offset:1024
    v_exp_f32 v118, v118
    v_exp_f32 v119, v119
    v_exp_f32 v120, v120
    v_exp_f32 v121, v121
    v_smfmac_f32_32x32x32_bf16 v[144:159], v[40:43], v[112:119], v246
    s_lshl_b32 s3, s78, 12
    s_add_u32 m0, s3, 66560
    s_lshl_b32 s3, s78, 15
    s_add_u32 s3, s3, 270336
    buffer_load_dwordx4 v238, s[28:31], s3 offen lds
    v_exp_f32 v122, v122
    v_exp_f32 v123, v123
    v_exp_f32 v124, v124
    v_exp_f32 v125, v125
    s_nop 0
    ds_write_b32 v228, v136 offset:2048
    v_exp_f32 v126, v126
    v_exp_f32 v127, v127
    v_exp_f32 v96, v96
    v_exp_f32 v97, v97
    v_smfmac_f32_32x32x32_bf16 v[144:159], v[44:47], v[120:127], v246
    v_exp_f32 v98, v98
    v_exp_f32 v99, v99
    v_exp_f32 v100, v100
    v_exp_f32 v101, v101
    v_mfma_f32_32x32x16_bf16 v[112:127], v[12:15], v[220:223], 0
    v_exp_f32 v102, v102
    v_exp_f32 v103, v103
    v_exp_f32 v104, v104
    v_exp_f32 v105, v105
    v_smfmac_f32_32x32x32_bf16 v[144:159], v[48:51], v[96:103], v246
    s_lshl_b32 s3, s78, 12
    s_add_u32 m0, s3, 67584
    s_lshl_b32 s3, s78, 15
    s_add_u32 s3, s3, 278528
    buffer_load_dwordx4 v238, s[28:31], s3 offen lds
    v_exp_f32 v106, v106
    v_exp_f32 v107, v107
    v_exp_f32 v108, v108
    v_exp_f32 v109, v109
    s_nop 0
    v_exp_f32 v110, v110
    v_exp_f32 v111, v111
    s_setprio 2
    v_exp_f32 v112, v112
    v_exp_f32 v113, v113
    v_smfmac_f32_32x32x32_bf16 v[144:159], v[52:55], v[104:111], v246
    v_exp_f32 v114, v114
    v_exp_f32 v115, v115
    v_exp_f32 v116, v116
    v_exp_f32 v117, v117
    v_mfma_f32_32x32x16_bf16 v[96:111], v[16:19], v[220:223], 0
    v_exp_f32 v118, v118
    v_exp_f32 v119, v119
    v_exp_f32 v120, v120
    v_exp_f32 v121, v121
    v_smfmac_f32_32x32x32_bf16 v[144:159], v[56:59], v[112:119], v246
    s_lshl_b32 s3, s78, 12
    s_add_u32 m0, s3, 68608
    s_lshl_b32 s3, s78, 15
    s_add_u32 s3, s3, 286720
    buffer_load_dwordx4 v238, s[28:31], s3 offen lds
    v_exp_f32 v122, v122
    v_exp_f32 v123, v123
    v_exp_f32 v124, v124
    v_exp_f32 v125, v125
    s_nop 0
    v_exp_f32 v126, v126
    v_exp_f32 v127, v127
    v_exp_f32 v96, v96
    v_exp_f32 v97, v97
    v_smfmac_f32_32x32x32_bf16 v[144:159], v[60:63], v[120:127], v246
    s_waitcnt vmcnt(4)
    s_lshl4_add_u32 s3, s79, s80
    s_lshl_b32 s3, s3, 5
    s_add_u32 s3, s3, s78
    s_lshl_b32 s3, s3, 2
    s_add_u32 s3, s3, 212992
    buffer_store_dword v244, v243, s[20:23], s3 offen sc1
    v_exp_f32 v98, v98
    v_exp_f32 v99, v99
    v_exp_f32 v100, v100
    v_exp_f32 v101, v101
    v_mfma_f32_32x32x16_bf16 v[112:127], v[20:23], v[220:223], 0
    v_exp_f32 v102, v102
    v_exp_f32 v103, v103
    v_exp_f32 v104, v104
    v_exp_f32 v105, v105
    v_smfmac_f32_32x32x32_bf16 v[144:159], v[64:67], v[96:103], v246
    s_add_u32 s3, s78, 2
    s_and_b32 s3, s3, 7
    s_lshl_b32 s3, s3, 10
    s_add_u32 s3, s3, 151552
    v_add_u32 v230, s3, v225
    ds_read_b128 v[216:219], v230
    v_exp_f32 v106, v106
    v_exp_f32 v107, v107
    v_exp_f32 v108, v108
    v_exp_f32 v109, v109
    s_nop 0
    v_exp_f32 v110, v110
    v_exp_f32 v111, v111
    s_setprio 1
    v_exp_f32 v112, v112
    v_exp_f32 v113, v113
    v_smfmac_f32_32x32x32_bf16 v[144:159], v[68:71], v[104:111], v246
    s_lshl_b32 s3, s78, 11
    s_add_u32 m0, s3, 135168
    s_lshl_b32 s3, s78, 14
    s_add_u32 s3, s3, 1310720
    buffer_load_dwordx4 v238, s[24:27], s3 offen lds
    v_exp_f32 v114, v114
    v_exp_f32 v115, v115
    v_exp_f32 v116, v116
    v_exp_f32 v117, v117
    v_mfma_f32_32x32x16_bf16 v[96:111], v[24:27], v[220:223], 0
    v_exp_f32 v118, v118
    v_exp_f32 v119, v119
    v_exp_f32 v120, v120
    v_exp_f32 v121, v121
    v_smfmac_f32_32x32x32_bf16 v[144:159], v[72:75], v[112:119], v246
    s_add_u32 s3, s78, 2
    s_and_b32 s3, s3, 7
    s_mul_i32 s3, s3, 2304
    s_add_u32 s3, s3, 98304
    v_add_u32 v226, s3, v225
    v_add_u32 v228, s3, v239
    v_exp_f32 v122, v122
    v_exp_f32 v123, v123
    v_exp_f32 v124, v124
    v_exp_f32 v125, v125
    s_nop 0
    v_exp_f32 v126, v126
    v_exp_f32 v127, v127
    s_setprio 0
    v_exp_f32 v96, v96
    v_exp_f32 v97, v97
    v_smfmac_f32_32x32x32_bf16 v[144:159], v[76:79], v[120:127], v246
    s_lshl_b32 s3, s78, 11
    s_add_u32 m0, s3, 136192
    s_lshl_b32 s3, s78, 14
    s_add_u32 s3, s3, 1318912
    buffer_load_dwordx4 v238, s[24:27], s3 offen lds
    v_exp_f32 v98, v98
    v_exp_f32 v99, v99
    v_exp_f32 v100, v100
    v_exp_f32 v101, v101
    v_mfma_f32_32x32x16_bf16 v[112:127], v[28:31], v[220:223], 0
    v_exp_f32 v102, v102
    v_exp_f32 v103, v103
    v_exp_f32 v104, v104
    v_exp_f32 v105, v105
    v_smfmac_f32_32x32x32_bf16 v[144:159], v[80:83], v[96:103], v246
    v_exp_f32 v106, v106
    v_exp_f32 v107, v107
    v_exp_f32 v108, v108
    v_exp_f32 v109, v109
    s_nop 0
    v_exp_f32 v110, v110
    v_exp_f32 v111, v111
    s_setprio 3
    v_exp_f32 v112, v112
    v_exp_f32 v113, v113
    v_smfmac_f32_32x32x32_bf16 v[144:159], v[84:87], v[104:111], v246
    s_waitcnt lgkmcnt(0)
    s_barrier
    v_exp_f32 v114, v114
    v_exp_f32 v115, v115
    v_exp_f32 v116, v116
    v_exp_f32 v117, v117
    v_mfma_f32_32x32x16_bf16 v[96:111], v[0:3], v[216:219], 0
    ds_read_b128 v[128:131], v226 offset:0
    v_exp_f32 v118, v118
    v_exp_f32 v119, v119
    v_exp_f32 v120, v120
    v_exp_f32 v121, v121
    v_smfmac_f32_32x32x32_bf16 v[144:159], v[88:91], v[112:119], v246
    s_lshl_b32 s3, s78, 12
    s_add_u32 m0, s3, 0
    s_lshl_b32 s3, s78, 15
    s_add_u32 s3, s3, 0
    buffer_load_dwordx4 v238, s[24:27], s3 offen lds
    ds_read_b128 v[132:135], v226 offset:1024
    v_exp_f32 v122, v122
    v_exp_f32 v123, v123
    v_exp_f32 v124, v124
    v_exp_f32 v125, v125
    s_nop 0
    ds_read_b32 v136, v228 offset:2048
    v_exp_f32 v126, v126
    v_exp_f32 v127, v127
    v_exp_f32 v96, v96
    v_exp_f32 v97, v97
    v_smfmac_f32_32x32x32_bf16 v[144:159], v[92:95], v[120:127], v246
    v_exp_f32 v98, v98
    v_exp_f32 v99, v99
    v_exp_f32 v100, v100
    v_exp_f32 v101, v101
    v_mfma_f32_32x32x16_bf16 v[112:127], v[4:7], v[216:219], 0
    v_exp_f32 v102, v102
    v_exp_f32 v103, v103
    v_exp_f32 v104, v104
    v_exp_f32 v105, v105
    s_waitcnt lgkmcnt(0)
    v_smfmac_f32_32x32x32_bf16 v[128:143], v[32:35], v[96:103], v246
    s_lshl_b32 s3, s78, 12
    s_add_u32 m0, s3, 1024
    s_lshl_b32 s3, s78, 15
    s_add_u32 s3, s3, 8192
    buffer_load_dwordx4 v238, s[24:27], s3 offen lds
    v_exp_f32 v106, v106
    v_exp_f32 v107, v107
    v_exp_f32 v108, v108
    v_exp_f32 v109, v109
    s_nop 0
    v_exp_f32 v110, v110
    v_exp_f32 v111, v111
    v_exp_f32 v112, v112
    v_exp_f32 v113, v113
    v_smfmac_f32_32x32x32_bf16 v[128:143], v[36:39], v[104:111], v246
    ds_write_b128 v227, v[144:147] offset:0
    v_exp_f32 v114, v114
    v_exp_f32 v115, v115
    v_exp_f32 v116, v116
    v_exp_f32 v117, v117
    v_mfma_f32_32x32x16_bf16 v[96:111], v[8:11], v[216:219], 0
    ds_write_b128 v227, v[148:151] offset:1024
    v_exp_f32 v118, v118
    v_exp_f32 v119, v119
    v_exp_f32 v120, v120
    v_exp_f32 v121, v121
    v_smfmac_f32_32x32x32_bf16 v[128:143], v[40:43], v[112:119], v246
    s_lshl_b32 s3, s78, 12
    s_add_u32 m0, s3, 2048
    s_lshl_b32 s3, s78, 15
    s_add_u32 s3, s3, 16384
    buffer_load_dwordx4 v238, s[24:27], s3 offen lds
    v_and_b32 v234, 0x3c, v224
    v_lshlrev_b32 v234, 5, v234
    v_and_b32 v249, 3, v224
    v_lshl_add_u32 v249, v249, 3, v234
    s_lshr_b32 s6, s85, 1
    s_lshl_b32 s6, s6, 11
    s_add_u32 s6, s6, 212992
    buffer_load_dwordx2 v[234:235], v249, s[20:23], s6 offen sc1
    v_and_b32 v250, 28, v239
    s_lshl_b32 s6, s79, 11
    s_add_u32 s6, s6, 214912
    buffer_load_dword v251, v250, s[20:23], s6 offen sc1
    v_exp_f32 v122, v122
    v_exp_f32 v123, v123
    v_exp_f32 v124, v124
    v_exp_f32 v125, v125
    s_nop 0
    ds_write_b32 v229, v152 offset:2048
    v_exp_f32 v126, v126
    v_exp_f32 v127, v127
    v_exp_f32 v96, v96
    v_exp_f32 v97, v97
    v_smfmac_f32_32x32x32_bf16 v[128:143], v[44:47], v[120:127], v246
    v_exp_f32 v98, v98
    v_exp_f32 v99, v99
    v_exp_f32 v100, v100
    v_exp_f32 v101, v101
    v_mfma_f32_32x32x16_bf16 v[112:127], v[12:15], v[216:219], 0
    v_exp_f32 v102, v102
    v_exp_f32 v103, v103
    v_exp_f32 v104, v104
    v_exp_f32 v105, v105
    v_smfmac_f32_32x32x32_bf16 v[128:143], v[48:51], v[96:103], v246
    s_lshl_b32 s3, s78, 12
    s_add_u32 m0, s3, 3072
    s_lshl_b32 s3, s78, 15
    s_add_u32 s3, s3, 24576
    buffer_load_dwordx4 v238, s[24:27], s3 offen lds
    v_exp_f32 v106, v106
    v_exp_f32 v107, v107
    v_exp_f32 v108, v108
    v_exp_f32 v109, v109
    s_nop 0
    v_exp_f32 v110, v110
    v_exp_f32 v111, v111
    s_setprio 2
    v_exp_f32 v112, v112
    v_exp_f32 v113, v113
    v_smfmac_f32_32x32x32_bf16 v[128:143], v[52:55], v[104:111], v246
    v_exp_f32 v114, v114
    v_exp_f32 v115, v115
    v_exp_f32 v116, v116
    v_exp_f32 v117, v117
    v_mfma_f32_32x32x16_bf16 v[96:111], v[16:19], v[216:219], 0
    v_exp_f32 v118, v118
    v_exp_f32 v119, v119
    v_exp_f32 v120, v120
    v_exp_f32 v121, v121
    v_smfmac_f32_32x32x32_bf16 v[128:143], v[56:59], v[112:119], v246
    v_exp_f32 v122, v122
    v_exp_f32 v123, v123
    v_exp_f32 v124, v124
    v_exp_f32 v125, v125
    s_nop 0
    v_exp_f32 v126, v126
    v_exp_f32 v127, v127
    v_exp_f32 v96, v96
    v_exp_f32 v97, v97
    v_smfmac_f32_32x32x32_bf16 v[128:143], v[60:63], v[120:127], v246
    s_waitcnt vmcnt(1)
    s_mov_b32 s92, 0
L_fh:
    v_cmp_eq_u32 vcc, s81, v234
    v_cmp_eq_u32 s[90:91], s81, v235
    s_and_b64 vcc, vcc, s[90:91]
    v_cmp_eq_u32 s[90:91], s81, v251
    s_and_b64 vcc, vcc, s[90:91]
    s_cmp_eq_u64 vcc, -1
    s_cbranch_scc1 L_fh_ok
    s_add_u32 s92, s92, 1
    s_cmp_gt_u32 s92, 0x100000
    s_cbranch_scc1 L_fh_ok
    s_sleep 4
    s_lshr_b32 s6, s85, 1
    s_lshl_b32 s6, s6, 11
    s_add_u32 s6, s6, 212992
    buffer_load_dwordx2 v[234:235], v249, s[20:23], s6 offen sc1
    s_lshl_b32 s6, s79, 11
    s_add_u32 s6, s6, 214912
    buffer_load_dword v251, v250, s[20:23], s6 offen sc1
    s_waitcnt vmcnt(0)
    s_branch L_fh
L_fh_ok:
    s_add_u32 s6, s78, 7
    s_bfe_u32 s6, s6, 0x20001
    s_lshl2_add_u32 s6, s79, s6
    s_lshl_b32 s6, s6, 7
    s_add_u32 s6, s6, 16384
    buffer_load_dword v250, v248, s[20:23], s6 offen sc1
    buffer_load_dword v248, v248, s[20:23], s40 offen sc1
    v_exp_f32 v98, v98
    v_exp_f32 v99, v99
    v_exp_f32 v100, v100
    v_exp_f32 v101, v101
    v_mfma_f32_32x32x16_bf16 v[112:127], v[20:23], v[216:219], 0
    v_exp_f32 v102, v102
    v_exp_f32 v103, v103
    v_exp_f32 v104, v104
    v_exp_f32 v105, v105
    v_smfmac_f32_32x32x32_bf16 v[128:143], v[64:67], v[96:103], v246
    s_add_u32 s3, s78, 3
    s_and_b32 s3, s3, 7
    s_lshl_b32 s3, s3, 10
    s_add_u32 s3, s3, 151552
    v_add_u32 v230, s3, v225
    ds_read_b128 v[220:223], v230
    v_exp_f32 v106, v106
    v_exp_f32 v107, v107
    v_exp_f32 v108, v108
    v_exp_f32 v109, v109
    s_nop 0
    s_add_u32 s3, s98, 32768
    buffer_load_dwordx4 v[192:195], v225, s[20:23], s3 offen sc1
    v_exp_f32 v110, v110
    v_exp_f32 v111, v111
    s_setprio 1
    v_exp_f32 v112, v112
    v_exp_f32 v113, v113
    v_smfmac_f32_32x32x32_bf16 v[128:143], v[68:71], v[104:111], v246
    v_exp_f32 v114, v114
    v_exp_f32 v115, v115
    v_exp_f32 v116, v116
    v_exp_f32 v117, v117
    v_mfma_f32_32x32x16_bf16 v[96:111], v[24:27], v[216:219], 0
    v_exp_f32 v118, v118
    v_exp_f32 v119, v119
    v_exp_f32 v120, v120
    v_exp_f32 v121, v121
    v_smfmac_f32_32x32x32_bf16 v[128:143], v[72:75], v[112:119], v246
    s_add_u32 s3, s78, 3
    s_and_b32 s3, s3, 7
    s_mul_i32 s3, s3, 2304
    s_add_u32 s3, s3, 116736
    v_add_u32 v227, s3, v225
    v_add_u32 v229, s3, v239
    v_exp_f32 v122, v122
    v_exp_f32 v123, v123
    v_exp_f32 v124, v124
    v_exp_f32 v125, v125
    s_nop 0
    s_add_u32 s3, s98, 36864
    buffer_load_dwordx4 v[196:199], v225, s[20:23], s3 offen sc1
    v_exp_f32 v126, v126
    v_exp_f32 v127, v127
    s_setprio 0
    v_exp_f32 v96, v96
    v_exp_f32 v97, v97
    v_smfmac_f32_32x32x32_bf16 v[128:143], v[76:79], v[120:127], v246
    v_exp_f32 v98, v98
    v_exp_f32 v99, v99
    v_exp_f32 v100, v100
    v_exp_f32 v101, v101
    v_mfma_f32_32x32x16_bf16 v[112:127], v[28:31], v[216:219], 0
    v_exp_f32 v102, v102
    v_exp_f32 v103, v103
    v_exp_f32 v104, v104
    v_exp_f32 v105, v105
    v_smfmac_f32_32x32x32_bf16 v[128:143], v[80:83], v[96:103], v246
    v_exp_f32 v106, v106
    v_exp_f32 v107, v107
    v_exp_f32 v108, v108
    v_exp_f32 v109, v109
    s_nop 0
    s_add_u32 s3, s98, 40960
    buffer_load_dwordx4 v[200:203], v225, s[20:23], s3 offen sc1
    v_exp_f32 v110, v110
    v_exp_f32 v111, v111
    s_setprio 3
    v_exp_f32 v112, v112
    v_exp_f32 v113, v113
    v_smfmac_f32_32x32x32_bf16 v[128:143], v[84:87], v[104:111], v246
    s_waitcnt vmcnt(5) lgkmcnt(0)
    s_barrier
    ds_read_b64_tr_b16 v[208:209], v240 offset:0
    v_exp_f32 v114, v114
    v_exp_f32 v115, v115
    v_exp_f32 v116, v116
    v_exp_f32 v117, v117
    v_mfma_f32_32x32x16_bf16 v[96:111], v[0:3], v[220:223], 0
    ds_read_b64_tr_b16 v[210:211], v240 offset:512
    ds_read_b128 v[144:147], v227 offset:0
    v_exp_f32 v118, v118
    v_exp_f32 v119, v119
    v_exp_f32 v120, v120
    v_exp_f32 v121, v121
    v_smfmac_f32_32x32x32_bf16 v[128:143], v[88:91], v[112:119], v246
    s_lshl_b32 s3, s78, 12
    s_add_u32 m0, s3, 32768
    s_lshl_b32 s3, s78, 15
    s_add_u32 s3, s3, 262144
    buffer_load_dwordx4 v238, s[24:27], s3 offen lds
    ds_read_b128 v[148:151], v227 offset:1024
    v_exp_f32 v122, v122
    v_exp_f32 v123, v123
    v_exp_f32 v124, v124
    v_exp_f32 v125, v125
    s_nop 0
    s_add_u32 s3, s98, 45056
    buffer_load_dwordx4 v[204:207], v225, s[20:23], s3 offen sc1
    ds_read_b32 v152, v229 offset:2048
    v_exp_f32 v126, v126
    v_exp_f32 v127, v127
    v_exp_f32 v96, v96
    v_exp_f32 v97, v97
    v_smfmac_f32_32x32x32_bf16 v[128:143], v[92:95], v[120:127], v246
    ds_read_b64_tr_b16 v[212:213], v241 offset:0
    v_exp_f32 v98, v98
    v_exp_f32 v99, v99
    v_exp_f32 v100, v100
    v_exp_f32 v101, v101
    v_mfma_f32_32x32x16_bf16 v[112:127], v[4:7], v[220:223], 0
    ds_read_b64_tr_b16 v[214:215], v241 offset:512
    v_exp_f32 v102, v102
    v_exp_f32 v103, v103
    v_exp_f32 v104, v104
    v_exp_f32 v105, v105
    s_waitcnt lgkmcnt(2)
    v_smfmac_f32_32x32x32_bf16 v[144:159], v[32:35], v[96:103], v246
    s_lshl_b32 s3, s78, 12
    s_add_u32 m0, s3, 33792
    s_lshl_b32 s3, s78, 15
    s_add_u32 s3, s3, 270336
    buffer_load_dwordx4 v238, s[24:27], s3 offen lds
    v_exp_f32 v106, v106
    v_exp_f32 v107, v107
    v_exp_f32 v108, v108
    v_exp_f32 v109, v109
    s_waitcnt vmcnt(5)
    v_mfma_f32_32x32x16_bf16 v[160:175], v[208:211], v[192:195], 0
    v_exp_f32 v110, v110
    v_exp_f32 v111, v111
    v_exp_f32 v112, v112
    v_exp_f32 v113, v113
    v_smfmac_f32_32x32x32_bf16 v[144:159], v[36:39], v[104:111], v246
    ds_read_b64_tr_b16 v[208:209], v240 offset:8192
    ds_write_b128 v226, v[128:131] offset:0
    v_exp_f32 v114, v114
    v_exp_f32 v115, v115
    v_exp_f32 v116, v116
    v_exp_f32 v117, v117
    v_mfma_f32_32x32x16_bf16 v[96:111], v[8:11], v[220:223], 0
    ds_read_b64_tr_b16 v[210:211], v240 offset:8704
    ds_write_b128 v226, v[132:135] offset:1024
    v_exp_f32 v118, v118
    v_exp_f32 v119, v119
    v_exp_f32 v120, v120
    v_exp_f32 v121, v121
    v_smfmac_f32_32x32x32_bf16 v[144:159], v[40:43], v[112:119], v246
    s_lshl_b32 s3, s78, 12
    s_add_u32 m0, s3, 34816
    s_lshl_b32 s3, s78, 15
    s_add_u32 s3, s3, 278528
    buffer_load_dwordx4 v238, s[24:27], s3 offen lds
    v_exp_f32 v122, v122
    v_exp_f32 v123, v123
    v_exp_f32 v124, v124
    v_exp_f32 v125, v125
    s_waitcnt lgkmcnt(4)
    v_mfma_f32_32x32x16_bf16 v[176:191], v[212:215], v[192:195], 0
    s_add_u32 s3, s98, 49152
    buffer_load_dwordx4 v[192:195], v225, s[20:23], s3 offen sc1
    ds_write_b32 v228, v136 offset:2048
    v_exp_f32 v126, v126
    v_exp_f32 v127, v127
    v_exp_f32 v96, v96
    v_exp_f32 v97, v97
    v_smfmac_f32_32x32x32_bf16 v[144:159], v[44:47], v[120:127], v246
    ds_read_b64_tr_b16 v[212:213], v241 offset:8192
    v_exp_f32 v98, v98
    v_exp_f32 v99, v99
    v_exp_f32 v100, v100
    v_exp_f32 v101, v101
    v_mfma_f32_32x32x16_bf16 v[112:127], v[12:15], v[220:223], 0
    ds_read_b64_tr_b16 v[214:215], v241 offset:8704
    v_exp_f32 v102, v102
    v_exp_f32 v103, v103
    v_exp_f32 v104, v104
    v_exp_f32 v105, v105
    v_smfmac_f32_32x32x32_bf16 v[144:159], v[48:51], v[96:103], v246
    s_lshl_b32 s3, s78, 12
    s_add_u32 m0, s3, 35840
    s_lshl_b32 s3, s78, 15
    s_add_u32 s3, s3, 286720
    buffer_load_dwordx4 v238, s[24:27], s3 offen lds
    v_exp_f32 v106, v106
    v_exp_f32 v107, v107
    v_exp_f32 v108, v108
    v_exp_f32 v109, v109
    s_waitcnt lgkmcnt(4)
    s_waitcnt vmcnt(7)
    v_mfma_f32_32x32x16_bf16 v[160:175], v[208:211], v[196:199], v[160:175]
    v_exp_f32 v110, v110
    v_exp_f32 v111, v111
    s_setprio 2
    v_exp_f32 v112, v112
    v_exp_f32 v113, v113
    v_smfmac_f32_32x32x32_bf16 v[144:159], v[52:55], v[104:111], v246
    ds_read_b64_tr_b16 v[208:209], v240 offset:16384
    v_exp_f32 v114, v114
    v_exp_f32 v115, v115
    v_exp_f32 v116, v116
    v_exp_f32 v117, v117
    v_mfma_f32_32x32x16_bf16 v[96:111], v[16:19], v[220:223], 0
    ds_read_b64_tr_b16 v[210:211], v240 offset:16896
    v_exp_f32 v118, v118
    v_exp_f32 v119, v119
    v_exp_f32 v120, v120
    v_exp_f32 v121, v121
    v_smfmac_f32_32x32x32_bf16 v[144:159], v[56:59], v[112:119], v246
    v_exp_f32 v122, v122
    v_exp_f32 v123, v123
    v_exp_f32 v124, v124
    v_exp_f32 v125, v125
    s_waitcnt lgkmcnt(2)
    v_mfma_f32_32x32x16_bf16 v[176:191], v[212:215], v[196:199], v[176:191]
    s_add_u32 s3, s98, 53248
    buffer_load_dwordx4 v[196:199], v225, s[20:23], s3 offen sc1
    v_exp_f32 v126, v126
    v_exp_f32 v127, v127
    v_exp_f32 v96, v96
    v_exp_f32 v97, v97
    v_smfmac_f32_32x32x32_bf16 v[144:159], v[60:63], v[120:127], v246
    ds_read_b64_tr_b16 v[212:213], v241 offset:16384
    v_exp_f32 v98, v98
    v_exp_f32 v99, v99
    v_exp_f32 v100, v100
    v_exp_f32 v101, v101
    v_mfma_f32_32x32x16_bf16 v[112:127], v[20:23], v[220:223], 0
    ds_read_b64_tr_b16 v[214:215], v241 offset:16896
    v_exp_f32 v102, v102
    v_exp_f32 v103, v103
    v_exp_f32 v104, v104
    v_exp_f32 v105, v105
    v_smfmac_f32_32x32x32_bf16 v[144:159], v[64:67], v[96:103], v246
    s_add_u32 s3, s78, 4
    s_and_b32 s3, s3, 7
    s_lshl_b32 s3, s3, 10
    s_add_u32 s3, s3, 151552
    v_add_u32 v230, s3, v225
    ds_read_b128 v[216:219], v230
    v_exp_f32 v106, v106
    v_exp_f32 v107, v107
    v_exp_f32 v108, v108
    v_exp_f32 v109, v109
    s_waitcnt lgkmcnt(3)
    s_waitcnt vmcnt(7)
    v_mfma_f32_32x32x16_bf16 v[160:175], v[208:211], v[200:203], v[160:175]
    v_exp_f32 v110, v110
    v_exp_f32 v111, v111
    s_setprio 1
    v_exp_f32 v112, v112
    v_exp_f32 v113, v113
    v_smfmac_f32_32x32x32_bf16 v[144:159], v[68:71], v[104:111], v246
    ds_read_b64_tr_b16 v[208:209], v240 offset:24576
    v_exp_f32 v114, v114
    v_exp_f32 v115, v115
    v_exp_f32 v116, v116
    v_exp_f32 v117, v117
    v_mfma_f32_32x32x16_bf16 v[96:111], v[24:27], v[220:223], 0
    ds_read_b64_tr_b16 v[210:211], v240 offset:25088
    v_exp_f32 v118, v118
    v_exp_f32 v119, v119
    v_exp_f32 v120, v120
    v_exp_f32 v121, v121
    v_smfmac_f32_32x32x32_bf16 v[144:159], v[72:75], v[112:119], v246
    s_add_u32 s3, s78, 4
    s_and_b32 s3, s3, 7
    s_mul_i32 s3, s3, 2304
    s_add_u32 s3, s3, 98304
    v_add_u32 v226, s3, v225
    v_add_u32 v228, s3, v239
    v_exp_f32 v122, v122
    v_exp_f32 v123, v123
    v_exp_f32 v124, v124
    v_exp_f32 v125, v125
    s_waitcnt lgkmcnt(3)
    v_mfma_f32_32x32x16_bf16 v[176:191], v[212:215], v[200:203], v[176:191]
    s_add_u32 s3, s98, 57344
    buffer_load_dwordx4 v[200:203], v225, s[20:23], s3 offen sc1
    v_exp_f32 v126, v126
    v_exp_f32 v127, v127
    s_setprio 0
    v_exp_f32 v96, v96
    v_exp_f32 v97, v97
    v_smfmac_f32_32x32x32_bf16 v[144:159], v[76:79], v[120:127], v246
    ds_read_b64_tr_b16 v[212:213], v241 offset:24576
    v_exp_f32 v98, v98
    v_exp_f32 v99, v99
    v_exp_f32 v100, v100
    v_exp_f32 v101, v101
    v_mfma_f32_32x32x16_bf16 v[112:127], v[28:31], v[220:223], 0
    ds_read_b64_tr_b16 v[214:215], v241 offset:25088
    v_exp_f32 v102, v102
    v_exp_f32 v103, v103
    v_exp_f32 v104, v104
    v_exp_f32 v105, v105
    v_smfmac_f32_32x32x32_bf16 v[144:159], v[80:83], v[96:103], v246
    v_exp_f32 v106, v106
    v_exp_f32 v107, v107
    v_exp_f32 v108, v108
    v_exp_f32 v109, v109
    s_waitcnt lgkmcnt(2)
    s_waitcnt vmcnt(6)
    v_mfma_f32_32x32x16_bf16 v[160:175], v[208:211], v[204:207], v[160:175]
    v_exp_f32 v110, v110
    v_exp_f32 v111, v111
    s_setprio 3
    v_exp_f32 v112, v112
    v_exp_f32 v113, v113
    v_smfmac_f32_32x32x32_bf16 v[144:159], v[84:87], v[104:111], v246
    s_waitcnt vmcnt(2) lgkmcnt(0)
    s_barrier
    ds_read_b64_tr_b16 v[208:209], v240 offset:32768
    v_exp_f32 v114, v114
    v_exp_f32 v115, v115
    v_exp_f32 v116, v116
    v_exp_f32 v117, v117
    v_mfma_f32_32x32x16_bf16 v[96:111], v[0:3], v[216:219], 0
    ds_read_b64_tr_b16 v[210:211], v240 offset:33280
    ds_read_b128 v[128:131], v226 offset:0
    v_exp_f32 v118, v118
    v_exp_f32 v119, v119
    v_exp_f32 v120, v120
    v_exp_f32 v121, v121
    v_smfmac_f32_32x32x32_bf16 v[144:159], v[88:91], v[112:119], v246
    s_lshl_b32 s3, s78, 12
    s_add_u32 m0, s3, 0
    s_lshl_b32 s3, s78, 15
    s_add_u32 s3, s3, 524288
    buffer_load_dwordx4 v238, s[24:27], s3 offen lds
    ds_read_b128 v[132:135], v226 offset:1024
    v_exp_f32 v122, v122
    v_exp_f32 v123, v123
    v_exp_f32 v124, v124
    v_exp_f32 v125, v125
    v_mfma_f32_32x32x16_bf16 v[176:191], v[212:215], v[204:207], v[176:191]
    s_add_u32 s3, s98, 61440
    buffer_load_dwordx4 v[204:207], v225, s[20:23], s3 offen sc1
    ds_read_b32 v136, v228 offset:2048
    v_exp_f32 v126, v126
    v_exp_f32 v127, v127
    v_exp_f32 v96, v96
    v_exp_f32 v97, v97
    v_smfmac_f32_32x32x32_bf16 v[144:159], v[92:95], v[120:127], v246
    ds_read_b64_tr_b16 v[212:213], v241 offset:32768
    v_exp_f32 v98, v98
    v_exp_f32 v99, v99
    v_exp_f32 v100, v100
    v_exp_f32 v101, v101
    v_mfma_f32_32x32x16_bf16 v[112:127], v[4:7], v[216:219], 0
    ds_read_b64_tr_b16 v[214:215], v241 offset:33280
    v_exp_f32 v102, v102
    v_exp_f32 v103, v103
    v_exp_f32 v104, v104
    v_exp_f32 v105, v105
    s_waitcnt lgkmcnt(2)
    v_smfmac_f32_32x32x32_bf16 v[128:143], v[32:35], v[96:103], v246
    s_lshl_b32 s3, s78, 12
    s_add_u32 m0, s3, 1024
    s_lshl_b32 s3, s78, 15
    s_add_u32 s3, s3, 532480
    buffer_load_dwordx4 v238, s[24:27], s3 offen lds
    v_exp_f32 v106, v106
    v_exp_f32 v107, v107
    v_exp_f32 v108, v108
    v_exp_f32 v109, v109
    v_mfma_f32_32x32x16_bf16 v[160:175], v[208:211], v[192:195], v[160:175]
    v_exp_f32 v110, v110
    v_exp_f32 v111, v111
    v_exp_f32 v112, v112
    v_exp_f32 v113, v113
    v_smfmac_f32_32x32x32_bf16 v[128:143], v[36:39], v[104:111], v246
    ds_read_b64_tr_b16 v[208:209], v240 offset:40960
    ds_write_b128 v227, v[144:147] offset:0
    v_exp_f32 v114, v114
    v_exp_f32 v115, v115
    v_exp_f32 v116, v116
    v_exp_f32 v117, v117
    v_mfma_f32_32x32x16_bf16 v[96:111], v[8:11], v[216:219], 0
    ds_read_b64_tr_b16 v[210:211], v240 offset:41472
    ds_write_b128 v227, v[148:151] offset:1024
    v_exp_f32 v118, v118
    v_exp_f32 v119, v119
    v_exp_f32 v120, v120
    v_exp_f32 v121, v121
    v_smfmac_f32_32x32x32_bf16 v[128:143], v[40:43], v[112:119], v246
    s_lshl_b32 s3, s78, 12
    s_add_u32 m0, s3, 2048
    s_lshl_b32 s3, s78, 15
    s_add_u32 s3, s3, 540672
    buffer_load_dwordx4 v238, s[24:27], s3 offen lds
    v_exp_f32 v122, v122
    v_exp_f32 v123, v123
    v_exp_f32 v124, v124
    v_exp_f32 v125, v125
    s_waitcnt lgkmcnt(4)
    v_mfma_f32_32x32x16_bf16 v[176:191], v[212:215], v[192:195], v[176:191]
    s_add_u32 s3, s98, 65536
    buffer_load_dwordx4 v[192:195], v225, s[20:23], s3 offen sc1
    ds_write_b32 v229, v152 offset:2048
    v_exp_f32 v126, v126
    v_exp_f32 v127, v127
    v_exp_f32 v96, v96
    v_exp_f32 v97, v97
    v_smfmac_f32_32x32x32_bf16 v[128:143], v[44:47], v[120:127], v246
    ds_read_b64_tr_b16 v[212:213], v241 offset:40960
    v_exp_f32 v98, v98
    v_exp_f32 v99, v99
    v_exp_f32 v100, v100
    v_exp_f32 v101, v101
    v_mfma_f32_32x32x16_bf16 v[112:127], v[12:15], v[216:219], 0
    ds_read_b64_tr_b16 v[214:215], v241 offset:41472
    v_exp_f32 v102, v102
    v_exp_f32 v103, v103
    v_exp_f32 v104, v104
    v_exp_f32 v105, v105
    v_smfmac_f32_32x32x32_bf16 v[128:143], v[48:51], v[96:103], v246
    s_lshl_b32 s3, s78, 12
    s_add_u32 m0, s3, 3072
    s_lshl_b32 s3, s78, 15
    s_add_u32 s3, s3, 548864
    buffer_load_dwordx4 v238, s[24:27], s3 offen lds
    v_exp_f32 v106, v106
    v_exp_f32 v107, v107
    v_exp_f32 v108, v108
    v_exp_f32 v109, v109
    s_waitcnt lgkmcnt(4)
    s_waitcnt vmcnt(7)
    v_mfma_f32_32x32x16_bf16 v[160:175], v[208:211], v[196:199], v[160:175]
    v_exp_f32 v110, v110
    v_exp_f32 v111, v111
    s_setprio 2
    v_exp_f32 v112, v112
    v_exp_f32 v113, v113
    v_smfmac_f32_32x32x32_bf16 v[128:143], v[52:55], v[104:111], v246
    ds_read_b64_tr_b16 v[208:209], v240 offset:49152
    v_exp_f32 v114, v114
    v_exp_f32 v115, v115
    v_exp_f32 v116, v116
    v_exp_f32 v117, v117
    v_mfma_f32_32x32x16_bf16 v[96:111], v[16:19], v[216:219], 0
    ds_read_b64_tr_b16 v[210:211], v240 offset:49664
    v_exp_f32 v118, v118
    v_exp_f32 v119, v119
    v_exp_f32 v120, v120
    v_exp_f32 v121, v121
    v_smfmac_f32_32x32x32_bf16 v[128:143], v[56:59], v[112:119], v246
    v_exp_f32 v122, v122
    v_exp_f32 v123, v123
    v_exp_f32 v124, v124
    v_exp_f32 v125, v125
    s_waitcnt lgkmcnt(2)
    v_mfma_f32_32x32x16_bf16 v[176:191], v[212:215], v[196:199], v[176:191]
    s_add_u32 s3, s98, 69632
    buffer_load_dwordx4 v[196:199], v225, s[20:23], s3 offen sc1
    v_exp_f32 v126, v126
    v_exp_f32 v127, v127
    v_exp_f32 v96, v96
    v_exp_f32 v97, v97
    v_smfmac_f32_32x32x32_bf16 v[128:143], v[60:63], v[120:127], v246
    ds_read_b64_tr_b16 v[212:213], v241 offset:49152
    v_exp_f32 v98, v98
    v_exp_f32 v99, v99
    v_exp_f32 v100, v100
    v_exp_f32 v101, v101
    v_mfma_f32_32x32x16_bf16 v[112:127], v[20:23], v[216:219], 0
    ds_read_b64_tr_b16 v[214:215], v241 offset:49664
    v_exp_f32 v102, v102
    v_exp_f32 v103, v103
    v_exp_f32 v104, v104
    v_exp_f32 v105, v105
    v_smfmac_f32_32x32x32_bf16 v[128:143], v[64:67], v[96:103], v246
    s_add_u32 s3, s78, 5
    s_and_b32 s3, s3, 7
    s_lshl_b32 s3, s3, 10
    s_add_u32 s3, s3, 151552
    v_add_u32 v230, s3, v225
    ds_read_b128 v[220:223], v230
    v_exp_f32 v106, v106
    v_exp_f32 v107, v107
    v_exp_f32 v108, v108
    v_exp_f32 v109, v109
    s_waitcnt lgkmcnt(3)
    s_waitcnt vmcnt(7)
    v_mfma_f32_32x32x16_bf16 v[160:175], v[208:211], v[200:203], v[160:175]
    v_exp_f32 v110, v110
    v_exp_f32 v111, v111
    s_setprio 1
    v_exp_f32 v112, v112
    v_exp_f32 v113, v113
    v_smfmac_f32_32x32x32_bf16 v[128:143], v[68:71], v[104:111], v246
    ds_read_b64_tr_b16 v[208:209], v240 offset:57344
    v_exp_f32 v114, v114
    v_exp_f32 v115, v115
    v_exp_f32 v116, v116
    v_exp_f32 v117, v117
    v_mfma_f32_32x32x16_bf16 v[96:111], v[24:27], v[216:219], 0
    ds_read_b64_tr_b16 v[210:211], v240 offset:57856
    v_exp_f32 v118, v118
    v_exp_f32 v119, v119
    v_exp_f32 v120, v120
    v_exp_f32 v121, v121
    v_smfmac_f32_32x32x32_bf16 v[128:143], v[72:75], v[112:119], v246
    s_add_u32 s3, s78, 5
    s_and_b32 s3, s3, 7
    s_mul_i32 s3, s3, 2304
    s_add_u32 s3, s3, 116736
    v_add_u32 v227, s3, v225
    v_add_u32 v229, s3, v239
    v_exp_f32 v122, v122
    v_exp_f32 v123, v123
    v_exp_f32 v124, v124
    v_exp_f32 v125, v125
    s_waitcnt lgkmcnt(3)
    v_mfma_f32_32x32x16_bf16 v[176:191], v[212:215], v[200:203], v[176:191]
    s_add_u32 s3, s98, 73728
    buffer_load_dwordx4 v[200:203], v225, s[20:23], s3 offen sc1
    v_exp_f32 v126, v126
    v_exp_f32 v127, v127
    s_setprio 0
    v_exp_f32 v96, v96
    v_exp_f32 v97, v97
    v_smfmac_f32_32x32x32_bf16 v[128:143], v[76:79], v[120:127], v246
    ds_read_b64_tr_b16 v[212:213], v241 offset:57344
    v_exp_f32 v98, v98
    v_exp_f32 v99, v99
    v_exp_f32 v100, v100
    v_exp_f32 v101, v101
    v_mfma_f32_32x32x16_bf16 v[112:127], v[28:31], v[216:219], 0
    ds_read_b64_tr_b16 v[214:215], v241 offset:57856
    v_exp_f32 v102, v102
    v_exp_f32 v103, v103
    v_exp_f32 v104, v104
    v_exp_f32 v105, v105
    v_smfmac_f32_32x32x32_bf16 v[128:143], v[80:83], v[96:103], v246
    v_exp_f32 v106, v106
    v_exp_f32 v107, v107
    v_exp_f32 v108, v108
    v_exp_f32 v109, v109
    s_waitcnt lgkmcnt(2)
    s_waitcnt vmcnt(6)
    v_mfma_f32_32x32x16_bf16 v[160:175], v[208:211], v[204:207], v[160:175]
    v_exp_f32 v110, v110
    v_exp_f32 v111, v111
    s_setprio 3
    v_exp_f32 v112, v112
    v_exp_f32 v113, v113
    v_smfmac_f32_32x32x32_bf16 v[128:143], v[84:87], v[104:111], v246
    s_waitcnt vmcnt(2) lgkmcnt(0)
    s_barrier
    ds_read_b64_tr_b16 v[208:209], v240 offset:0
    v_exp_f32 v114, v114
    v_exp_f32 v115, v115
    v_exp_f32 v116, v116
    v_exp_f32 v117, v117
    v_mfma_f32_32x32x16_bf16 v[96:111], v[0:3], v[220:223], 0
    ds_read_b64_tr_b16 v[210:211], v240 offset:512
    ds_read_b128 v[144:147], v227 offset:0
    v_exp_f32 v118, v118
    v_exp_f32 v119, v119
    v_exp_f32 v120, v120
    v_exp_f32 v121, v121
    v_smfmac_f32_32x32x32_bf16 v[128:143], v[88:91], v[112:119], v246
    s_lshl_b32 s3, s78, 12
    s_add_u32 m0, s3, 32768
    s_lshl_b32 s3, s78, 15
    s_add_u32 s3, s3, 786432
    buffer_load_dwordx4 v238, s[24:27], s3 offen lds
    ds_read_b128 v[148:151], v227 offset:1024
    v_exp_f32 v122, v122
    v_exp_f32 v123, v123
    v_exp_f32 v124, v124
    v_exp_f32 v125, v125
    v_mfma_f32_32x32x16_bf16 v[176:191], v[212:215], v[204:207], v[176:191]
    s_add_u32 s3, s98, 77824
    buffer_load_dwordx4 v[204:207], v225, s[20:23], s3 offen sc1
    ds_read_b32 v152, v229 offset:2048
    v_exp_f32 v126, v126
    v_exp_f32 v127, v127
    v_exp_f32 v96, v96
    v_exp_f32 v97, v97
    v_smfmac_f32_32x32x32_bf16 v[128:143], v[92:95], v[120:127], v246
    ds_read_b64_tr_b16 v[212:213], v241 offset:0
    v_exp_f32 v98, v98
    v_exp_f32 v99, v99
    v_exp_f32 v100, v100
    v_exp_f32 v101, v101
    v_mfma_f32_32x32x16_bf16 v[112:127], v[4:7], v[220:223], 0
    ds_read_b64_tr_b16 v[214:215], v241 offset:512
    v_exp_f32 v102, v102
    v_exp_f32 v103, v103
    v_exp_f32 v104, v104
    v_exp_f32 v105, v105
    s_waitcnt lgkmcnt(2)
    v_smfmac_f32_32x32x32_bf16 v[144:159], v[32:35], v[96:103], v246
    s_lshl_b32 s3, s78, 12
    s_add_u32 m0, s3, 33792
    s_lshl_b32 s3, s78, 15
    s_add_u32 s3, s3, 794624
    buffer_load_dwordx4 v238, s[24:27], s3 offen lds
    v_exp_f32 v106, v106
    v_exp_f32 v107, v107
    v_exp_f32 v108, v108
    v_exp_f32 v109, v109
    v_mfma_f32_32x32x16_bf16 v[160:175], v[208:211], v[192:195], v[160:175]
    v_exp_f32 v110, v110
    v_exp_f32 v111, v111
    v_exp_f32 v112, v112
    v_exp_f32 v113, v113
    v_smfmac_f32_32x32x32_bf16 v[144:159], v[36:39], v[104:111], v246
    ds_read_b64_tr_b16 v[208:209], v240 offset:8192
    ds_write_b128 v226, v[128:131] offset:0
    v_exp_f32 v114, v114
    v_exp_f32 v115, v115
    v_exp_f32 v116, v116
    v_exp_f32 v117, v117
    v_mfma_f32_32x32x16_bf16 v[96:111], v[8:11], v[220:223], 0
    ds_read_b64_tr_b16 v[210:211], v240 offset:8704
    ds_write_b128 v226, v[132:135] offset:1024
    v_exp_f32 v118, v118
    v_exp_f32 v119, v119
    v_exp_f32 v120, v120
    v_exp_f32 v121, v121
    v_smfmac_f32_32x32x32_bf16 v[144:159], v[40:43], v[112:119], v246
    s_lshl_b32 s3, s78, 12
    s_add_u32 m0, s3, 34816
    s_lshl_b32 s3, s78, 15
    s_add_u32 s3, s3, 802816
    buffer_load_dwordx4 v238, s[24:27], s3 offen lds
    v_exp_f32 v122, v122
    v_exp_f32 v123, v123
    v_exp_f32 v124, v124
    v_exp_f32 v125, v125
    s_waitcnt lgkmcnt(4)
    v_mfma_f32_32x32x16_bf16 v[176:191], v[212:215], v[192:195], v[176:191]
    s_add_u32 s3, s98, 81920
    buffer_load_dwordx4 v[192:195], v225, s[20:23], s3 offen sc1
    ds_write_b32 v228, v136 offset:2048
    v_exp_f32 v126, v126
    v_exp_f32 v127, v127
    v_exp_f32 v96, v96
    v_exp_f32 v97, v97
    v_smfmac_f32_32x32x32_bf16 v[144:159], v[44:47], v[120:127], v246
    ds_read_b64_tr_b16 v[212:213], v241 offset:8192
    v_exp_f32 v98, v98
    v_exp_f32 v99, v99
    v_exp_f32 v100, v100
    v_exp_f32 v101, v101
    v_mfma_f32_32x32x16_bf16 v[112:127], v[12:15], v[220:223], 0
    ds_read_b64_tr_b16 v[214:215], v241 offset:8704
    v_exp_f32 v102, v102
    v_exp_f32 v103, v103
    v_exp_f32 v104, v104
    v_exp_f32 v105, v105
    v_smfmac_f32_32x32x32_bf16 v[144:159], v[48:51], v[96:103], v246
    s_lshl_b32 s3, s78, 12
    s_add_u32 m0, s3, 35840
    s_lshl_b32 s3, s78, 15
    s_add_u32 s3, s3, 811008
    buffer_load_dwordx4 v238, s[24:27], s3 offen lds
    v_exp_f32 v106, v106
    v_exp_f32 v107, v107
    v_exp_f32 v108, v108
    v_exp_f32 v109, v109
    s_waitcnt lgkmcnt(4)
    s_waitcnt vmcnt(7)
    v_mfma_f32_32x32x16_bf16 v[160:175], v[208:211], v[196:199], v[160:175]
    v_exp_f32 v110, v110
    v_exp_f32 v111, v111
    s_setprio 2
    v_exp_f32 v112, v112
    v_exp_f32 v113, v113
    v_smfmac_f32_32x32x32_bf16 v[144:159], v[52:55], v[104:111], v246
    ds_read_b64_tr_b16 v[208:209], v240 offset:16384
    v_exp_f32 v114, v114
    v_exp_f32 v115, v115
    v_exp_f32 v116, v116
    v_exp_f32 v117, v117
    v_mfma_f32_32x32x16_bf16 v[96:111], v[16:19], v[220:223], 0
    ds_read_b64_tr_b16 v[210:211], v240 offset:16896
    v_exp_f32 v118, v118
    v_exp_f32 v119, v119
    v_exp_f32 v120, v120
    v_exp_f32 v121, v121
    v_smfmac_f32_32x32x32_bf16 v[144:159], v[56:59], v[112:119], v246
    v_exp_f32 v122, v122
    v_exp_f32 v123, v123
    v_exp_f32 v124, v124
    v_exp_f32 v125, v125
    s_waitcnt lgkmcnt(2)
    v_mfma_f32_32x32x16_bf16 v[176:191], v[212:215], v[196:199], v[176:191]
    s_add_u32 s3, s98, 86016
    buffer_load_dwordx4 v[196:199], v225, s[20:23], s3 offen sc1
    v_exp_f32 v126, v126
    v_exp_f32 v127, v127
    v_exp_f32 v96, v96
    v_exp_f32 v97, v97
    v_smfmac_f32_32x32x32_bf16 v[144:159], v[60:63], v[120:127], v246
    ds_read_b64_tr_b16 v[212:213], v241 offset:16384
    v_exp_f32 v98, v98
    v_exp_f32 v99, v99
    v_exp_f32 v100, v100
    v_exp_f32 v101, v101
    v_mfma_f32_32x32x16_bf16 v[112:127], v[20:23], v[220:223], 0
    ds_read_b64_tr_b16 v[214:215], v241 offset:16896
    v_exp_f32 v102, v102
    v_exp_f32 v103, v103
    v_exp_f32 v104, v104
    v_exp_f32 v105, v105
    v_smfmac_f32_32x32x32_bf16 v[144:159], v[64:67], v[96:103], v246
    s_add_u32 s3, s78, 6
    s_and_b32 s3, s3, 7
    s_lshl_b32 s3, s3, 10
    s_add_u32 s3, s3, 151552
    v_add_u32 v230, s3, v225
    ds_read_b128 v[216:219], v230
    v_exp_f32 v106, v106
    v_exp_f32 v107, v107
    v_exp_f32 v108, v108
    v_exp_f32 v109, v109
    s_waitcnt lgkmcnt(3)
    s_waitcnt vmcnt(7)
    v_mfma_f32_32x32x16_bf16 v[160:175], v[208:211], v[200:203], v[160:175]
    v_exp_f32 v110, v110
    v_exp_f32 v111, v111
    s_setprio 1
    v_exp_f32 v112, v112
    v_exp_f32 v113, v113
    v_smfmac_f32_32x32x32_bf16 v[144:159], v[68:71], v[104:111], v246
    ds_read_b64_tr_b16 v[208:209], v240 offset:24576
    v_exp_f32 v114, v114
    v_exp_f32 v115, v115
    v_exp_f32 v116, v116
    v_exp_f32 v117, v117
    v_mfma_f32_32x32x16_bf16 v[96:111], v[24:27], v[220:223], 0
    ds_read_b64_tr_b16 v[210:211], v240 offset:25088
    v_exp_f32 v118, v118
    v_exp_f32 v119, v119
    v_exp_f32 v120, v120
    v_exp_f32 v121, v121
    v_smfmac_f32_32x32x32_bf16 v[144:159], v[72:75], v[112:119], v246
    s_add_u32 s3, s78, 6
    s_and_b32 s3, s3, 7
    s_mul_i32 s3, s3, 2304
    s_add_u32 s3, s3, 98304
    v_add_u32 v226, s3, v225
    v_add_u32 v228, s3, v239
    v_exp_f32 v122, v122
    v_exp_f32 v123, v123
    v_exp_f32 v124, v124
    v_exp_f32 v125, v125
    s_waitcnt lgkmcnt(3)
    v_mfma_f32_32x32x16_bf16 v[176:191], v[212:215], v[200:203], v[176:191]
    s_add_u32 s3, s98, 90112
    buffer_load_dwordx4 v[200:203], v225, s[20:23], s3 offen sc1
    v_exp_f32 v126, v126
    v_exp_f32 v127, v127
    s_setprio 0
    v_exp_f32 v96, v96
    v_exp_f32 v97, v97
    v_smfmac_f32_32x32x32_bf16 v[144:159], v[76:79], v[120:127], v246
    ds_read_b64_tr_b16 v[212:213], v241 offset:24576
    v_exp_f32 v98, v98
    v_exp_f32 v99, v99
    v_exp_f32 v100, v100
    v_exp_f32 v101, v101
    v_mfma_f32_32x32x16_bf16 v[112:127], v[28:31], v[220:223], 0
    ds_read_b64_tr_b16 v[214:215], v241 offset:25088
    v_exp_f32 v102, v102
    v_exp_f32 v103, v103
    v_exp_f32 v104, v104
    v_exp_f32 v105, v105
    v_smfmac_f32_32x32x32_bf16 v[144:159], v[80:83], v[96:103], v246
    v_exp_f32 v106, v106
    v_exp_f32 v107, v107
    v_exp_f32 v108, v108
    v_exp_f32 v109, v109
    s_waitcnt lgkmcnt(2)
    s_waitcnt vmcnt(6)
    v_mfma_f32_32x32x16_bf16 v[160:175], v[208:211], v[204:207], v[160:175]
    v_exp_f32 v110, v110
    v_exp_f32 v111, v111
    s_setprio 3
    v_exp_f32 v112, v112
    v_exp_f32 v113, v113
    v_smfmac_f32_32x32x32_bf16 v[144:159], v[84:87], v[104:111], v246
    s_waitcnt vmcnt(2) lgkmcnt(0)
    s_barrier
    ds_read_b64_tr_b16 v[208:209], v240 offset:32768
    v_exp_f32 v114, v114
    v_exp_f32 v115, v115
    v_exp_f32 v116, v116
    v_exp_f32 v117, v117
    v_mfma_f32_32x32x16_bf16 v[96:111], v[0:3], v[216:219], 0
    ds_read_b64_tr_b16 v[210:211], v240 offset:33280
    ds_read_b128 v[128:131], v226 offset:0
    v_exp_f32 v118, v118
    v_exp_f32 v119, v119
    v_exp_f32 v120, v120
    v_exp_f32 v121, v121
    v_smfmac_f32_32x32x32_bf16 v[144:159], v[88:91], v[112:119], v246
    s_lshl_b32 s3, s78, 12
    s_add_u32 m0, s3, 0
    s_lshl_b32 s3, s78, 15
    s_add_u32 s3, s3, 1048576
    buffer_load_dwordx4 v238, s[24:27], s3 offen lds
    ds_read_b128 v[132:135], v226 offset:1024
    v_exp_f32 v122, v122
    v_exp_f32 v123, v123
    v_exp_f32 v124, v124
    v_exp_f32 v125, v125
    v_mfma_f32_32x32x16_bf16 v[176:191], v[212:215], v[204:207], v[176:191]
    s_add_u32 s3, s98, 94208
    buffer_load_dwordx4 v[204:207], v225, s[20:23], s3 offen sc1
    ds_read_b32 v136, v228 offset:2048
    v_exp_f32 v126, v126
    v_exp_f32 v127, v127
    v_exp_f32 v96, v96
    v_exp_f32 v97, v97
    v_smfmac_f32_32x32x32_bf16 v[144:159], v[92:95], v[120:127], v246
    ds_read_b64_tr_b16 v[212:213], v241 offset:32768
    v_exp_f32 v98, v98
    v_exp_f32 v99, v99
    v_exp_f32 v100, v100
    v_exp_f32 v101, v101
    v_mfma_f32_32x32x16_bf16 v[112:127], v[4:7], v[216:219], 0
    ds_read_b64_tr_b16 v[214:215], v241 offset:33280
    v_exp_f32 v102, v102
    v_exp_f32 v103, v103
    v_exp_f32 v104, v104
    v_exp_f32 v105, v105
    s_waitcnt lgkmcnt(2)
    v_smfmac_f32_32x32x32_bf16 v[128:143], v[32:35], v[96:103], v246
    s_lshl_b32 s3, s78, 12
    s_add_u32 m0, s3, 1024
    s_lshl_b32 s3, s78, 15
    s_add_u32 s3, s3, 1056768
    buffer_load_dwordx4 v238, s[24:27], s3 offen lds
    v_exp_f32 v106, v106
    v_exp_f32 v107, v107
    v_exp_f32 v108, v108
    v_exp_f32 v109, v109
    v_mfma_f32_32x32x16_bf16 v[160:175], v[208:211], v[192:195], v[160:175]
    v_exp_f32 v110, v110
    v_exp_f32 v111, v111
    v_exp_f32 v112, v112
    v_exp_f32 v113, v113
    v_smfmac_f32_32x32x32_bf16 v[128:143], v[36:39], v[104:111], v246
    ds_read_b64_tr_b16 v[208:209], v240 offset:40960
    ds_write_b128 v227, v[144:147] offset:0
    v_exp_f32 v114, v114
    v_exp_f32 v115, v115
    v_exp_f32 v116, v116
    v_exp_f32 v117, v117
    v_mfma_f32_32x32x16_bf16 v[96:111], v[8:11], v[216:219], 0
    ds_read_b64_tr_b16 v[210:211], v240 offset:41472
    ds_write_b128 v227, v[148:151] offset:1024
    v_exp_f32 v118, v118
    v_exp_f32 v119, v119
    v_exp_f32 v120, v120
    v_exp_f32 v121, v121
    v_smfmac_f32_32x32x32_bf16 v[128:143], v[40:43], v[112:119], v246
    s_lshl_b32 s3, s78, 12
    s_add_u32 m0, s3, 2048
    s_lshl_b32 s3, s78, 15
    s_add_u32 s3, s3, 1064960
    buffer_load_dwordx4 v238, s[24:27], s3 offen lds
    v_exp_f32 v122, v122
    v_exp_f32 v123, v123
    v_exp_f32 v124, v124
    v_exp_f32 v125, v125
    s_waitcnt lgkmcnt(4)
    v_mfma_f32_32x32x16_bf16 v[176:191], v[212:215], v[192:195], v[176:191]
    s_add_u32 s3, s98, 98304
    buffer_load_dwordx4 v[192:195], v225, s[20:23], s3 offen sc1
    ds_write_b32 v229, v152 offset:2048
    v_exp_f32 v126, v126
    v_exp_f32 v127, v127
    v_exp_f32 v96, v96
    v_exp_f32 v97, v97
    v_smfmac_f32_32x32x32_bf16 v[128:143], v[44:47], v[120:127], v246
    ds_read_b64_tr_b16 v[212:213], v241 offset:40960
    v_exp_f32 v98, v98
    v_exp_f32 v99, v99
    v_exp_f32 v100, v100
    v_exp_f32 v101, v101
    v_mfma_f32_32x32x16_bf16 v[112:127], v[12:15], v[216:219], 0
    ds_read_b64_tr_b16 v[214:215], v241 offset:41472
    v_exp_f32 v102, v102
    v_exp_f32 v103, v103
    v_exp_f32 v104, v104
    v_exp_f32 v105, v105
    v_smfmac_f32_32x32x32_bf16 v[128:143], v[48:51], v[96:103], v246
    s_lshl_b32 s3, s78, 12
    s_add_u32 m0, s3, 3072
    s_lshl_b32 s3, s78, 15
    s_add_u32 s3, s3, 1073152
    buffer_load_dwordx4 v238, s[24:27], s3 offen lds
    v_exp_f32 v106, v106
    v_exp_f32 v107, v107
    v_exp_f32 v108, v108
    v_exp_f32 v109, v109
    s_waitcnt lgkmcnt(4)
    s_waitcnt vmcnt(7)
    v_mfma_f32_32x32x16_bf16 v[160:175], v[208:211], v[196:199], v[160:175]
    v_exp_f32 v110, v110
    v_exp_f32 v111, v111
    s_setprio 2
    v_exp_f32 v112, v112
    v_exp_f32 v113, v113
    v_smfmac_f32_32x32x32_bf16 v[128:143], v[52:55], v[104:111], v246
    ds_read_b64_tr_b16 v[208:209], v240 offset:49152
    v_exp_f32 v114, v114
    v_exp_f32 v115, v115
    v_exp_f32 v116, v116
    v_exp_f32 v117, v117
    v_mfma_f32_32x32x16_bf16 v[96:111], v[16:19], v[216:219], 0
    ds_read_b64_tr_b16 v[210:211], v240 offset:49664
    v_exp_f32 v118, v118
    v_exp_f32 v119, v119
    v_exp_f32 v120, v120
    v_exp_f32 v121, v121
    v_smfmac_f32_32x32x32_bf16 v[128:143], v[56:59], v[112:119], v246
    v_exp_f32 v122, v122
    v_exp_f32 v123, v123
    v_exp_f32 v124, v124
    v_exp_f32 v125, v125
    s_waitcnt lgkmcnt(2)
    v_mfma_f32_32x32x16_bf16 v[176:191], v[212:215], v[196:199], v[176:191]
    s_add_u32 s3, s98, 102400
    buffer_load_dwordx4 v[196:199], v225, s[20:23], s3 offen sc1
    v_exp_f32 v126, v126
    v_exp_f32 v127, v127
    v_exp_f32 v96, v96
    v_exp_f32 v97, v97
    v_smfmac_f32_32x32x32_bf16 v[128:143], v[60:63], v[120:127], v246
    ds_read_b64_tr_b16 v[212:213], v241 offset:49152
    v_exp_f32 v98, v98
    v_exp_f32 v99, v99
    v_exp_f32 v100, v100
    v_exp_f32 v101, v101
    v_mfma_f32_32x32x16_bf16 v[112:127], v[20:23], v[216:219], 0
    ds_read_b64_tr_b16 v[214:215], v241 offset:49664
    v_exp_f32 v102, v102
    v_exp_f32 v103, v103
    v_exp_f32 v104, v104
    v_exp_f32 v105, v105
    v_smfmac_f32_32x32x32_bf16 v[128:143], v[64:67], v[96:103], v246
    s_add_u32 s3, s78, 7
    s_and_b32 s3, s3, 7
    s_lshl_b32 s3, s3, 10
    s_add_u32 s3, s3, 151552
    v_add_u32 v230, s3, v225
    ds_read_b128 v[220:223], v230
    v_exp_f32 v106, v106
    v_exp_f32 v107, v107
    v_exp_f32 v108, v108
    v_exp_f32 v109, v109
    s_waitcnt lgkmcnt(3)
    s_waitcnt vmcnt(7)
    v_mfma_f32_32x32x16_bf16 v[160:175], v[208:211], v[200:203], v[160:175]
    v_exp_f32 v110, v110
    v_exp_f32 v111, v111
    s_setprio 1
    v_exp_f32 v112, v112
    v_exp_f32 v113, v113
    v_smfmac_f32_32x32x32_bf16 v[128:143], v[68:71], v[104:111], v246
    ds_read_b64_tr_b16 v[208:209], v240 offset:57344
    v_exp_f32 v114, v114
    v_exp_f32 v115, v115
    v_exp_f32 v116, v116
    v_exp_f32 v117, v117
    v_mfma_f32_32x32x16_bf16 v[96:111], v[24:27], v[216:219], 0
    ds_read_b64_tr_b16 v[210:211], v240 offset:57856
    v_exp_f32 v118, v118
    v_exp_f32 v119, v119
    v_exp_f32 v120, v120
    v_exp_f32 v121, v121
    v_smfmac_f32_32x32x32_bf16 v[128:143], v[72:75], v[112:119], v246
    s_add_u32 s3, s78, 7
    s_and_b32 s3, s3, 7
    s_mul_i32 s3, s3, 2304
    s_add_u32 s3, s3, 116736
    v_add_u32 v227, s3, v225
    v_add_u32 v229, s3, v239
    v_exp_f32 v122, v122
    v_exp_f32 v123, v123
    v_exp_f32 v124, v124
    v_exp_f32 v125, v125
    s_waitcnt lgkmcnt(3)
    v_mfma_f32_32x32x16_bf16 v[176:191], v[212:215], v[200:203], v[176:191]
    s_add_u32 s3, s98, 106496
    buffer_load_dwordx4 v[200:203], v225, s[20:23], s3 offen sc1
    v_exp_f32 v126, v126
    v_exp_f32 v127, v127
    s_setprio 0
    v_exp_f32 v96, v96
    v_exp_f32 v97, v97
    v_smfmac_f32_32x32x32_bf16 v[128:143], v[76:79], v[120:127], v246
    ds_read_b64_tr_b16 v[212:213], v241 offset:57344
    v_exp_f32 v98, v98
    v_exp_f32 v99, v99
    v_exp_f32 v100, v100
    v_exp_f32 v101, v101
    v_mfma_f32_32x32x16_bf16 v[112:127], v[28:31], v[216:219], 0
    ds_read_b64_tr_b16 v[214:215], v241 offset:57856
    v_exp_f32 v102, v102
    v_exp_f32 v103, v103
    v_exp_f32 v104, v104
    v_exp_f32 v105, v105
    v_smfmac_f32_32x32x32_bf16 v[128:143], v[80:83], v[96:103], v246
    v_exp_f32 v106, v106
    v_exp_f32 v107, v107
    v_exp_f32 v108, v108
    v_exp_f32 v109, v109
    s_waitcnt lgkmcnt(2)
    s_waitcnt vmcnt(6)
    v_mfma_f32_32x32x16_bf16 v[160:175], v[208:211], v[204:207], v[160:175]
    v_exp_f32 v110, v110
    v_exp_f32 v111, v111
    s_setprio 3
    v_exp_f32 v112, v112
    v_exp_f32 v113, v113
    v_smfmac_f32_32x32x32_bf16 v[128:143], v[84:87], v[104:111], v246
    s_waitcnt lgkmcnt(0)
    s_barrier
    v_exp_f32 v114, v114
    v_exp_f32 v115, v115
    v_exp_f32 v116, v116
    v_exp_f32 v117, v117
    v_mfma_f32_32x32x16_bf16 v[96:111], v[0:3], v[220:223], 0
    ds_read_b128 v[144:147], v227 offset:0
    v_exp_f32 v118, v118
    v_exp_f32 v119, v119
    v_exp_f32 v120, v120
    v_exp_f32 v121, v121
    v_smfmac_f32_32x32x32_bf16 v[128:143], v[88:91], v[112:119], v246
    ds_read_b128 v[148:151], v227 offset:1024
    s_lshl_b32 s3, s78, 12
    s_add_u32 m0, s3, 32768
    s_lshl_b32 s3, s78, 15
    s_add_u32 s3, s3, 0
    buffer_load_dwordx4 v238, s[28:31], s3 offen lds
    v_exp_f32 v122, v122
    v_exp_f32 v123, v123
    v_exp_f32 v124, v124
    v_exp_f32 v125, v125
    v_mfma_f32_32x32x16_bf16 v[176:191], v[212:215], v[204:207], v[176:191]
    s_add_u32 s3, s98, 110592
    buffer_load_dwordx4 v[204:207], v225, s[20:23], s3 offen sc1
    ds_read_b32 v152, v229 offset:2048
    v_exp_f32 v126, v126
    v_exp_f32 v127, v127
    v_exp_f32 v96, v96
    v_exp_f32 v97, v97
    v_smfmac_f32_32x32x32_bf16 v[128:143], v[92:95], v[120:127], v246
    v_exp_f32 v98, v98
    v_exp_f32 v99, v99
    v_exp_f32 v100, v100
    v_exp_f32 v101, v101
    v_mfma_f32_32x32x16_bf16 v[112:127], v[4:7], v[220:223], 0
    v_exp_f32 v102, v102
    v_exp_f32 v103, v103
    v_exp_f32 v104, v104
    v_exp_f32 v105, v105
    s_waitcnt lgkmcnt(0)
    v_smfmac_f32_32x32x32_bf16 v[144:159], v[32:35], v[96:103], v246
    s_lshl_b32 s3, s78, 12
    s_add_u32 m0, s3, 33792
    s_lshl_b32 s3, s78, 15
    s_add_u32 s3, s3, 8192
    buffer_load_dwordx4 v238, s[28:31], s3 offen lds
    v_exp_f32 v106, v106
    v_exp_f32 v107, v107
    v_exp_f32 v108, v108
    v_exp_f32 v109, v109
    s_nop 0
    v_exp_f32 v110, v110
    v_exp_f32 v111, v111
    v_exp_f32 v112, v112
    v_exp_f32 v113, v113
    v_smfmac_f32_32x32x32_bf16 v[144:159], v[36:39], v[104:111], v246
    ds_write_b128 v226, v[128:131] offset:0
    v_exp_f32 v114, v114
    v_exp_f32 v115, v115
    v_exp_f32 v116, v116
    v_exp_f32 v117, v117
    v_mfma_f32_32x32x16_bf16 v[96:111], v[8:11], v[220:223], 0
    ds_write_b128 v226, v[132:135] offset:1024
    v_exp_f32 v118, v118
    v_exp_f32 v119, v119
    v_exp_f32 v120, v120
    v_exp_f32 v121, v121
    v_smfmac_f32_32x32x32_bf16 v[144:159], v[40:43], v[112:119], v246
    s_lshl_b32 s3, s78, 12
    s_add_u32 m0, s3, 34816
    s_lshl_b32 s3, s78, 15
    s_add_u32 s3, s3, 16384
    buffer_load_dwordx4 v238, s[28:31], s3 offen lds
    v_exp_f32 v122, v122
    v_exp_f32 v123, v123
    v_exp_f32 v124, v124
    v_exp_f32 v125, v125
    s_nop 0
    ds_write_b32 v228, v136 offset:2048
    v_exp_f32 v126, v126
    v_exp_f32 v127, v127
    v_exp_f32 v96, v96
    v_exp_f32 v97, v97
    v_smfmac_f32_32x32x32_bf16 v[144:159], v[44:47], v[120:127], v246
    v_exp_f32 v98, v98
    v_exp_f32 v99, v99
    v_exp_f32 v100, v100
    v_exp_f32 v101, v101
    v_mfma_f32_32x32x16_bf16 v[112:127], v[12:15], v[220:223], 0
    v_exp_f32 v102, v102
    v_exp_f32 v103, v103
    v_exp_f32 v104, v104
    v_exp_f32 v105, v105
    v_smfmac_f32_32x32x32_bf16 v[144:159], v[48:51], v[96:103], v246
    s_lshl_b32 s3, s78, 12
    s_add_u32 m0, s3, 35840
    s_lshl_b32 s3, s78, 15
    s_add_u32 s3, s3, 24576
    buffer_load_dwordx4 v238, s[28:31], s3 offen lds
    v_exp_f32 v106, v106
    v_exp_f32 v107, v107
    v_exp_f32 v108, v108
    v_exp_f32 v109, v109
    s_nop 0
    v_exp_f32 v110, v110
    v_exp_f32 v111, v111
    s_setprio 2
    v_exp_f32 v112, v112
    v_exp_f32 v113, v113
    v_smfmac_f32_32x32x32_bf16 v[144:159], v[52:55], v[104:111], v246
    v_exp_f32 v114, v114
    v_exp_f32 v115, v115
    v_exp_f32 v116, v116
    v_exp_f32 v117, v117
    v_mfma_f32_32x32x16_bf16 v[96:111], v[16:19], v[220:223], 0
    v_exp_f32 v118, v118
    v_exp_f32 v119, v119
    v_exp_f32 v120, v120
    v_exp_f32 v121, v121
    v_smfmac_f32_32x32x32_bf16 v[144:159], v[56:59], v[112:119], v246
    v_exp_f32 v122, v122
    v_exp_f32 v123, v123
    v_exp_f32 v124, v124
    v_exp_f32 v125, v125
    s_nop 0
    v_exp_f32 v126, v126
    v_exp_f32 v127, v127
    v_exp_f32 v96, v96
    v_exp_f32 v97, v97
    v_smfmac_f32_32x32x32_bf16 v[144:159], v[60:63], v[120:127], v246
    v_exp_f32 v98, v98
    v_exp_f32 v99, v99
    v_exp_f32 v100, v100
    v_exp_f32 v101, v101
    v_mfma_f32_32x32x16_bf16 v[112:127], v[20:23], v[220:223], 0
    v_exp_f32 v102, v102
    v_exp_f32 v103, v103
    v_exp_f32 v104, v104
    v_exp_f32 v105, v105
    v_smfmac_f32_32x32x32_bf16 v[144:159], v[64:67], v[96:103], v246
    s_add_u32 s3, s98, 114688
    buffer_load_dwordx4 v[208:211], v225, s[20:23], s3 offen sc1
    v_exp_f32 v106, v106
    v_exp_f32 v107, v107
    v_exp_f32 v108, v108
    v_exp_f32 v109, v109
    s_nop 0
    v_exp_f32 v110, v110
    v_exp_f32 v111, v111
    s_setprio 1
    v_exp_f32 v112, v112
    v_exp_f32 v113, v113
    v_smfmac_f32_32x32x32_bf16 v[144:159], v[68:71], v[104:111], v246
    v_exp_f32 v114, v114
    v_exp_f32 v115, v115
    v_exp_f32 v116, v116
    v_exp_f32 v117, v117
    v_mfma_f32_32x32x16_bf16 v[96:111], v[24:27], v[220:223], 0
    v_exp_f32 v118, v118
    v_exp_f32 v119, v119
    v_exp_f32 v120, v120
    v_exp_f32 v121, v121
    v_smfmac_f32_32x32x32_bf16 v[144:159], v[72:75], v[112:119], v246
    s_add_u32 s3, s78, 7
    s_and_b32 s3, s3, 7
    s_mul_i32 s3, s3, 2304
    s_add_u32 s3, s3, 98304
    v_add_u32 v226, s3, v225
    v_add_u32 v228, s3, v239
    s_add_u32 s3, s98, 118784
    s_cmp_lt_u32 s78, 4
    s_cselect_b32 s3, s3, 0x80000000
    buffer_load_dwordx4 v[212:215], v225, s[20:23], s3 offen sc1
    v_exp_f32 v122, v122
    v_exp_f32 v123, v123
    v_exp_f32 v124, v124
    v_exp_f32 v125, v125
    s_nop 0
    v_exp_f32 v126, v126
    v_exp_f32 v127, v127
    s_setprio 0
    v_exp_f32 v96, v96
    v_exp_f32 v97, v97
    v_smfmac_f32_32x32x32_bf16 v[144:159], v[76:79], v[120:127], v246
    v_exp_f32 v98, v98
    v_exp_f32 v99, v99
    v_exp_f32 v100, v100
    v_exp_f32 v101, v101
    v_mfma_f32_32x32x16_bf16 v[112:127], v[28:31], v[220:223], 0
    v_exp_f32 v102, v102
    v_exp_f32 v103, v103
    v_exp_f32 v104, v104
    v_exp_f32 v105, v105
    v_smfmac_f32_32x32x32_bf16 v[144:159], v[80:83], v[96:103], v246
    v_exp_f32 v106, v106
    v_exp_f32 v107, v107
    v_exp_f32 v108, v108
    v_exp_f32 v109, v109
    s_nop 0
    v_exp_f32 v110, v110
    v_exp_f32 v111, v111
    s_setprio 3
    v_exp_f32 v112, v112
    v_exp_f32 v113, v113
    v_smfmac_f32_32x32x32_bf16 v[144:159], v[84:87], v[104:111], v246
    s_waitcnt vmcnt(2) lgkmcnt(0)
    s_barrier
    v_exp_f32 v114, v114
    v_exp_f32 v115, v115
    v_exp_f32 v116, v116
    v_exp_f32 v117, v117
    ds_read_b128 v[128:131], v226 offset:0
    v_exp_f32 v118, v118
    v_exp_f32 v119, v119
    v_exp_f32 v120, v120
    v_exp_f32 v121, v121
    v_smfmac_f32_32x32x32_bf16 v[144:159], v[88:91], v[112:119], v246
    ds_read_b128 v[132:135], v226 offset:1024
    v_exp_f32 v122, v122
    v_exp_f32 v123, v123
    v_exp_f32 v124, v124
    v_exp_f32 v125, v125
    s_nop 0
    ds_read_b32 v136, v228 offset:2048
    v_exp_f32 v126, v126
    v_exp_f32 v127, v127
    s_nop 1
    v_smfmac_f32_32x32x32_bf16 v[144:159], v[92:95], v[120:127], v246
L_tail:
    s_setprio 0
    v_add_u32 v228, 135168, v240
    v_add_u32 v229, 135168, v241
    s_waitcnt lgkmcnt(0)
    s_nop 7
    v_add_f32 v136, v136, v152
    v_rcp_f32 v136, v136
    v_pk_add_f32 v[128:129], v[128:129], v[144:145]
    v_pk_add_f32 v[130:131], v[130:131], v[146:147]
    v_pk_add_f32 v[132:133], v[132:133], v[148:149]
    v_pk_add_f32 v[134:135], v[134:135], v[150:151]
    v_mul_f32 v136, v136, v250
    v_mov_b32 v137, v136
    v_pk_mul_f32 v[128:129], v[128:129], v[136:137]
    v_pk_mul_f32 v[130:131], v[130:131], v[136:137]
    v_pk_mul_f32 v[132:133], v[132:133], v[136:137]
    v_pk_mul_f32 v[134:135], v[134:135], v[136:137]
    v_cvt_pk_bf16_f32 v140, v128, v129
    v_cvt_pk_bf16_f32 v141, v130, v131
    v_cvt_pk_bf16_f32 v142, v132, v133
    v_cvt_pk_bf16_f32 v143, v134, v135
    buffer_store_dwordx4 v[140:143], v225, s[20:23], s99 offen sc0 sc1
    v_add_u32 v230, 32768, v240
    v_add_u32 v231, 32768, v241
    ds_read_b64_tr_b16 v[96:97], v240 offset:0
    ds_read_b64_tr_b16 v[98:99], v240 offset:512
    ds_read_b64_tr_b16 v[100:101], v241 offset:0
    ds_read_b64_tr_b16 v[102:103], v241 offset:512
    ds_read_b64_tr_b16 v[104:105], v240 offset:8192
    ds_read_b64_tr_b16 v[106:107], v240 offset:8704
    ds_read_b64_tr_b16 v[108:109], v241 offset:8192
    ds_read_b64_tr_b16 v[110:111], v241 offset:8704
    ds_read_b64_tr_b16 v[112:113], v240 offset:16384
    ds_read_b64_tr_b16 v[114:115], v240 offset:16896
    ds_read_b64_tr_b16 v[116:117], v241 offset:16384
    ds_read_b64_tr_b16 v[118:119], v241 offset:16896
    s_waitcnt lgkmcnt(8)
    v_mfma_f32_32x32x16_bf16 v[160:175], v[96:99], v[192:195], v[160:175]
    v_mfma_f32_32x32x16_bf16 v[176:191], v[100:103], v[192:195], v[176:191]
    ds_read_b64_tr_b16 v[120:121], v240 offset:24576
    ds_read_b64_tr_b16 v[122:123], v240 offset:25088
    ds_read_b64_tr_b16 v[124:125], v241 offset:24576
    ds_read_b64_tr_b16 v[126:127], v241 offset:25088
    s_waitcnt lgkmcnt(8)
    v_mfma_f32_32x32x16_bf16 v[160:175], v[104:107], v[196:199], v[160:175]
    v_mfma_f32_32x32x16_bf16 v[176:191], v[108:111], v[196:199], v[176:191]
    ds_read_b64_tr_b16 v[144:145], v228 offset:0
    ds_read_b64_tr_b16 v[146:147], v228 offset:512
    ds_read_b64_tr_b16 v[148:149], v229 offset:0
    ds_read_b64_tr_b16 v[150:151], v229 offset:512
    s_waitcnt lgkmcnt(8)
    v_mfma_f32_32x32x16_bf16 v[160:175], v[112:115], v[200:203], v[160:175]
    v_mfma_f32_32x32x16_bf16 v[176:191], v[116:119], v[200:203], v[176:191]
    ds_read_b64_tr_b16 v[152:153], v228 offset:8192
    ds_read_b64_tr_b16 v[154:155], v228 offset:8704
    ds_read_b64_tr_b16 v[156:157], v229 offset:8192
    ds_read_b64_tr_b16 v[158:159], v229 offset:8704
    s_waitcnt lgkmcnt(8)
    v_mfma_f32_32x32x16_bf16 v[160:175], v[120:123], v[204:207], v[160:175]
    v_mfma_f32_32x32x16_bf16 v[176:191], v[124:127], v[204:207], v[176:191]
    ds_read_b64_tr_b16 v[32:33], v230 offset:0
    ds_read_b64_tr_b16 v[34:35], v230 offset:512
    ds_read_b64_tr_b16 v[36:37], v231 offset:0
    ds_read_b64_tr_b16 v[38:39], v231 offset:512
    s_waitcnt lgkmcnt(8)
    s_waitcnt vmcnt(2)
    v_mfma_f32_32x32x16_bf16 v[160:175], v[144:147], v[208:211], v[160:175]
    v_mfma_f32_32x32x16_bf16 v[176:191], v[148:151], v[208:211], v[176:191]
    ds_read_b64_tr_b16 v[40:41], v230 offset:8192
    ds_read_b64_tr_b16 v[42:43], v230 offset:8704
    ds_read_b64_tr_b16 v[44:45], v231 offset:8192
    ds_read_b64_tr_b16 v[46:47], v231 offset:8704
    s_waitcnt lgkmcnt(8)
    s_waitcnt vmcnt(1)
    v_mfma_f32_32x32x16_bf16 v[160:175], v[152:155], v[212:215], v[160:175]
    v_mfma_f32_32x32x16_bf16 v[176:191], v[156:159], v[212:215], v[176:191]
    ds_read_b64_tr_b16 v[48:49], v230 offset:16384
    ds_read_b64_tr_b16 v[50:51], v230 offset:16896
    ds_read_b64_tr_b16 v[52:53], v231 offset:16384
    ds_read_b64_tr_b16 v[54:55], v231 offset:16896
    ds_read_b64_tr_b16 v[56:57], v230 offset:24576
    ds_read_b64_tr_b16 v[58:59], v230 offset:25088
    ds_read_b64_tr_b16 v[60:61], v231 offset:24576
    ds_read_b64_tr_b16 v[62:63], v231 offset:25088
    ds_read_b64_tr_b16 v[64:65], v230 offset:32768
    ds_read_b64_tr_b16 v[66:67], v230 offset:33280
    ds_read_b64_tr_b16 v[68:69], v231 offset:32768
    ds_read_b64_tr_b16 v[70:71], v231 offset:33280
    ds_read_b64_tr_b16 v[72:73], v230 offset:40960
    ds_read_b64_tr_b16 v[74:75], v230 offset:41472
    ds_read_b64_tr_b16 v[76:77], v231 offset:40960
    ds_read_b64_tr_b16 v[78:79], v231 offset:41472
    ds_read_b64_tr_b16 v[80:81], v230 offset:49152
    ds_read_b64_tr_b16 v[82:83], v230 offset:49664
    ds_read_b64_tr_b16 v[84:85], v231 offset:49152
    ds_read_b64_tr_b16 v[86:87], v231 offset:49664
    ds_read_b64_tr_b16 v[88:89], v230 offset:57344
    ds_read_b64_tr_b16 v[90:91], v230 offset:57856
    ds_read_b64_tr_b16 v[92:93], v231 offset:57344
    ds_read_b64_tr_b16 v[94:95], v231 offset:57856
    s_mov_b32 s92, 0
    v_sub_f32 v232, 1.0, v248
    v_mov_b32 v233, v232
    s_mov_b32 s44, 0xff
    s_mov_b32 s45, 0
    s_add_u32 s3, s98, 24576
    buffer_load_dwordx4 v[24:27], v225, s[20:23], s3 offen sc1
    s_add_u32 s3, s98, 28672
    buffer_load_dwordx4 v[28:31], v225, s[20:23], s3 offen sc1
    s_add_u32 s3, s98, 16384
    buffer_load_dwordx4 v[16:19], v225, s[20:23], s3 offen sc1
    s_add_u32 s3, s98, 20480
    buffer_load_dwordx4 v[20:23], v225, s[20:23], s3 offen sc1
    s_add_u32 s3, s98, 0
    buffer_load_dwordx4 v[0:3], v225, s[20:23], s3 offen sc1
    s_add_u32 s3, s98, 4096
    buffer_load_dwordx4 v[4:7], v225, s[20:23], s3 offen sc1
    s_add_u32 s3, s98, 8192
    buffer_load_dwordx4 v[8:11], v225, s[20:23], s3 offen sc1
    s_add_u32 s3, s98, 12288
    buffer_load_dwordx4 v[12:15], v225, s[20:23], s3 offen sc1
    v_pk_mul_f32 v[160:161], v[160:161], v[232:233]
    v_pk_mul_f32 v[162:163], v[162:163], v[232:233]
    v_pk_mul_f32 v[164:165], v[164:165], v[232:233]
    v_pk_mul_f32 v[166:167], v[166:167], v[232:233]
    v_pk_mul_f32 v[168:169], v[168:169], v[232:233]
    v_pk_mul_f32 v[170:171], v[170:171], v[232:233]
    v_pk_mul_f32 v[172:173], v[172:173], v[232:233]
    v_pk_mul_f32 v[174:175], v[174:175], v[232:233]
    v_pk_mul_f32 v[176:177], v[176:177], v[232:233]
    v_pk_mul_f32 v[178:179], v[178:179], v[232:233]
    v_pk_mul_f32 v[180:181], v[180:181], v[232:233]
    v_pk_mul_f32 v[182:183], v[182:183], v[232:233]
    v_pk_mul_f32 v[184:185], v[184:185], v[232:233]
    v_pk_mul_f32 v[186:187], v[186:187], v[232:233]
    v_pk_mul_f32 v[188:189], v[188:189], v[232:233]
    v_pk_mul_f32 v[190:191], v[190:191], v[232:233]
    s_and_b32 s3, s78, 1
    s_lshr_b32 s47, s78, 1
    s_lshl2_add_u32 s46, s3, s47
    s_lshl_b32 s46, s46, 13
    v_and_b32 v226, 31, v224
    v_and_b32 v227, 15, v224
    v_lshrrev_b32 v228, 3, v224
    v_and_b32 v229, 4, v228
    v_xor_b32 v227, v227, v229
    v_lshlrev_b32 v227, 4, v227
    v_lshl_add_u32 v227, v226, 8, v227
    v_add_u32 v100, s46, v227
    v_xor_b32 v101, 16, v100
    v_xor_b32 v102, 32, v100
    v_xor_b32 v103, 48, v100
    v_xor_b32 v104, 128, v100
    v_xor_b32 v105, 144, v100
    v_xor_b32 v106, 160, v100
    v_xor_b32 v107, 176, v100
    s_lshl_b32 s46, s47, 3
    v_add_u32 v228, s46, v228
    v_and_b32 v229, 7, v224
    v_lshlrev_b32 v227, 1, v229
    v_and_b32 v226, 15, v228
    v_xor_b32 v227, v227, v226
    v_lshlrev_b32 v227, 4, v227
    v_lshl_add_u32 v227, v228, 8, v227
    s_lshl_b32 s46, s3, 15
    v_add_u32 v236, s46, v227
    v_xor_b32 v237, 16, v236
    v_lshlrev_b32 v229, 4, v229
    v_lshl_add_u32 v226, v228, 10, v229
    s_lshl1_add_u32 s46, s85, s3
    s_lshl_b32 s46, s46, 15
    s_lshl_b32 s3, s86, 7
    s_add_u32 s46, s46, s3
    s_waitcnt lgkmcnt(0)
    s_barrier
    s_waitcnt vmcnt(7)
    v_max3_u32 v231, v24, v25, v26
    v_max_u32 v231, v27, v231
    v_cmp_eq_u32 vcc, -1, v231
    s_cmp_eq_u64 vcc, 0
    s_cbranch_scc0 L_oc16
    s_bitset0_b32 s44, 6
L_oc16:
    s_cmp_eq_u32 s45, 0
    s_cbranch_scc0 L_om16
    s_bitcmp1_b32 s44, 6
    s_cbranch_scc1 L_om16
    v_mfma_f32_32x32x16_bf16 v[160:175], v[80:83], v[24:27], v[160:175]
    v_mfma_f32_32x32x16_bf16 v[176:191], v[84:87], v[24:27], v[176:191]
    s_mov_b32 s45, 1
L_om16:
    s_waitcnt vmcnt(6)
    v_max3_u32 v231, v28, v29, v30
    v_max_u32 v231, v31, v231
    v_cmp_eq_u32 vcc, -1, v231
    s_cmp_eq_u64 vcc, 0
    s_cbranch_scc0 L_oc17
    s_bitset0_b32 s44, 7
L_oc17:
    s_cmp_eq_u32 s45, 1
    s_cbranch_scc0 L_om17
    s_bitcmp1_b32 s44, 7
    s_cbranch_scc1 L_om17
    v_mfma_f32_32x32x16_bf16 v[160:175], v[88:91], v[28:31], v[160:175]
    v_mfma_f32_32x32x16_bf16 v[176:191], v[92:95], v[28:31], v[176:191]
    s_mov_b32 s45, 2
L_om17:
    s_waitcnt vmcnt(5)
    v_max3_u32 v231, v16, v17, v18
    v_max_u32 v231, v19, v231
    v_cmp_eq_u32 vcc, -1, v231
    s_cmp_eq_u64 vcc, 0
    s_cbranch_scc0 L_oc14
    s_bitset0_b32 s44, 4
L_oc14:
    s_cmp_eq_u32 s45, 2
    s_cbranch_scc0 L_om14
    s_bitcmp1_b32 s44, 4
    s_cbranch_scc1 L_om14
    v_mfma_f32_32x32x16_bf16 v[160:175], v[64:67], v[16:19], v[160:175]
    v_mfma_f32_32x32x16_bf16 v[176:191], v[68:71], v[16:19], v[176:191]
    s_mov_b32 s45, 3
L_om14:
    s_waitcnt vmcnt(4)
    v_max3_u32 v231, v20, v21, v22
    v_max_u32 v231, v23, v231
    v_cmp_eq_u32 vcc, -1, v231
    s_cmp_eq_u64 vcc, 0
    s_cbranch_scc0 L_oc15
    s_bitset0_b32 s44, 5
L_oc15:
    s_cmp_eq_u32 s45, 3
    s_cbranch_scc0 L_om15
    s_bitcmp1_b32 s44, 5
    s_cbranch_scc1 L_om15
    v_mfma_f32_32x32x16_bf16 v[160:175], v[72:75], v[20:23], v[160:175]
    v_mfma_f32_32x32x16_bf16 v[176:191], v[76:79], v[20:23], v[176:191]
    s_mov_b32 s45, 4
L_om15:
    s_waitcnt vmcnt(3)
    v_max3_u32 v231, v0, v1, v2
    v_max_u32 v231, v3, v231
    v_cmp_eq_u32 vcc, -1, v231
    s_cmp_eq_u64 vcc, 0
    s_cbranch_scc0 L_oc10
    s_bitset0_b32 s44, 0
L_oc10:
    s_cmp_eq_u32 s45, 4
    s_cbranch_scc0 L_om10
    s_bitcmp1_b32 s44, 0
    s_cbranch_scc1 L_om10
    v_mfma_f32_32x32x16_bf16 v[160:175], v[32:35], v[0:3], v[160:175]
    v_mfma_f32_32x32x16_bf16 v[176:191], v[36:39], v[0:3], v[176:191]
    s_mov_b32 s45, 5
L_om10:
    s_waitcnt vmcnt(2)
    v_max3_u32 v231, v4, v5, v6
    v_max_u32 v231, v7, v231
    v_cmp_eq_u32 vcc, -1, v231
    s_cmp_eq_u64 vcc, 0
    s_cbranch_scc0 L_oc11
    s_bitset0_b32 s44, 1
L_oc11:
    s_cmp_eq_u32 s45, 5
    s_cbranch_scc0 L_om11
    s_bitcmp1_b32 s44, 1
    s_cbranch_scc1 L_om11
    v_mfma_f32_32x32x16_bf16 v[160:175], v[40:43], v[4:7], v[160:175]
    v_mfma_f32_32x32x16_bf16 v[176:191], v[44:47], v[4:7], v[176:191]
    s_mov_b32 s45, 6
L_om11:
    s_waitcnt vmcnt(1)
    v_max3_u32 v231, v8, v9, v10
    v_max_u32 v231, v11, v231
    v_cmp_eq_u32 vcc, -1, v231
    s_cmp_eq_u64 vcc, 0
    s_cbranch_scc0 L_oc12
    s_bitset0_b32 s44, 2
L_oc12:
    s_cmp_eq_u32 s45, 6
    s_cbranch_scc0 L_om12
    s_bitcmp1_b32 s44, 2
    s_cbranch_scc1 L_om12
    v_mfma_f32_32x32x16_bf16 v[160:175], v[48:51], v[8:11], v[160:175]
    v_mfma_f32_32x32x16_bf16 v[176:191], v[52:55], v[8:11], v[176:191]
    s_mov_b32 s45, 7
L_om12:
    s_waitcnt vmcnt(0)
    v_max3_u32 v231, v12, v13, v14
    v_max_u32 v231, v15, v231
    v_cmp_eq_u32 vcc, -1, v231
    s_cmp_eq_u64 vcc, 0
    s_cbranch_scc0 L_oc13
    s_bitset0_b32 s44, 3
L_oc13:
    s_cmp_eq_u32 s45, 7
    s_cbranch_scc0 L_om13
    s_bitcmp1_b32 s44, 3
    s_cbranch_scc1 L_om13
    v_mfma_f32_32x32x16_bf16 v[160:175], v[56:59], v[12:15], v[160:175]
    v_mfma_f32_32x32x16_bf16 v[176:191], v[60:63], v[12:15], v[176:191]
    s_mov_b32 s45, 8
L_om13:
    s_cmp_eq_u32 s45, 8
    s_cbranch_scc1 L_opoll_ok
L_opoll:
    s_bitcmp1_b32 s44, 6
    s_cbranch_scc0 L_ol6
    s_add_u32 s3, s98, 24576
    buffer_load_dwordx4 v[24:27], v225, s[20:23], s3 offen sc1
L_ol6:
    s_bitcmp1_b32 s44, 7
    s_cbranch_scc0 L_ol7
    s_add_u32 s3, s98, 28672
    buffer_load_dwordx4 v[28:31], v225, s[20:23], s3 offen sc1
L_ol7:
    s_bitcmp1_b32 s44, 4
    s_cbranch_scc0 L_ol4
    s_add_u32 s3, s98, 16384
    buffer_load_dwordx4 v[16:19], v225, s[20:23], s3 offen sc1
L_ol4:
    s_bitcmp1_b32 s44, 5
    s_cbranch_scc0 L_ol5
    s_add_u32 s3, s98, 20480
    buffer_load_dwordx4 v[20:23], v225, s[20:23], s3 offen sc1
L_ol5:
    s_bitcmp1_b32 s44, 0
    s_cbranch_scc0 L_ol0
    s_add_u32 s3, s98, 0
    buffer_load_dwordx4 v[0:3], v225, s[20:23], s3 offen sc1
L_ol0:
    s_bitcmp1_b32 s44, 1
    s_cbranch_scc0 L_ol1
    s_add_u32 s3, s98, 4096
    buffer_load_dwordx4 v[4:7], v225, s[20:23], s3 offen sc1
L_ol1:
    s_bitcmp1_b32 s44, 2
    s_cbranch_scc0 L_ol2
    s_add_u32 s3, s98, 8192
    buffer_load_dwordx4 v[8:11], v225, s[20:23], s3 offen sc1
L_ol2:
    s_bitcmp1_b32 s44, 3
    s_cbranch_scc0 L_ol3
    s_add_u32 s3, s98, 12288
    buffer_load_dwordx4 v[12:15], v225, s[20:23], s3 offen sc1
L_ol3:
L_owait:
    s_waitcnt vmcnt(0)
L_ochk:
    s_bitcmp1_b32 s44, 6
    s_cbranch_scc0 L_oc6
    v_max3_u32 v231, v24, v25, v26
    v_max_u32 v231, v27, v231
    v_cmp_eq_u32 vcc, -1, v231
    s_cmp_eq_u64 vcc, 0
    s_cbranch_scc0 L_oc6
    s_bitset0_b32 s44, 6
L_oc6:
    s_cmp_eq_u32 s45, 0
    s_cbranch_scc0 L_om6
    s_bitcmp1_b32 s44, 6
    s_cbranch_scc1 L_om6
    v_mfma_f32_32x32x16_bf16 v[160:175], v[80:83], v[24:27], v[160:175]
    v_mfma_f32_32x32x16_bf16 v[176:191], v[84:87], v[24:27], v[176:191]
    s_mov_b32 s45, 1
L_om6:
    s_bitcmp1_b32 s44, 7
    s_cbranch_scc0 L_oc7
    v_max3_u32 v231, v28, v29, v30
    v_max_u32 v231, v31, v231
    v_cmp_eq_u32 vcc, -1, v231
    s_cmp_eq_u64 vcc, 0
    s_cbranch_scc0 L_oc7
    s_bitset0_b32 s44, 7
L_oc7:
    s_cmp_eq_u32 s45, 1
    s_cbranch_scc0 L_om7
    s_bitcmp1_b32 s44, 7
    s_cbranch_scc1 L_om7
    v_mfma_f32_32x32x16_bf16 v[160:175], v[88:91], v[28:31], v[160:175]
    v_mfma_f32_32x32x16_bf16 v[176:191], v[92:95], v[28:31], v[176:191]
    s_mov_b32 s45, 2
L_om7:
    s_bitcmp1_b32 s44, 4
    s_cbranch_scc0 L_oc4
    v_max3_u32 v231, v16, v17, v18
    v_max_u32 v231, v19, v231
    v_cmp_eq_u32 vcc, -1, v231
    s_cmp_eq_u64 vcc, 0
    s_cbranch_scc0 L_oc4
    s_bitset0_b32 s44, 4
L_oc4:
    s_cmp_eq_u32 s45, 2
    s_cbranch_scc0 L_om4
    s_bitcmp1_b32 s44, 4
    s_cbranch_scc1 L_om4
    v_mfma_f32_32x32x16_bf16 v[160:175], v[64:67], v[16:19], v[160:175]
    v_mfma_f32_32x32x16_bf16 v[176:191], v[68:71], v[16:19], v[176:191]
    s_mov_b32 s45, 3
L_om4:
    s_bitcmp1_b32 s44, 5
    s_cbranch_scc0 L_oc5
    v_max3_u32 v231, v20, v21, v22
    v_max_u32 v231, v23, v231
    v_cmp_eq_u32 vcc, -1, v231
    s_cmp_eq_u64 vcc, 0
    s_cbranch_scc0 L_oc5
    s_bitset0_b32 s44, 5
L_oc5:
    s_cmp_eq_u32 s45, 3
    s_cbranch_scc0 L_om5
    s_bitcmp1_b32 s44, 5
    s_cbranch_scc1 L_om5
    v_mfma_f32_32x32x16_bf16 v[160:175], v[72:75], v[20:23], v[160:175]
    v_mfma_f32_32x32x16_bf16 v[176:191], v[76:79], v[20:23], v[176:191]
    s_mov_b32 s45, 4
L_om5:
    s_bitcmp1_b32 s44, 0
    s_cbranch_scc0 L_oc0
    v_max3_u32 v231, v0, v1, v2
    v_max_u32 v231, v3, v231
    v_cmp_eq_u32 vcc, -1, v231
    s_cmp_eq_u64 vcc, 0
    s_cbranch_scc0 L_oc0
    s_bitset0_b32 s44, 0
L_oc0:
    s_cmp_eq_u32 s45, 4
    s_cbranch_scc0 L_om0
    s_bitcmp1_b32 s44, 0
    s_cbranch_scc1 L_om0
    v_mfma_f32_32x32x16_bf16 v[160:175], v[32:35], v[0:3], v[160:175]
    v_mfma_f32_32x32x16_bf16 v[176:191], v[36:39], v[0:3], v[176:191]
    s_mov_b32 s45, 5
L_om0:
    s_bitcmp1_b32 s44, 1
    s_cbranch_scc0 L_oc1
    v_max3_u32 v231, v4, v5, v6
    v_max_u32 v231, v7, v231
    v_cmp_eq_u32 vcc, -1, v231
    s_cmp_eq_u64 vcc, 0
    s_cbranch_scc0 L_oc1
    s_bitset0_b32 s44, 1
L_oc1:
    s_cmp_eq_u32 s45, 5
    s_cbranch_scc0 L_om1
    s_bitcmp1_b32 s44, 1
    s_cbranch_scc1 L_om1
    v_mfma_f32_32x32x16_bf16 v[160:175], v[40:43], v[4:7], v[160:175]
    v_mfma_f32_32x32x16_bf16 v[176:191], v[44:47], v[4:7], v[176:191]
    s_mov_b32 s45, 6
L_om1:
    s_bitcmp1_b32 s44, 2
    s_cbranch_scc0 L_oc2
    v_max3_u32 v231, v8, v9, v10
    v_max_u32 v231, v11, v231
    v_cmp_eq_u32 vcc, -1, v231
    s_cmp_eq_u64 vcc, 0
    s_cbranch_scc0 L_oc2
    s_bitset0_b32 s44, 2
L_oc2:
    s_cmp_eq_u32 s45, 6
    s_cbranch_scc0 L_om2
    s_bitcmp1_b32 s44, 2
    s_cbranch_scc1 L_om2
    v_mfma_f32_32x32x16_bf16 v[160:175], v[48:51], v[8:11], v[160:175]
    v_mfma_f32_32x32x16_bf16 v[176:191], v[52:55], v[8:11], v[176:191]
    s_mov_b32 s45, 7
L_om2:
    s_bitcmp1_b32 s44, 3
    s_cbranch_scc0 L_oc3
    v_max3_u32 v231, v12, v13, v14
    v_max_u32 v231, v15, v231
    v_cmp_eq_u32 vcc, -1, v231
    s_cmp_eq_u64 vcc, 0
    s_cbranch_scc0 L_oc3
    s_bitset0_b32 s44, 3
L_oc3:
    s_cmp_eq_u32 s45, 7
    s_cbranch_scc0 L_om3
    s_bitcmp1_b32 s44, 3
    s_cbranch_scc1 L_om3
    v_mfma_f32_32x32x16_bf16 v[160:175], v[56:59], v[12:15], v[160:175]
    v_mfma_f32_32x32x16_bf16 v[176:191], v[60:63], v[12:15], v[176:191]
    s_mov_b32 s45, 8
L_om3:
    s_cmp_eq_u32 s45, 8
    s_cbranch_scc1 L_opoll_ok
    s_add_u32 s92, s92, 1
    s_cmp_lt_u32 s92, 0x100000
    s_cbranch_scc1 L_opoll
L_opoll_ok:
    s_nop 9
    ds_write_b128 v100, v[160:163]
    ds_write_b128 v101, v[164:167]
    ds_write_b128 v102, v[168:171]
    ds_write_b128 v103, v[172:175]
    ds_write_b128 v104, v[176:179]
    ds_write_b128 v105, v[180:183]
    ds_write_b128 v106, v[184:187]
    ds_write_b128 v107, v[188:191]
    s_waitcnt lgkmcnt(0)
    s_barrier
    ds_read_b128 v[128:131], v236 offset:0
    ds_read_b128 v[132:135], v237 offset:0
    ds_read_b128 v[136:139], v236 offset:8192
    ds_read_b128 v[140:143], v237 offset:8192
    ds_read_b128 v[144:147], v236 offset:16384
    ds_read_b128 v[148:151], v237 offset:16384
    ds_read_b128 v[152:155], v236 offset:24576
    ds_read_b128 v[156:159], v237 offset:24576
    s_waitcnt lgkmcnt(4)
    v_pk_add_f32 v[128:129], v[128:129], v[136:137]
    v_pk_add_f32 v[130:131], v[130:131], v[138:139]
    v_pk_add_f32 v[132:133], v[132:133], v[140:141]
    v_pk_add_f32 v[134:135], v[134:135], v[142:143]
    s_waitcnt lgkmcnt(0)
    v_pk_add_f32 v[144:145], v[144:145], v[152:153]
    v_pk_add_f32 v[146:147], v[146:147], v[154:155]
    v_pk_add_f32 v[148:149], v[148:149], v[156:157]
    v_pk_add_f32 v[150:151], v[150:151], v[158:159]
    v_pk_add_f32 v[128:129], v[128:129], v[144:145]
    v_pk_add_f32 v[130:131], v[130:131], v[146:147]
    v_pk_add_f32 v[132:133], v[132:133], v[148:149]
    v_pk_add_f32 v[134:135], v[134:135], v[150:151]
    v_cvt_pk_bf16_f32 v112, v128, v129
    v_cvt_pk_bf16_f32 v113, v130, v131
    v_cvt_pk_bf16_f32 v114, v132, v133
    v_cvt_pk_bf16_f32 v115, v134, v135
    buffer_store_dwordx4 v[112:115], v226, s[32:35], s46 offen sc0 sc1
L_fin:
L_end:
    s_endpgm
L_special14:
    v_mov_b32 v253, 0x80000000
    v_mul_u32_u24 v28, 12, v29
    v_sub_u32 v28, v224, v28
    v_add_u32 v28, 0, v28
    v_cmp_gt_u32 vcc, 4, v28
    s_nop 1
    v_cndmask_b32 v228, v253, v228, vcc
    v_mul_u32_u24 v28, 12, v30
    v_sub_u32 v28, v224, v28
    v_add_u32 v28, 64, v28
    v_cmp_gt_u32 vcc, 4, v28
    s_nop 1
    v_cndmask_b32 v229, v253, v229, vcc
    v_mul_u32_u24 v28, 12, v31
    v_sub_u32 v28, v224, v28
    v_add_u32 v28, 128, v28
    v_cmp_gt_u32 vcc, 4, v28
    s_nop 1
    v_cndmask_b32 v230, v253, v230, vcc
    s_branch L_special14_done
L_roleKV:
    v_and_b32 v31, 16, v224
    v_mul_u32_u24 v31, 126, v31
    v_lshl_add_u32 v31, v220, 5, v31
    v_add_u32 v31, v31, v221
    v_add_u32 v236, 131072, v31
    v_and_b32 v237, 32, v224
    v_lshrrev_b32 v237, 1, v237
    s_waitcnt lgkmcnt(0)
    s_and_b32 s6, s2, 7
    s_bfe_u32 s7, s2, 0x20003
    s_lshl2_add_u32 s85, s6, s7
    s_lshr_b32 s86, s2, 5
    s_mov_b32 s20, s76
    s_and_b32 s21, s77, 0xffff
    s_mov_b32 s22, 0x1000000
    s_mov_b32 s23, 0x20000
    s_mov_b32 s48, s74
    s_and_b32 s49, s75, 0xffff
    s_mov_b32 s50, 0x100
    s_mov_b32 s51, 0x20000
    v_lshlrev_b32 v239, 2, v224
    v_mov_b32 v247, 0
    v_and_b32 v222, 11, v224
    v_cmp_eq_u32 vcc, 0, v222
    v_mov_b32 v223, 0x3f803f80
    s_nop 0
    v_cndmask_b32 v242, 0, v223, vcc
    v_mov_b32 v32, v242
    v_mov_b32 v33, v242
    v_mov_b32 v34, v242
    v_mov_b32 v35, v242
    v_mov_b32 v36, v242
    v_mov_b32 v37, v242
    v_mov_b32 v38, v242
    v_mov_b32 v39, v242
    v_mov_b32 v40, v242
    s_mov_b32 s24, s68
    s_and_b32 s25, s69, 0xffff
    s_mov_b32 s26, 0x158000
    s_mov_b32 s27, 0x20000
    s_mov_b32 s28, s60
    s_and_b32 s29, s61, 0xffff
    s_mov_b32 s30, 0x80000
    s_mov_b32 s31, 0x20000
    s_mov_b32 s32, s72
    s_and_b32 s33, s73, 0xffff
    s_mov_b32 s34, 0x200000
    s_mov_b32 s35, 0x20000
    v_mov_b32 v243, 0x80000000
    v_mov_b32 v245, 163328
    v_writelane_b32 v243, 0, 0
    v_mov_b32 v50, v242
    v_mov_b32 v51, v242
    v_mov_b32 v52, v242
    v_mov_b32 v53, v242
    v_mov_b32 v54, v242
    v_mov_b32 v55, v242
    v_mov_b32 v56, v242
    v_mov_b32 v57, v242
    v_mov_b32 v58, v242
    s_barrier
    ds_read_b128 v[192:195], v232
    ds_read_b64_tr_b16 v[196:197], v236 offset:0
    ds_read_b64_tr_b16 v[198:199], v236 offset:128
    s_waitcnt lgkmcnt(0)
    v_mfma_f32_32x32x16_bf16 v[96:111], v[196:199], v[192:195], 0
    ds_read_b128 v[0:3], v233
    ds_read_b64_tr_b16 v[4:5], v236 offset:512
    ds_read_b64_tr_b16 v[6:7], v236 offset:640
    v_mfma_f32_32x32x16_bf16 v[112:127], v[192:195], v[196:199], 0
    s_waitcnt lgkmcnt(0)
    v_mfma_f32_32x32x16_bf16 v[96:111], v[4:7], v[0:3], v[96:111]
    ds_read_b128 v[192:195], v234
    ds_read_b64_tr_b16 v[196:197], v236 offset:1024
    ds_read_b64_tr_b16 v[198:199], v236 offset:1152
    v_mfma_f32_32x32x16_bf16 v[112:127], v[0:3], v[4:7], v[112:127]
    s_waitcnt lgkmcnt(0)
    v_mfma_f32_32x32x16_bf16 v[96:111], v[196:199], v[192:195], v[96:111]
    ds_read_b128 v[0:3], v235
    ds_read_b64_tr_b16 v[4:5], v236 offset:1536
    ds_read_b64_tr_b16 v[6:7], v236 offset:1664
    v_mfma_f32_32x32x16_bf16 v[112:127], v[192:195], v[196:199], v[112:127]
    v_add_u32 v232, 16384, v232
    v_add_u32 v233, 16384, v233
    v_add_u32 v234, 16384, v234
    v_add_u32 v235, 16384, v235
    v_add_u32 v236, 4096, v236
    s_waitcnt lgkmcnt(0)
    v_mfma_f32_32x32x16_bf16 v[96:111], v[4:7], v[0:3], v[96:111]
    ds_read_b128 v[192:195], v232
    ds_read_b64_tr_b16 v[196:197], v236 offset:0
    ds_read_b64_tr_b16 v[198:199], v236 offset:128
    v_mfma_f32_32x32x16_bf16 v[112:127], v[0:3], v[4:7], v[112:127]
    s_waitcnt lgkmcnt(0)
    v_mfma_f32_32x32x16_bf16 v[96:111], v[196:199], v[192:195], v[96:111]
    ds_read_b128 v[0:3], v233
    ds_read_b64_tr_b16 v[4:5], v236 offset:512
    ds_read_b64_tr_b16 v[6:7], v236 offset:640
    v_mfma_f32_32x32x16_bf16 v[112:127], v[192:195], v[196:199], v[112:127]
    s_waitcnt lgkmcnt(0)
    v_mfma_f32_32x32x16_bf16 v[96:111], v[4:7], v[0:3], v[96:111]
    ds_read_b128 v[192:195], v234
    ds_read_b64_tr_b16 v[196:197], v236 offset:1024
    ds_read_b64_tr_b16 v[198:199], v236 offset:1152
    v_mfma_f32_32x32x16_bf16 v[112:127], v[0:3], v[4:7], v[112:127]
    s_waitcnt lgkmcnt(0)
    v_mfma_f32_32x32x16_bf16 v[96:111], v[196:199], v[192:195], v[96:111]
    ds_read_b128 v[0:3], v235
    ds_read_b64_tr_b16 v[4:5], v236 offset:1536
    ds_read_b64_tr_b16 v[6:7], v236 offset:1664
    v_mfma_f32_32x32x16_bf16 v[112:127], v[192:195], v[196:199], v[112:127]
    v_add_u32 v232, 16384, v232
    v_add_u32 v233, 16384, v233
    v_add_u32 v234, 16384, v234
    v_add_u32 v235, 16384, v235
    v_add_u32 v236, 4096, v236
    s_waitcnt lgkmcnt(0)
    s_barrier
    v_mfma_f32_32x32x16_bf16 v[96:111], v[4:7], v[0:3], v[96:111]
    ds_read_b128 v[192:195], v232
    ds_read_b64_tr_b16 v[196:197], v236 offset:0
    ds_read_b64_tr_b16 v[198:199], v236 offset:128
    v_mfma_f32_32x32x16_bf16 v[112:127], v[0:3], v[4:7], v[112:127]
    s_waitcnt lgkmcnt(0)
    v_mfma_f32_32x32x16_bf16 v[96:111], v[196:199], v[192:195], v[96:111]
    ds_read_b128 v[0:3], v233
    ds_read_b64_tr_b16 v[4:5], v236 offset:512
    ds_read_b64_tr_b16 v[6:7], v236 offset:640
    v_mfma_f32_32x32x16_bf16 v[112:127], v[192:195], v[196:199], v[112:127]
    s_waitcnt lgkmcnt(0)
    v_mfma_f32_32x32x16_bf16 v[96:111], v[4:7], v[0:3], v[96:111]
    ds_read_b128 v[192:195], v234
    ds_read_b64_tr_b16 v[196:197], v236 offset:1024
    ds_read_b64_tr_b16 v[198:199], v236 offset:1152
    v_mfma_f32_32x32x16_bf16 v[112:127], v[0:3], v[4:7], v[112:127]
    s_waitcnt lgkmcnt(0)
    v_mfma_f32_32x32x16_bf16 v[96:111], v[196:199], v[192:195], v[96:111]
    ds_read_b128 v[0:3], v235
    ds_read_b64_tr_b16 v[4:5], v236 offset:1536
    ds_read_b64_tr_b16 v[6:7], v236 offset:1664
    v_mfma_f32_32x32x16_bf16 v[112:127], v[192:195], v[196:199], v[112:127]
    v_add_u32 v232, 16384, v232
    v_add_u32 v233, 16384, v233
    v_add_u32 v234, 16384, v234
    v_add_u32 v235, 16384, v235
    v_add_u32 v236, 4096, v236
    s_waitcnt lgkmcnt(0)
    v_mfma_f32_32x32x16_bf16 v[96:111], v[4:7], v[0:3], v[96:111]
    ds_read_b128 v[192:195], v232
    ds_read_b64_tr_b16 v[196:197], v236 offset:0
    ds_read_b64_tr_b16 v[198:199], v236 offset:128
    v_mfma_f32_32x32x16_bf16 v[112:127], v[0:3], v[4:7], v[112:127]
    s_waitcnt lgkmcnt(0)
    v_mfma_f32_32x32x16_bf16 v[96:111], v[196:199], v[192:195], v[96:111]
    ds_read_b128 v[0:3], v233
    ds_read_b64_tr_b16 v[4:5], v236 offset:512
    ds_read_b64_tr_b16 v[6:7], v236 offset:640
    v_mfma_f32_32x32x16_bf16 v[112:127], v[192:195], v[196:199], v[112:127]
    s_waitcnt lgkmcnt(0)
    v_mfma_f32_32x32x16_bf16 v[96:111], v[4:7], v[0:3], v[96:111]
    ds_read_b128 v[192:195], v234
    ds_read_b64_tr_b16 v[196:197], v236 offset:1024
    ds_read_b64_tr_b16 v[198:199], v236 offset:1152
    v_mfma_f32_32x32x16_bf16 v[112:127], v[0:3], v[4:7], v[112:127]
    s_waitcnt lgkmcnt(0)
    v_mfma_f32_32x32x16_bf16 v[96:111], v[196:199], v[192:195], v[96:111]
    ds_read_b128 v[0:3], v235
    ds_read_b64_tr_b16 v[4:5], v236 offset:1536
    ds_read_b64_tr_b16 v[6:7], v236 offset:1664
    v_mfma_f32_32x32x16_bf16 v[112:127], v[192:195], v[196:199], v[112:127]
    v_add_u32 v232, 16384, v232
    v_add_u32 v233, 16384, v233
    v_add_u32 v234, 16384, v234
    v_add_u32 v235, 16384, v235
    v_add_u32 v236, 4096, v236
    buffer_load_dword v244, v247, s[48:51], 0 offen sc1
    s_waitcnt lgkmcnt(0)
    s_barrier
    v_mfma_f32_32x32x16_bf16 v[96:111], v[4:7], v[0:3], v[96:111]
    ds_read_b128 v[192:195], v232
    ds_read_b64_tr_b16 v[196:197], v236 offset:0
    ds_read_b64_tr_b16 v[198:199], v236 offset:128
    v_mfma_f32_32x32x16_bf16 v[112:127], v[0:3], v[4:7], v[112:127]
    s_waitcnt lgkmcnt(0)
    v_mfma_f32_32x32x16_bf16 v[96:111], v[196:199], v[192:195], v[96:111]
    ds_read_b128 v[0:3], v233
    ds_read_b64_tr_b16 v[4:5], v236 offset:512
    ds_read_b64_tr_b16 v[6:7], v236 offset:640
    v_mfma_f32_32x32x16_bf16 v[112:127], v[192:195], v[196:199], v[112:127]
    s_waitcnt lgkmcnt(0)
    v_mfma_f32_32x32x16_bf16 v[96:111], v[4:7], v[0:3], v[96:111]
    ds_read_b128 v[192:195], v234
    ds_read_b64_tr_b16 v[196:197], v236 offset:1024
    ds_read_b64_tr_b16 v[198:199], v236 offset:1152
    v_mfma_f32_32x32x16_bf16 v[112:127], v[0:3], v[4:7], v[112:127]
    s_waitcnt lgkmcnt(0)
    v_mfma_f32_32x32x16_bf16 v[96:111], v[196:199], v[192:195], v[96:111]
    ds_read_b128 v[0:3], v235
    ds_read_b64_tr_b16 v[4:5], v236 offset:1536
    ds_read_b64_tr_b16 v[6:7], v236 offset:1664
    v_mfma_f32_32x32x16_bf16 v[112:127], v[192:195], v[196:199], v[112:127]
    v_add_u32 v232, 16384, v232
    v_add_u32 v233, 16384, v233
    v_add_u32 v234, 16384, v234
    v_add_u32 v235, 16384, v235
    v_add_u32 v236, 4096, v236
    s_waitcnt lgkmcnt(0)
    v_mfma_f32_32x32x16_bf16 v[96:111], v[4:7], v[0:3], v[96:111]
    ds_read_b128 v[192:195], v232
    ds_read_b64_tr_b16 v[196:197], v236 offset:0
    ds_read_b64_tr_b16 v[198:199], v236 offset:128
    v_mfma_f32_32x32x16_bf16 v[112:127], v[0:3], v[4:7], v[112:127]
    s_waitcnt lgkmcnt(0)
    v_mfma_f32_32x32x16_bf16 v[96:111], v[196:199], v[192:195], v[96:111]
    ds_read_b128 v[0:3], v233
    ds_read_b64_tr_b16 v[4:5], v236 offset:512
    ds_read_b64_tr_b16 v[6:7], v236 offset:640
    v_mfma_f32_32x32x16_bf16 v[112:127], v[192:195], v[196:199], v[112:127]
    s_waitcnt lgkmcnt(0)
    v_mfma_f32_32x32x16_bf16 v[96:111], v[4:7], v[0:3], v[96:111]
    ds_read_b128 v[192:195], v234
    ds_read_b64_tr_b16 v[196:197], v236 offset:1024
    ds_read_b64_tr_b16 v[198:199], v236 offset:1152
    v_mfma_f32_32x32x16_bf16 v[112:127], v[0:3], v[4:7], v[112:127]
    s_waitcnt lgkmcnt(0)
    v_mfma_f32_32x32x16_bf16 v[96:111], v[196:199], v[192:195], v[96:111]
    ds_read_b128 v[0:3], v235
    ds_read_b64_tr_b16 v[4:5], v236 offset:1536
    ds_read_b64_tr_b16 v[6:7], v236 offset:1664
    v_mfma_f32_32x32x16_bf16 v[112:127], v[192:195], v[196:199], v[112:127]
    v_add_u32 v232, 16384, v232
    v_add_u32 v233, 16384, v233
    v_add_u32 v234, 16384, v234
    v_add_u32 v235, 16384, v235
    v_add_u32 v236, 4096, v236
    s_waitcnt lgkmcnt(0)
    s_barrier
    v_mfma_f32_32x32x16_bf16 v[96:111], v[4:7], v[0:3], v[96:111]
    ds_read_b128 v[192:195], v232
    ds_read_b64_tr_b16 v[196:197], v236 offset:0
    ds_read_b64_tr_b16 v[198:199], v236 offset:128
    v_mfma_f32_32x32x16_bf16 v[112:127], v[0:3], v[4:7], v[112:127]
    s_waitcnt lgkmcnt(0)
    v_mfma_f32_32x32x16_bf16 v[96:111], v[196:199], v[192:195], v[96:111]
    ds_read_b128 v[0:3], v233
    ds_read_b64_tr_b16 v[4:5], v236 offset:512
    ds_read_b64_tr_b16 v[6:7], v236 offset:640
    v_mfma_f32_32x32x16_bf16 v[112:127], v[192:195], v[196:199], v[112:127]
    s_waitcnt lgkmcnt(0)
    v_mfma_f32_32x32x16_bf16 v[96:111], v[4:7], v[0:3], v[96:111]
    ds_read_b128 v[192:195], v234
    ds_read_b64_tr_b16 v[196:197], v236 offset:1024
    ds_read_b64_tr_b16 v[198:199], v236 offset:1152
    v_mfma_f32_32x32x16_bf16 v[112:127], v[0:3], v[4:7], v[112:127]
    s_waitcnt lgkmcnt(0)
    v_mfma_f32_32x32x16_bf16 v[96:111], v[196:199], v[192:195], v[96:111]
    ds_read_b128 v[0:3], v235
    ds_read_b64_tr_b16 v[4:5], v236 offset:1536
    ds_read_b64_tr_b16 v[6:7], v236 offset:1664
    v_mfma_f32_32x32x16_bf16 v[112:127], v[192:195], v[196:199], v[112:127]
    v_add_u32 v232, 16384, v232
    v_add_u32 v233, 16384, v233
    v_add_u32 v234, 16384, v234
    v_add_u32 v235, 16384, v235
    v_add_u32 v236, 4096, v236
    s_waitcnt lgkmcnt(0)
    v_mfma_f32_32x32x16_bf16 v[96:111], v[4:7], v[0:3], v[96:111]
    ds_read_b128 v[192:195], v232
    ds_read_b64_tr_b16 v[196:197], v236 offset:0
    ds_read_b64_tr_b16 v[198:199], v236 offset:128
    v_mfma_f32_32x32x16_bf16 v[112:127], v[0:3], v[4:7], v[112:127]
    s_waitcnt lgkmcnt(0)
    v_mfma_f32_32x32x16_bf16 v[96:111], v[196:199], v[192:195], v[96:111]
    ds_read_b128 v[0:3], v233
    ds_read_b64_tr_b16 v[4:5], v236 offset:512
    ds_read_b64_tr_b16 v[6:7], v236 offset:640
    v_mfma_f32_32x32x16_bf16 v[112:127], v[192:195], v[196:199], v[112:127]
    s_waitcnt lgkmcnt(0)
    v_mfma_f32_32x32x16_bf16 v[96:111], v[4:7], v[0:3], v[96:111]
    ds_read_b128 v[192:195], v234
    ds_read_b64_tr_b16 v[196:197], v236 offset:1024
    ds_read_b64_tr_b16 v[198:199], v236 offset:1152
    v_mfma_f32_32x32x16_bf16 v[112:127], v[0:3], v[4:7], v[112:127]
    s_waitcnt lgkmcnt(0)
    v_mfma_f32_32x32x16_bf16 v[96:111], v[196:199], v[192:195], v[96:111]
    ds_read_b128 v[0:3], v235
    ds_read_b64_tr_b16 v[4:5], v236 offset:1536
    ds_read_b64_tr_b16 v[6:7], v236 offset:1664
    v_mfma_f32_32x32x16_bf16 v[112:127], v[192:195], v[196:199], v[112:127]
    s_waitcnt lgkmcnt(0)
    v_mfma_f32_32x32x16_bf16 v[96:111], v[4:7], v[0:3], v[96:111]
    v_mfma_f32_32x32x16_bf16 v[112:127], v[0:3], v[4:7], v[112:127]
    s_lshl2_add_u32 s93, s79, s78
    v_and_b32 v160, 31, v224
    v_lshrrev_b32 v161, 5, v224
    v_and_b32 v162, 0x13, v160
    v_and_b32 v163, 4, v160
    v_lshl_or_b32 v162, v163, 1, v162
    v_and_b32 v163, 8, v160
    v_lshrrev_b32 v163, 1, v163
    v_or_b32 v162, v162, v163
    v_lshl_add_u32 v162, v161, 5, v162
    v_lshlrev_b32 v162, 4, v162
    v_lshlrev_b32 v163, 8, v161
    v_lshl_add_u32 v163, v160, 4, v163
    v_mov_b32 v164, 0x80000000
    v_cmp_lt_u32 vcc, 15, v160
    s_lshl_b32 s3, s93, 10
    s_add_u32 s6, s3, 98048
    s_add_u32 s3, s3, 32768
    v_cndmask_b32 v163, v164, v163, vcc
    v_cvt_pk_bf16_f32 v168, v96, v97
    v_cvt_pk_bf16_f32 v169, v98, v99
    v_cvt_pk_bf16_f32 v170, v100, v101
    v_cvt_pk_bf16_f32 v171, v102, v103
    buffer_store_dwordx4 v[168:171], v162, s[20:23], s3 offen sc0 sc1
    v_cvt_pk_bf16_f32 v172, v112, v113
    v_cvt_pk_bf16_f32 v173, v114, v115
    v_cvt_pk_bf16_f32 v174, v116, v117
    v_cvt_pk_bf16_f32 v175, v118, v119
    v_cvt_pk_bf16_f32 v176, v120, v121
    v_cvt_pk_bf16_f32 v177, v122, v123
    v_cvt_pk_bf16_f32 v178, v124, v125
    v_cvt_pk_bf16_f32 v179, v126, v127
    buffer_store_dwordx4 v[172:175], v163, s[20:23], s6 offen sc0 sc1
    buffer_store_dwordx4 v[176:179], v163, s[20:23], s6 offen offset:512 sc0 sc1
    s_barrier
    s_lshl_b32 s3, s93, 7
    v_pk_mul_f32 v[104:105], v[96:97], v[96:97]
    v_pk_fma_f32 v[104:105], v[98:99], v[98:99], v[104:105]
    v_pk_fma_f32 v[104:105], v[100:101], v[100:101], v[104:105]
    v_pk_fma_f32 v[104:105], v[102:103], v[102:103], v[104:105]
    v_max3_f32 v106, |v112|, |v113|, |v114|
    v_max3_f32 v106, |v115|, |v116|, v106
    v_max3_f32 v106, |v117|, |v118|, v106
    v_max3_f32 v106, |v119|, |v120|, v106
    v_max3_f32 v106, |v121|, |v122|, v106
    v_max3_f32 v106, |v123|, |v124|, v106
    v_max3_f32 v106, |v125|, |v126|, v106
    v_max_f32 v106, |v127|, v106
    v_add_f32 v104, v104, v105
    v_cmp_gt_f32 vcc, 0x4e800000, v106
    v_mov_b32 v105, v104
    v_mov_b32 v107, 0x7f800000
    s_nop 0
    v_permlane32_swap_b32 v104, v105
    s_nop 1
    v_add_f32 v104, v104, v105
    v_cndmask_b32 v104, v107, v104, vcc
    s_nop 1
    v_max_f32_dpp v104, v104, v104 row_shr:1
    s_nop 1
    v_max_f32_dpp v104, v104, v104 row_shr:2
    s_nop 1
    v_max_f32_dpp v104, v104, v104 row_shr:4
    s_nop 1
    v_max_f32_dpp v104, v104, v104 row_shr:8
    s_nop 1
    v_max_f32_dpp v104, v104, v104 row_bcast:15 row_mask:0xa
    s_nop 1
    v_max_f32_dpp v104, v104, v104 row_bcast:31 row_mask:0xc
    s_nop 0
    v_readlane_b32 s6, v104, 63
    v_mov_b32 v101, 0x3f828f5c
    s_add_u32 s3, s3, 196608
    v_mul_f32 v101, s6, v101
    s_waitcnt vmcnt(0)
    s_mov_b32 s92, 0
L_tagKV:
    v_readfirstlane_b32 s81, v244
    s_cmp_lg_u32 s81, 0
    s_cbranch_scc1 L_tag_okKV
    s_add_u32 s92, s92, 1
    s_cmp_gt_u32 s92, 0x100000
    s_cbranch_scc1 L_tag_okKV
    s_sleep 4
    buffer_load_dword v244, v247, s[48:51], 0 offen sc1
    s_waitcnt vmcnt(0)
    s_branch L_tagKV
L_tag_okKV:
    v_mov_b32 v100, v244
    buffer_store_dwordx2 v[100:101], v243, s[20:23], s3 offen sc0 sc1
    s_barrier
    s_mov_b32 s44, s70
    s_and_b32 s45, s71, 0xffff
    s_mov_b32 s46, 0x400
    s_mov_b32 s47, 0x20000
    v_add_u32 v232, 0xfffe4000, v232
    v_add_u32 v233, 0xfffe4000, v233
    v_add_u32 v234, 0xfffe4000, v234
    v_add_u32 v235, 0xfffe4000, v235
    buffer_load_dwordx4 v[144:147], v237, s[44:47], 0 offen offset:0
    buffer_load_dwordx4 v[148:151], v237, s[44:47], 0 offen offset:32
    buffer_load_dwordx4 v[152:155], v237, s[44:47], 0 offen offset:64
    buffer_load_dwordx4 v[156:159], v237, s[44:47], 0 offen offset:96
    buffer_load_dwordx4 v[160:163], v237, s[44:47], 0 offen offset:128
    buffer_load_dwordx4 v[164:167], v237, s[44:47], 0 offen offset:160
    buffer_load_dwordx4 v[168:171], v237, s[44:47], 0 offen offset:192
    buffer_load_dwordx4 v[172:175], v237, s[44:47], 0 offen offset:224
    buffer_load_dwordx4 v[176:179], v237, s[44:47], 0 offen offset:256
    buffer_load_dwordx4 v[180:183], v237, s[44:47], 0 offen offset:288
    buffer_load_dwordx4 v[184:187], v237, s[44:47], 0 offen offset:320
    buffer_load_dwordx4 v[188:191], v237, s[44:47], 0 offen offset:352
    buffer_load_dwordx4 v[192:195], v237, s[44:47], 0 offen offset:384
    buffer_load_dwordx4 v[196:199], v237, s[44:47], 0 offen offset:416
    buffer_load_dwordx4 v[200:203], v237, s[44:47], 0 offen offset:448
    buffer_load_dwordx4 v[204:207], v237, s[44:47], 0 offen offset:480
    ds_read_b128 v[0:3], v232
    ds_read_b128 v[4:7], v233
    ds_read_b128 v[8:11], v234
    ds_read_b128 v[12:15], v235
    v_add_u32 v232, 16384, v232
    v_add_u32 v233, 16384, v233
    v_add_u32 v234, 16384, v234
    v_add_u32 v235, 16384, v235
    s_waitcnt vmcnt(12) lgkmcnt(0)
    v_mfma_f32_32x32x16_bf16 v[128:143], v[144:147], v[0:3], 0
    v_mfma_f32_32x32x16_bf16 v[128:143], v[148:151], v[4:7], v[128:143]
    v_mfma_f32_32x32x16_bf16 v[128:143], v[152:155], v[8:11], v[128:143]
    v_mfma_f32_32x32x16_bf16 v[128:143], v[156:159], v[12:15], v[128:143]
    ds_read_b128 v[0:3], v232
    ds_read_b128 v[4:7], v233
    ds_read_b128 v[8:11], v234
    ds_read_b128 v[12:15], v235
    v_add_u32 v232, 16384, v232
    v_add_u32 v233, 16384, v233
    v_add_u32 v234, 16384, v234
    v_add_u32 v235, 16384, v235
    s_waitcnt vmcnt(8) lgkmcnt(0)
    v_mfma_f32_32x32x16_bf16 v[128:143], v[160:163], v[0:3], v[128:143]
    v_mfma_f32_32x32x16_bf16 v[128:143], v[164:167], v[4:7], v[128:143]
    v_mfma_f32_32x32x16_bf16 v[128:143], v[168:171], v[8:11], v[128:143]
    v_mfma_f32_32x32x16_bf16 v[128:143], v[172:175], v[12:15], v[128:143]
    ds_read_b128 v[0:3], v232
    ds_read_b128 v[4:7], v233
    ds_read_b128 v[8:11], v234
    ds_read_b128 v[12:15], v235
    v_add_u32 v232, 16384, v232
    v_add_u32 v233, 16384, v233
    v_add_u32 v234, 16384, v234
    v_add_u32 v235, 16384, v235
    s_waitcnt vmcnt(4) lgkmcnt(0)
    v_mfma_f32_32x32x16_bf16 v[128:143], v[176:179], v[0:3], v[128:143]
    v_mfma_f32_32x32x16_bf16 v[128:143], v[180:183], v[4:7], v[128:143]
    v_mfma_f32_32x32x16_bf16 v[128:143], v[184:187], v[8:11], v[128:143]
    v_mfma_f32_32x32x16_bf16 v[128:143], v[188:191], v[12:15], v[128:143]
    ds_read_b128 v[0:3], v232
    ds_read_b128 v[4:7], v233
    ds_read_b128 v[8:11], v234
    ds_read_b128 v[12:15], v235
    v_add_u32 v232, 16384, v232
    v_add_u32 v233, 16384, v233
    v_add_u32 v234, 16384, v234
    v_add_u32 v235, 16384, v235
    s_waitcnt vmcnt(0) lgkmcnt(0)
    v_mfma_f32_32x32x16_bf16 v[128:143], v[192:195], v[0:3], v[128:143]
    v_mfma_f32_32x32x16_bf16 v[128:143], v[196:199], v[4:7], v[128:143]
    v_mfma_f32_32x32x16_bf16 v[128:143], v[200:203], v[8:11], v[128:143]
    v_mfma_f32_32x32x16_bf16 v[128:143], v[204:207], v[12:15], v[128:143]
    buffer_load_dwordx4 v[144:147], v237, s[44:47], 0 offen offset:512
    buffer_load_dwordx4 v[148:151], v237, s[44:47], 0 offen offset:544
    buffer_load_dwordx4 v[152:155], v237, s[44:47], 0 offen offset:576
    buffer_load_dwordx4 v[156:159], v237, s[44:47], 0 offen offset:608
    buffer_load_dwordx4 v[160:163], v237, s[44:47], 0 offen offset:640
    buffer_load_dwordx4 v[164:167], v237, s[44:47], 0 offen offset:672
    buffer_load_dwordx4 v[168:171], v237, s[44:47], 0 offen offset:704
    buffer_load_dwordx4 v[172:175], v237, s[44:47], 0 offen offset:736
    buffer_load_dwordx4 v[176:179], v237, s[44:47], 0 offen offset:768
    buffer_load_dwordx4 v[180:183], v237, s[44:47], 0 offen offset:800
    buffer_load_dwordx4 v[184:187], v237, s[44:47], 0 offen offset:832
    buffer_load_dwordx4 v[188:191], v237, s[44:47], 0 offen offset:864
    buffer_load_dwordx4 v[192:195], v237, s[44:47], 0 offen offset:896
    buffer_load_dwordx4 v[196:199], v237, s[44:47], 0 offen offset:928
    buffer_load_dwordx4 v[200:203], v237, s[44:47], 0 offen offset:960
    buffer_load_dwordx4 v[204:207], v237, s[44:47], 0 offen offset:992
    ds_read_b128 v[0:3], v232
    ds_read_b128 v[4:7], v233
    ds_read_b128 v[8:11], v234
    ds_read_b128 v[12:15], v235
    v_add_u32 v232, 16384, v232
    v_add_u32 v233, 16384, v233
    v_add_u32 v234, 16384, v234
    v_add_u32 v235, 16384, v235
    s_waitcnt vmcnt(12) lgkmcnt(0)
    v_mfma_f32_32x32x16_bf16 v[128:143], v[144:147], v[0:3], v[128:143]
    v_mfma_f32_32x32x16_bf16 v[128:143], v[148:151], v[4:7], v[128:143]
    v_mfma_f32_32x32x16_bf16 v[128:143], v[152:155], v[8:11], v[128:143]
    v_mfma_f32_32x32x16_bf16 v[128:143], v[156:159], v[12:15], v[128:143]
    ds_read_b128 v[0:3], v232
    ds_read_b128 v[4:7], v233
    ds_read_b128 v[8:11], v234
    ds_read_b128 v[12:15], v235
    v_add_u32 v232, 16384, v232
    v_add_u32 v233, 16384, v233
    v_add_u32 v234, 16384, v234
    v_add_u32 v235, 16384, v235
    s_waitcnt vmcnt(8) lgkmcnt(0)
    v_mfma_f32_32x32x16_bf16 v[128:143], v[160:163], v[0:3], v[128:143]
    v_mfma_f32_32x32x16_bf16 v[128:143], v[164:167], v[4:7], v[128:143]
    v_mfma_f32_32x32x16_bf16 v[128:143], v[168:171], v[8:11], v[128:143]
    v_mfma_f32_32x32x16_bf16 v[128:143], v[172:175], v[12:15], v[128:143]
    ds_read_b128 v[0:3], v232
    ds_read_b128 v[4:7], v233
    ds_read_b128 v[8:11], v234
    ds_read_b128 v[12:15], v235
    v_add_u32 v232, 16384, v232
    v_add_u32 v233, 16384, v233
    v_add_u32 v234, 16384, v234
    v_add_u32 v235, 16384, v235
    s_waitcnt vmcnt(4) lgkmcnt(0)
    v_mfma_f32_32x32x16_bf16 v[128:143], v[176:179], v[0:3], v[128:143]
    v_mfma_f32_32x32x16_bf16 v[128:143], v[180:183], v[4:7], v[128:143]
    v_mfma_f32_32x32x16_bf16 v[128:143], v[184:187], v[8:11], v[128:143]
    v_mfma_f32_32x32x16_bf16 v[128:143], v[188:191], v[12:15], v[128:143]
    ds_read_b128 v[0:3], v232
    ds_read_b128 v[4:7], v233
    ds_read_b128 v[8:11], v234
    ds_read_b128 v[12:15], v235
    s_waitcnt vmcnt(0) lgkmcnt(0)
    v_mfma_f32_32x32x16_bf16 v[128:143], v[192:195], v[0:3], v[128:143]
    v_mfma_f32_32x32x16_bf16 v[128:143], v[196:199], v[4:7], v[128:143]
    v_mfma_f32_32x32x16_bf16 v[128:143], v[200:203], v[8:11], v[128:143]
    v_mfma_f32_32x32x16_bf16 v[128:143], v[204:207], v[12:15], v[128:143]
    s_add_u32 s7, s78, 7
    s_bfe_u32 s6, s7, 0x20001
    s_lshl2_add_u32 s6, s79, s6
    s_mul_i32 s6, s6, 120832
    s_and_b32 s7, s7, 1
    s_lshl1_add_u32 s7, s80, s7
    s_lshl_b32 s7, s7, 10
    s_add_u32 s6, s6, s7
    s_add_u32 s99, s6, 262144
    v_lshlrev_b32 v249, 7, v224
    v_mov_b32 v41, v242
    v_mov_b32 v42, v242
    v_mov_b32 v43, v242
    v_mov_b32 v44, v242
    v_mov_b32 v45, v242
    v_mov_b32 v46, v242
    v_mov_b32 v47, v242
    v_mov_b32 v48, v242
    v_mov_b32 v49, v242
    v_mul_f32 v128, 0xbfb8aa3b, v128
    v_exp_f32 v128, v128
    v_and_b32 v160, 0x7c, v239
    v_add_f32 v128, 1.0, v128
    v_rcp_f32 v128, v128
    s_lshl_b32 s3, s93, 7
    s_add_u32 s6, s3, 16384
    buffer_store_dword v128, v160, s[20:23], s6 offen sc1
    v_lshrrev_b32 v222, 3, v224
    v_lshlrev_b32 v222, 10, v222
    v_and_b32 v223, 16, v224
    v_lshlrev_b32 v223, 2, v223
    v_xor_b32 v223, v223, v225
    v_and_b32 v223, 0x70, v223
    s_lshl_b32 s6, s86, 7
    v_add3_u32 v238, v222, v223, s6
    v_mov_b32 v59, v242
    v_mov_b32 v60, v242
    v_mov_b32 v61, v242
    v_mov_b32 v62, v242
    v_mov_b32 v63, v242
    v_mov_b32 v64, v242
    v_mov_b32 v65, v242
    v_mov_b32 v66, v242
    v_mov_b32 v67, v242
    v_and_b32 v222, 1, v224
    v_lshlrev_b32 v222, 5, v222
    v_and_b32 v223, 16, v224
    v_add_u32 v222, v222, v223
    v_and_b32 v223, 2, v224
    v_lshl_add_u32 v222, v223, 2, v222
    v_lshl_add_u32 v222, v220, 7, v222
    v_and_b32 v223, 8, v224
    v_lshl_add_u32 v222, v223, 3, v222
    s_lshr_b32 s6, s78, 1
    s_lshl_b32 s6, s6, 11
    v_add_u32 v240, s6, v222
    v_xor_b32 v241, 64, v240
    v_mov_b32 v68, v242
    v_mov_b32 v69, v242
    v_mov_b32 v70, v242
    v_mov_b32 v71, v242
    v_mov_b32 v72, v242
    v_mov_b32 v73, v242
    v_mov_b32 v74, v242
    v_mov_b32 v75, v242
    v_mov_b32 v76, v242
    v_readfirstlane_b32 s81, v244
    v_mov_b32 v246, 0xdddddddd
    v_and_b32 v222, 32, v224
    v_lshlrev_b32 v222, 3, v222
    v_and_b32 v223, 0xf0, v225
    v_add_u32 v254, v222, v223
    v_and_b32 v248, 0x7c, v239
    v_mov_b32 v77, v242
    v_mov_b32 v78, v242
    v_mov_b32 v79, v242
    v_mov_b32 v80, v242
    v_mov_b32 v81, v242
    v_mov_b32 v82, v242
    v_mov_b32 v83, v242
    v_mov_b32 v84, v242
    v_mov_b32 v85, v242
    s_and_b32 s6, s78, 1
    s_lshl1_add_u32 s6, s85, s6
    s_lshl_b32 s40, s6, 7
    s_add_u32 s40, s40, 16384
    s_mul_i32 s98, s6, 120832
    s_lshr_b32 s6, s78, 1
    s_lshl_b32 s6, s6, 10
    s_add_u32 s98, s98, s6
    s_add_u32 s98, s98, 262144
    s_lshl_b32 s6, s78, 13
    s_mov_b32 s39, 0
    s_xor_b32 s6, s6, s39
    s_mov_b32 s36, 0
    s_add_u32 s37, s6, 32768
    s_add_u32 s38, s6, 98304
    s_mov_b32 s42, 0xffff
    s_mov_b32 s43, 0xffff
    v_mov_b32 v86, v242
    v_mov_b32 v87, v242
    v_mov_b32 v88, v242
    v_mov_b32 v89, v242
    v_mov_b32 v90, v242
    v_mov_b32 v91, v242
    v_mov_b32 v92, v242
    v_mov_b32 v93, v242
    v_mov_b32 v94, v242
    v_mov_b32 v95, v242
    s_barrier
    s_add_u32 s96, s36, 0
    s_and_b32 s96, s96, 7
    s_lshl_b32 s96, s96, 10
    s_add_u32 s96, s96, s37
    buffer_load_dwordx4 v[0:3], v225, s[20:23], s96 offen sc1
    s_add_u32 s96, s36, 1
    s_and_b32 s96, s96, 7
    s_lshl_b32 s96, s96, 10
    s_add_u32 s96, s96, s37
    buffer_load_dwordx4 v[4:7], v225, s[20:23], s96 offen sc1
    s_add_u32 s96, s36, 0
    s_and_b32 s96, s96, 7
    s_lshl_b32 s96, s96, 10
    s_add_u32 s96, s96, s38
    s_mov_b64 exec, s[42:43]
    buffer_load_dwordx4 v[32:35], v254, s[20:23], s96 offen offset:0 sc1
    buffer_load_dwordx4 v[36:39], v254, s[20:23], s96 offen offset:512 sc1
    s_mov_b64 exec, -1
    s_add_u32 s96, s36, 2
    s_and_b32 s96, s96, 7
    s_lshl_b32 s96, s96, 10
    s_add_u32 s96, s96, s37
    buffer_load_dwordx4 v[8:11], v225, s[20:23], s96 offen sc1
    s_add_u32 s96, s36, 1
    s_and_b32 s96, s96, 7
    s_lshl_b32 s96, s96, 10
    s_add_u32 s96, s96, s38
    s_mov_b64 exec, s[42:43]
    buffer_load_dwordx4 v[40:43], v254, s[20:23], s96 offen offset:0 sc1
    buffer_load_dwordx4 v[44:47], v254, s[20:23], s96 offen offset:512 sc1
    s_mov_b64 exec, -1
    s_add_u32 s96, s36, 3
    s_and_b32 s96, s96, 7
    s_lshl_b32 s96, s96, 10
    s_add_u32 s96, s96, s37
    buffer_load_dwordx4 v[12:15], v225, s[20:23], s96 offen sc1
    s_add_u32 s96, s36, 2
    s_and_b32 s96, s96, 7
    s_lshl_b32 s96, s96, 10
    s_add_u32 s96, s96, s38
    s_mov_b64 exec, s[42:43]
    buffer_load_dwordx4 v[48:51], v254, s[20:23], s96 offen offset:0 sc1
    buffer_load_dwordx4 v[52:55], v254, s[20:23], s96 offen offset:512 sc1
    s_mov_b64 exec, -1
    s_add_u32 s96, s36, 4
    s_and_b32 s96, s96, 7
    s_lshl_b32 s96, s96, 10
    s_add_u32 s96, s96, s37
    buffer_load_dwordx4 v[16:19], v225, s[20:23], s96 offen sc1
    s_mov_b32 s44, 0x80000000
    s_mov_b32 s45, 0x80000000
    s_mov_b32 s46, 0x80000000
    s_waitcnt lgkmcnt(0)
    s_barrier
    s_add_u32 s96, s36, 3
    s_and_b32 s96, s96, 7
    s_lshl_b32 s96, s96, 10
    s_add_u32 s96, s96, s38
    s_mov_b64 exec, s[42:43]
    buffer_load_dwordx4 v[56:59], v254, s[20:23], s96 offen offset:0 sc1
    buffer_load_dwordx4 v[60:63], v254, s[20:23], s96 offen offset:512 sc1
    s_mov_b64 exec, -1
    s_add_u32 s96, s36, 5
    s_and_b32 s96, s96, 7
    s_lshl_b32 s96, s96, 10
    s_add_u32 s96, s96, s37
    buffer_load_dwordx4 v[20:23], v225, s[20:23], s96 offen sc1
    s_add_u32 s96, s36, 4
    s_and_b32 s96, s96, 7
    s_lshl_b32 s96, s96, 10
    s_add_u32 s96, s96, s38
    s_mov_b64 exec, s[42:43]
    buffer_load_dwordx4 v[64:67], v254, s[20:23], s96 offen offset:0 sc1
    buffer_load_dwordx4 v[68:71], v254, s[20:23], s96 offen offset:512 sc1
    s_mov_b64 exec, -1
    s_add_u32 s96, s36, 6
    s_and_b32 s96, s96, 7
    s_lshl_b32 s96, s96, 10
    s_add_u32 s96, s96, s37
    buffer_load_dwordx4 v[24:27], v225, s[20:23], s96 offen sc1
    s_add_u32 s96, s36, 5
    s_and_b32 s96, s96, 7
    s_lshl_b32 s96, s96, 10
    s_add_u32 s96, s96, s38
    s_mov_b64 exec, s[42:43]
    buffer_load_dwordx4 v[72:75], v254, s[20:23], s96 offen offset:0 sc1
    buffer_load_dwordx4 v[76:79], v254, s[20:23], s96 offen offset:512 sc1
    s_mov_b64 exec, -1
    s_add_u32 s96, s36, 7
    s_and_b32 s96, s96, 7
    s_lshl_b32 s96, s96, 10
    s_add_u32 s96, s96, s37
    buffer_load_dwordx4 v[28:31], v225, s[20:23], s96 offen sc1
    s_add_u32 s96, s36, 6
    s_and_b32 s96, s96, 7
    s_lshl_b32 s96, s96, 10
    s_add_u32 s96, s96, s38
    s_mov_b64 exec, s[42:43]
    buffer_load_dwordx4 v[80:83], v254, s[20:23], s96 offen offset:0 sc1
    buffer_load_dwordx4 v[84:87], v254, s[20:23], s96 offen offset:512 sc1
    s_mov_b64 exec, -1
    s_add_u32 s96, s36, 7
    s_and_b32 s96, s96, 7
    s_lshl_b32 s96, s96, 10
    s_add_u32 s96, s96, s38
    s_mov_b64 exec, s[42:43]
    buffer_load_dwordx4 v[88:91], v254, s[20:23], s96 offen offset:0 sc1
    buffer_load_dwordx4 v[92:95], v254, s[20:23], s96 offen offset:512 sc1
    s_mov_b64 exec, -1
    s_branch L_p1_done
L_roleB15:
    s_waitcnt lgkmcnt(0)
    s_mov_b32 s8, s52
    s_and_b32 s9, s53, 0xffff
    s_add_u32 m0, s87, 0
    s_add_u32 s96, s83, 14336
    buffer_load_dwordx4 v226, s[8:11], s83 offen offset:0 lds
    buffer_load_dwordx4 v227, s[8:11], s83 offen offset:1024 lds
    buffer_load_dwordx4 v226, s[8:11], s96 offen offset:2048 lds
    buffer_load_dwordx4 v227, s[8:11], s96 offen offset:3072 lds
    s_add_u32 s83, s83, 128
    s_cmp_lt_u32 s82, 2
    s_cselect_b32 s12, s56, s58
    s_cselect_b32 s13, s57, s59
    s_and_b32 s13, s13, 0xffff
    s_mov_b32 s14, 16384
    s_and_b32 s101, s82, 1
    s_lshl_b32 s101, s101, 10
    s_mov_b32 s16, s54
    s_and_b32 s17, s55, 0xffff
    s_add_u32 m0, s89, 131072
    s_nop 0
    buffer_load_dwordx4 v225, s[12:15], s101 offen lds
    s_add_u32 s101, s101, 2048
    s_add_u32 m0, s87, 16384
    s_add_u32 s96, s83, 14336
    buffer_load_dwordx4 v226, s[8:11], s83 offen offset:0 lds
    buffer_load_dwordx4 v227, s[8:11], s83 offen offset:1024 lds
    buffer_load_dwordx4 v226, s[8:11], s96 offen offset:2048 lds
    buffer_load_dwordx4 v227, s[8:11], s96 offen offset:3072 lds
    s_add_u32 s83, s83, 128
    s_add_u32 m0, s89, 135168
    s_nop 0
    buffer_load_dwordx4 v225, s[12:15], s101 offen lds
    s_add_u32 s101, s101, 2048
    s_add_u32 m0, s87, 32768
    s_add_u32 s96, s83, 14336
    buffer_load_dwordx4 v226, s[8:11], s83 offen offset:0 lds
    buffer_load_dwordx4 v227, s[8:11], s83 offen offset:1024 lds
    buffer_load_dwordx4 v226, s[8:11], s96 offen offset:2048 lds
    buffer_load_dwordx4 v227, s[8:11], s96 offen offset:3072 lds
    s_add_u32 s83, s83, 128
    s_add_u32 m0, s89, 139264
    s_nop 0
    buffer_load_dwordx4 v225, s[12:15], s101 offen lds
    s_add_u32 s101, s101, 2048
    s_add_u32 m0, s87, 49152
    s_add_u32 s96, s83, 14336
    buffer_load_dwordx4 v226, s[8:11], s83 offen offset:0 lds
    buffer_load_dwordx4 v227, s[8:11], s83 offen offset:1024 lds
    buffer_load_dwordx4 v226, s[8:11], s96 offen offset:2048 lds
    buffer_load_dwordx4 v227, s[8:11], s96 offen offset:3072 lds
    s_add_u32 s83, s83, 128
    s_add_u32 m0, s89, 143360
    s_nop 0
    buffer_load_dwordx4 v225, s[12:15], s101 offen lds
    s_add_u32 s101, s101, 2048
    v_and_b32 v28, 31, v224
    v_lshrrev_b32 v29, 5, v224
    v_bfe_u32 v30, v224, 1, 3
    v_xor_b32 v30, v30, v29
    v_lshlrev_b32 v30, 4, v30
    v_lshl_add_u32 v30, v28, 7, v30
    s_lshl_b32 s3, s82, 12
    v_add_u32 v232, s3, v30
    v_xor_b32 v233, 32, v232
    v_xor_b32 v234, 64, v232
    v_xor_b32 v235, 96, v232
    v_bfe_u32 v31, v224, 2, 2
    v_lshl_add_u32 v220, v29, 3, v31
    v_and_b32 v28, 17, v224
    v_and_b32 v29, 2, v224
    v_mul_u32_u24 v28, 18, v28
    v_and_b32 v28, 0x30, v28
    v_lshl_add_u32 v221, v29, 2, v28
    v_lshl_add_u32 v31, v220, 6, v221
    v_add_u32 v237, 131072, v31
    s_and_b32 s6, s2, 7
    s_bfe_u32 s7, s2, 0x20003
    s_lshl2_add_u32 s85, s6, s7
    s_lshr_b32 s86, s2, 5
    s_mov_b32 s20, s76
    s_and_b32 s21, s77, 0xffff
    s_mov_b32 s22, 0x1000000
    s_mov_b32 s23, 0x20000
    s_mov_b32 s48, s74
    s_and_b32 s49, s75, 0xffff
    s_mov_b32 s50, 0x100
    s_mov_b32 s51, 0x20000
    v_lshlrev_b32 v239, 2, v224
    v_mov_b32 v247, 0
    v_and_b32 v222, 11, v224
    v_cmp_eq_u32 vcc, 0, v222
    v_mov_b32 v223, 0x3f803f80
    s_nop 0
    v_cndmask_b32 v242, 0, v223, vcc
    v_mov_b32 v32, v242
    v_mov_b32 v33, v242
    v_mov_b32 v34, v242
    v_mov_b32 v35, v242
    v_mov_b32 v36, v242
    v_mov_b32 v37, v242
    v_mov_b32 v38, v242
    v_mov_b32 v39, v242
    v_mov_b32 v40, v242
    s_waitcnt vmcnt(10)
    s_barrier
    s_add_u32 m0, s87, 65536
    s_add_u32 s96, s83, 14336
    buffer_load_dwordx4 v226, s[8:11], s83 offen offset:0 lds
    buffer_load_dwordx4 v227, s[8:11], s83 offen offset:1024 lds
    buffer_load_dwordx4 v226, s[8:11], s96 offen offset:2048 lds
    buffer_load_dwordx4 v227, s[8:11], s96 offen offset:3072 lds
    s_add_u32 s83, s83, 128
    s_add_u32 m0, s89, 147456
    s_nop 0
    buffer_load_dwordx4 v225, s[12:15], s101 offen lds
    s_add_u32 s101, s101, 2048
    s_add_u32 m0, s87, 81920
    s_add_u32 s96, s83, 14336
    buffer_load_dwordx4 v226, s[8:11], s83 offen offset:0 lds
    buffer_load_dwordx4 v227, s[8:11], s83 offen offset:1024 lds
    buffer_load_dwordx4 v226, s[8:11], s96 offen offset:2048 lds
    buffer_load_dwordx4 v227, s[8:11], s96 offen offset:3072 lds
    s_add_u32 s83, s83, 128
    s_add_u32 m0, s89, 151552
    s_nop 0
    buffer_load_dwordx4 v225, s[12:15], s101 offen lds
    s_add_u32 s101, s101, 2048
    s_add_u32 s7, s78, 7
    s_bfe_u32 s6, s7, 0x20001
    s_lshl2_add_u32 s6, s79, s6
    s_mul_i32 s6, s6, 120832
    s_and_b32 s7, s7, 1
    s_lshl1_add_u32 s7, s80, s7
    s_lshl_b32 s7, s7, 10
    s_add_u32 s6, s6, s7
    s_add_u32 s99, s6, 262144
    v_lshlrev_b32 v249, 7, v224
    v_mov_b32 v41, v242
    v_mov_b32 v42, v242
    v_mov_b32 v43, v242
    v_mov_b32 v44, v242
    v_mov_b32 v45, v242
    v_mov_b32 v46, v242
    v_mov_b32 v47, v242
    v_mov_b32 v48, v242
    v_mov_b32 v49, v242
    s_waitcnt vmcnt(10)
    s_barrier
    s_add_u32 m0, s87, 98304
    s_add_u32 s96, s83, 14336
    buffer_load_dwordx4 v226, s[8:11], s83 offen offset:0 lds
    buffer_load_dwordx4 v227, s[8:11], s83 offen offset:1024 lds
    buffer_load_dwordx4 v226, s[8:11], s96 offen offset:2048 lds
    buffer_load_dwordx4 v227, s[8:11], s96 offen offset:3072 lds
    s_add_u32 s83, s83, 128
    s_add_u32 m0, s89, 155648
    s_nop 0
    buffer_load_dwordx4 v225, s[12:15], s101 offen lds
    s_add_u32 s101, s101, 2048
    s_add_u32 m0, s87, 114688
    s_add_u32 s96, s83, 14336
    buffer_load_dwordx4 v226, s[8:11], s83 offen offset:0 lds
    buffer_load_dwordx4 v227, s[8:11], s83 offen offset:1024 lds
    buffer_load_dwordx4 v226, s[8:11], s96 offen offset:2048 lds
    buffer_load_dwordx4 v227, s[8:11], s96 offen offset:3072 lds
    s_add_u32 s83, s83, 128
    s_add_u32 m0, s89, 159744
    s_nop 0
    buffer_load_dwordx4 v225, s[12:15], s101 offen lds
    s_add_u32 s101, s101, 2048
    buffer_load_dword v244, v247, s[48:51], 0 offen sc1
    s_mov_b32 s24, s68
    s_and_b32 s25, s69, 0xffff
    s_mov_b32 s26, 0x158000
    s_mov_b32 s27, 0x20000
    s_mov_b32 s28, s60
    s_and_b32 s29, s61, 0xffff
    s_mov_b32 s30, 0x80000
    s_mov_b32 s31, 0x20000
    s_mov_b32 s32, s72
    s_and_b32 s33, s73, 0xffff
    s_mov_b32 s34, 0x200000
    s_mov_b32 s35, 0x20000
    v_mov_b32 v243, 0x80000000
    v_mov_b32 v245, 163328
    v_writelane_b32 v243, 0, 0
    v_mov_b32 v50, v242
    v_mov_b32 v51, v242
    v_mov_b32 v52, v242
    v_mov_b32 v53, v242
    v_mov_b32 v54, v242
    v_mov_b32 v55, v242
    v_mov_b32 v56, v242
    v_mov_b32 v57, v242
    v_mov_b32 v58, v242
    v_lshrrev_b32 v222, 3, v224
    v_lshlrev_b32 v222, 10, v222
    v_and_b32 v223, 16, v224
    v_lshlrev_b32 v223, 2, v223
    v_xor_b32 v223, v223, v225
    v_and_b32 v223, 0x70, v223
    s_lshl_b32 s6, s86, 7
    v_add3_u32 v238, v222, v223, s6
    v_mov_b32 v59, v242
    v_mov_b32 v60, v242
    v_mov_b32 v61, v242
    v_mov_b32 v62, v242
    v_mov_b32 v63, v242
    v_mov_b32 v64, v242
    v_mov_b32 v65, v242
    v_mov_b32 v66, v242
    v_mov_b32 v67, v242
    s_waitcnt vmcnt(11)
    s_barrier
    v_and_b32 v222, 1, v224
    v_lshlrev_b32 v222, 5, v222
    v_and_b32 v223, 16, v224
    v_add_u32 v222, v222, v223
    v_and_b32 v223, 2, v224
    v_lshl_add_u32 v222, v223, 2, v222
    v_lshl_add_u32 v222, v220, 7, v222
    v_and_b32 v223, 8, v224
    v_lshl_add_u32 v222, v223, 3, v222
    s_lshr_b32 s6, s78, 1
    s_lshl_b32 s6, s6, 11
    v_add_u32 v240, s6, v222
    v_xor_b32 v241, 64, v240
    v_mov_b32 v68, v242
    v_mov_b32 v69, v242
    v_mov_b32 v70, v242
    v_mov_b32 v71, v242
    v_mov_b32 v72, v242
    v_mov_b32 v73, v242
    v_mov_b32 v74, v242
    v_mov_b32 v75, v242
    v_mov_b32 v76, v242
    s_waitcnt vmcnt(1)
    s_barrier
    s_barrier
    s_add_u32 m0, s89, 131072
    s_nop 0
    buffer_load_dwordx4 v231, s[16:19], s84 offen lds
    s_add_u32 s84, s84, 65536
    s_add_u32 m0, s89, 135168
    s_nop 0
    buffer_load_dwordx4 v231, s[16:19], s84 offen lds
    s_add_u32 s84, s84, 65536
    s_add_u32 m0, s89, 139264
    s_nop 0
    buffer_load_dwordx4 v231, s[16:19], s84 offen lds
    s_add_u32 s84, s84, 65536
    s_add_u32 m0, s89, 143360
    s_nop 0
    buffer_load_dwordx4 v231, s[16:19], s84 offen lds
    s_add_u32 s84, s84, 65536
    s_add_u32 m0, s89, 147456
    s_nop 0
    buffer_load_dwordx4 v231, s[16:19], s84 offen lds
    s_add_u32 s84, s84, 65536
    s_add_u32 m0, s89, 151552
    s_nop 0
    buffer_load_dwordx4 v231, s[16:19], s84 offen lds
    s_add_u32 s84, s84, 65536
    s_add_u32 m0, s89, 155648
    s_nop 0
    buffer_load_dwordx4 v231, s[16:19], s84 offen lds
    s_add_u32 s84, s84, 65536
    s_add_u32 m0, s89, 159744
    s_nop 0
    buffer_load_dwordx4 v231, s[16:19], s84 offen lds
    s_add_u32 s84, s84, 65536
    s_waitcnt vmcnt(8)
    s_mov_b32 s92, 0
L_tagB15:
    v_readfirstlane_b32 s81, v244
    s_cmp_lg_u32 s81, 0
    s_cbranch_scc1 L_tag_okB15
    s_add_u32 s92, s92, 1
    s_cmp_gt_u32 s92, 0x100000
    s_cbranch_scc1 L_tag_okB15
    s_sleep 4
    buffer_load_dword v244, v247, s[48:51], 0 offen sc1
    s_waitcnt vmcnt(0)
    s_branch L_tagB15
L_tag_okB15:
    s_setprio 0
    v_readfirstlane_b32 s81, v244
    v_mov_b32 v246, 0xdddddddd
    v_and_b32 v222, 32, v224
    v_lshlrev_b32 v222, 3, v222
    v_and_b32 v223, 0xf0, v225
    v_add_u32 v254, v222, v223
    v_and_b32 v248, 0x7c, v239
    v_mov_b32 v77, v242
    v_mov_b32 v78, v242
    v_mov_b32 v79, v242
    v_mov_b32 v80, v242
    v_mov_b32 v81, v242
    v_mov_b32 v82, v242
    v_mov_b32 v83, v242
    v_mov_b32 v84, v242
    v_mov_b32 v85, v242
    s_and_b32 s6, s78, 1
    s_lshl1_add_u32 s6, s85, s6
    s_lshl_b32 s40, s6, 7
    s_add_u32 s40, s40, 16384
    s_mul_i32 s98, s6, 120832
    s_lshr_b32 s6, s78, 1
    s_lshl_b32 s6, s6, 10
    s_add_u32 s98, s98, s6
    s_add_u32 s98, s98, 262144
    s_lshl_b32 s6, s78, 13
    s_mov_b32 s39, 0
    s_xor_b32 s6, s6, s39
    s_mov_b32 s36, 0
    s_add_u32 s37, s6, 32768
    s_add_u32 s38, s6, 98304
    s_mov_b32 s42, 0xffff
    s_mov_b32 s43, 0xffff
    v_mov_b32 v86, v242
    v_mov_b32 v87, v242
    v_mov_b32 v88, v242
    v_mov_b32 v89, v242
    v_mov_b32 v90, v242
    v_mov_b32 v91, v242
    v_mov_b32 v92, v242
    v_mov_b32 v93, v242
    v_mov_b32 v94, v242
    v_mov_b32 v95, v242
    s_waitcnt vmcnt(0)
    s_barrier
    ds_read_b128 v[192:195], v232
    ds_read_b64_tr_b16 v[196:197], v237 offset:0
    ds_read_b64_tr_b16 v[198:199], v237 offset:256
    s_waitcnt lgkmcnt(0)
    v_mfma_f32_32x32x16_bf16 v[128:143], v[196:199], v[192:195], 0
    ds_read_b128 v[0:3], v233
    ds_read_b64_tr_b16 v[4:5], v237 offset:1024
    ds_read_b64_tr_b16 v[6:7], v237 offset:1280
    s_waitcnt lgkmcnt(0)
    v_mfma_f32_32x32x16_bf16 v[128:143], v[4:7], v[0:3], v[128:143]
    ds_read_b128 v[192:195], v234
    ds_read_b64_tr_b16 v[196:197], v237 offset:2048
    ds_read_b64_tr_b16 v[198:199], v237 offset:2304
    s_waitcnt lgkmcnt(0)
    v_mfma_f32_32x32x16_bf16 v[128:143], v[196:199], v[192:195], v[128:143]
    ds_read_b128 v[0:3], v235
    ds_read_b64_tr_b16 v[4:5], v237 offset:3072
    ds_read_b64_tr_b16 v[6:7], v237 offset:3328
    v_add_u32 v232, 16384, v232
    v_add_u32 v233, 16384, v233
    v_add_u32 v234, 16384, v234
    v_add_u32 v235, 16384, v235
    v_add_u32 v237, 4096, v237
    s_waitcnt lgkmcnt(0)
    v_mfma_f32_32x32x16_bf16 v[128:143], v[4:7], v[0:3], v[128:143]
    ds_read_b128 v[192:195], v232
    ds_read_b64_tr_b16 v[196:197], v237 offset:0
    ds_read_b64_tr_b16 v[198:199], v237 offset:256
    s_waitcnt lgkmcnt(0)
    v_mfma_f32_32x32x16_bf16 v[128:143], v[196:199], v[192:195], v[128:143]
    ds_read_b128 v[0:3], v233
    ds_read_b64_tr_b16 v[4:5], v237 offset:1024
    ds_read_b64_tr_b16 v[6:7], v237 offset:1280
    s_waitcnt lgkmcnt(0)
    v_mfma_f32_32x32x16_bf16 v[128:143], v[4:7], v[0:3], v[128:143]
    ds_read_b128 v[192:195], v234
    ds_read_b64_tr_b16 v[196:197], v237 offset:2048
    ds_read_b64_tr_b16 v[198:199], v237 offset:2304
    s_waitcnt lgkmcnt(0)
    v_mfma_f32_32x32x16_bf16 v[128:143], v[196:199], v[192:195], v[128:143]
    ds_read_b128 v[0:3], v235
    ds_read_b64_tr_b16 v[4:5], v237 offset:3072
    ds_read_b64_tr_b16 v[6:7], v237 offset:3328
    v_add_u32 v232, 16384, v232
    v_add_u32 v233, 16384, v233
    v_add_u32 v234, 16384, v234
    v_add_u32 v235, 16384, v235
    v_add_u32 v237, 4096, v237
    s_waitcnt lgkmcnt(0)
    v_mfma_f32_32x32x16_bf16 v[128:143], v[4:7], v[0:3], v[128:143]
    ds_read_b128 v[192:195], v232
    ds_read_b64_tr_b16 v[196:197], v237 offset:0
    ds_read_b64_tr_b16 v[198:199], v237 offset:256
    s_waitcnt lgkmcnt(0)
    v_mfma_f32_32x32x16_bf16 v[128:143], v[196:199], v[192:195], v[128:143]
    ds_read_b128 v[0:3], v233
    ds_read_b64_tr_b16 v[4:5], v237 offset:1024
    ds_read_b64_tr_b16 v[6:7], v237 offset:1280
    s_waitcnt lgkmcnt(0)
    v_mfma_f32_32x32x16_bf16 v[128:143], v[4:7], v[0:3], v[128:143]
    ds_read_b128 v[192:195], v234
    ds_read_b64_tr_b16 v[196:197], v237 offset:2048
    ds_read_b64_tr_b16 v[198:199], v237 offset:2304
    s_waitcnt lgkmcnt(0)
    v_mfma_f32_32x32x16_bf16 v[128:143], v[196:199], v[192:195], v[128:143]
    ds_read_b128 v[0:3], v235
    ds_read_b64_tr_b16 v[4:5], v237 offset:3072
    ds_read_b64_tr_b16 v[6:7], v237 offset:3328
    v_add_u32 v232, 16384, v232
    v_add_u32 v233, 16384, v233
    v_add_u32 v234, 16384, v234
    v_add_u32 v235, 16384, v235
    v_add_u32 v237, 4096, v237
    s_waitcnt lgkmcnt(0)
    v_mfma_f32_32x32x16_bf16 v[128:143], v[4:7], v[0:3], v[128:143]
    ds_read_b128 v[192:195], v232
    ds_read_b64_tr_b16 v[196:197], v237 offset:0
    ds_read_b64_tr_b16 v[198:199], v237 offset:256
    s_waitcnt lgkmcnt(0)
    v_mfma_f32_32x32x16_bf16 v[128:143], v[196:199], v[192:195], v[128:143]
    ds_read_b128 v[0:3], v233
    ds_read_b64_tr_b16 v[4:5], v237 offset:1024
    ds_read_b64_tr_b16 v[6:7], v237 offset:1280
    s_waitcnt lgkmcnt(0)
    v_mfma_f32_32x32x16_bf16 v[128:143], v[4:7], v[0:3], v[128:143]
    ds_read_b128 v[192:195], v234
    ds_read_b64_tr_b16 v[196:197], v237 offset:2048
    ds_read_b64_tr_b16 v[198:199], v237 offset:2304
    s_waitcnt lgkmcnt(0)
    v_mfma_f32_32x32x16_bf16 v[128:143], v[196:199], v[192:195], v[128:143]
    ds_read_b128 v[0:3], v235
    ds_read_b64_tr_b16 v[4:5], v237 offset:3072
    ds_read_b64_tr_b16 v[6:7], v237 offset:3328
    v_add_u32 v232, 16384, v232
    v_add_u32 v233, 16384, v233
    v_add_u32 v234, 16384, v234
    v_add_u32 v235, 16384, v235
    v_add_u32 v237, 4096, v237
    s_waitcnt lgkmcnt(0)
    v_mfma_f32_32x32x16_bf16 v[128:143], v[4:7], v[0:3], v[128:143]
    ds_read_b128 v[192:195], v232
    ds_read_b64_tr_b16 v[196:197], v237 offset:0
    ds_read_b64_tr_b16 v[198:199], v237 offset:256
    s_waitcnt lgkmcnt(0)
    v_mfma_f32_32x32x16_bf16 v[128:143], v[196:199], v[192:195], v[128:143]
    ds_read_b128 v[0:3], v233
    ds_read_b64_tr_b16 v[4:5], v237 offset:1024
    ds_read_b64_tr_b16 v[6:7], v237 offset:1280
    s_waitcnt lgkmcnt(0)
    v_mfma_f32_32x32x16_bf16 v[128:143], v[4:7], v[0:3], v[128:143]
    ds_read_b128 v[192:195], v234
    ds_read_b64_tr_b16 v[196:197], v237 offset:2048
    ds_read_b64_tr_b16 v[198:199], v237 offset:2304
    s_waitcnt lgkmcnt(0)
    v_mfma_f32_32x32x16_bf16 v[128:143], v[196:199], v[192:195], v[128:143]
    ds_read_b128 v[0:3], v235
    ds_read_b64_tr_b16 v[4:5], v237 offset:3072
    ds_read_b64_tr_b16 v[6:7], v237 offset:3328
    v_add_u32 v232, 16384, v232
    v_add_u32 v233, 16384, v233
    v_add_u32 v234, 16384, v234
    v_add_u32 v235, 16384, v235
    v_add_u32 v237, 4096, v237
    s_waitcnt lgkmcnt(0)
    v_mfma_f32_32x32x16_bf16 v[128:143], v[4:7], v[0:3], v[128:143]
    ds_read_b128 v[192:195], v232
    ds_read_b64_tr_b16 v[196:197], v237 offset:0
    ds_read_b64_tr_b16 v[198:199], v237 offset:256
    s_waitcnt lgkmcnt(0)
    v_mfma_f32_32x32x16_bf16 v[128:143], v[196:199], v[192:195], v[128:143]
    ds_read_b128 v[0:3], v233
    ds_read_b64_tr_b16 v[4:5], v237 offset:1024
    ds_read_b64_tr_b16 v[6:7], v237 offset:1280
    s_waitcnt lgkmcnt(0)
    v_mfma_f32_32x32x16_bf16 v[128:143], v[4:7], v[0:3], v[128:143]
    ds_read_b128 v[192:195], v234
    ds_read_b64_tr_b16 v[196:197], v237 offset:2048
    ds_read_b64_tr_b16 v[198:199], v237 offset:2304
    s_waitcnt lgkmcnt(0)
    v_mfma_f32_32x32x16_bf16 v[128:143], v[196:199], v[192:195], v[128:143]
    ds_read_b128 v[0:3], v235
    ds_read_b64_tr_b16 v[4:5], v237 offset:3072
    ds_read_b64_tr_b16 v[6:7], v237 offset:3328
    v_add_u32 v232, 16384, v232
    v_add_u32 v233, 16384, v233
    v_add_u32 v234, 16384, v234
    v_add_u32 v235, 16384, v235
    v_add_u32 v237, 4096, v237
    s_waitcnt lgkmcnt(0)
    v_mfma_f32_32x32x16_bf16 v[128:143], v[4:7], v[0:3], v[128:143]
    ds_read_b128 v[192:195], v232
    ds_read_b64_tr_b16 v[196:197], v237 offset:0
    ds_read_b64_tr_b16 v[198:199], v237 offset:256
    s_waitcnt lgkmcnt(0)
    v_mfma_f32_32x32x16_bf16 v[128:143], v[196:199], v[192:195], v[128:143]
    ds_read_b128 v[0:3], v233
    ds_read_b64_tr_b16 v[4:5], v237 offset:1024
    ds_read_b64_tr_b16 v[6:7], v237 offset:1280
    s_waitcnt lgkmcnt(0)
    v_mfma_f32_32x32x16_bf16 v[128:143], v[4:7], v[0:3], v[128:143]
    ds_read_b128 v[192:195], v234
    ds_read_b64_tr_b16 v[196:197], v237 offset:2048
    ds_read_b64_tr_b16 v[198:199], v237 offset:2304
    s_waitcnt lgkmcnt(0)
    v_mfma_f32_32x32x16_bf16 v[128:143], v[196:199], v[192:195], v[128:143]
    ds_read_b128 v[0:3], v235
    ds_read_b64_tr_b16 v[4:5], v237 offset:3072
    ds_read_b64_tr_b16 v[6:7], v237 offset:3328
    v_add_u32 v232, 16384, v232
    v_add_u32 v233, 16384, v233
    v_add_u32 v234, 16384, v234
    v_add_u32 v235, 16384, v235
    v_add_u32 v237, 4096, v237
    s_waitcnt lgkmcnt(0)
    v_mfma_f32_32x32x16_bf16 v[128:143], v[4:7], v[0:3], v[128:143]
    ds_read_b128 v[192:195], v232
    ds_read_b64_tr_b16 v[196:197], v237 offset:0
    ds_read_b64_tr_b16 v[198:199], v237 offset:256
    s_waitcnt lgkmcnt(0)
    v_mfma_f32_32x32x16_bf16 v[128:143], v[196:199], v[192:195], v[128:143]
    ds_read_b128 v[0:3], v233
    ds_read_b64_tr_b16 v[4:5], v237 offset:1024
    ds_read_b64_tr_b16 v[6:7], v237 offset:1280
    s_waitcnt lgkmcnt(0)
    v_mfma_f32_32x32x16_bf16 v[128:143], v[4:7], v[0:3], v[128:143]
    ds_read_b128 v[192:195], v234
    ds_read_b64_tr_b16 v[196:197], v237 offset:2048
    ds_read_b64_tr_b16 v[198:199], v237 offset:2304
    s_waitcnt lgkmcnt(0)
    v_mfma_f32_32x32x16_bf16 v[128:143], v[196:199], v[192:195], v[128:143]
    ds_read_b128 v[0:3], v235
    ds_read_b64_tr_b16 v[4:5], v237 offset:3072
    ds_read_b64_tr_b16 v[6:7], v237 offset:3328
    s_waitcnt lgkmcnt(0)
    v_mfma_f32_32x32x16_bf16 v[128:143], v[4:7], v[0:3], v[128:143]
    s_cmp_eq_u32 s78, 7
    s_cbranch_scc0 L_nopollB15
    s_mov_b32 s92, 0
    s_mov_b32 s6, 196608
L_fkB15:
    buffer_load_dwordx2 v[250:251], v249, s[20:23], s6 offen sc1
    s_waitcnt vmcnt(0)
    v_cmp_eq_u32 vcc, s81, v250
    s_cmp_eq_u64 vcc, -1
    s_cbranch_scc1 L_fk_okB15
    s_sleep 2
    s_add_u32 s92, s92, 1
    s_cmp_lt_u32 s92, 0x100000
    s_cbranch_scc1 L_fkB15
L_fk_okB15:
L_nopollB15:
    s_barrier
    v_mov_b32 v28, 0
    v_and_b32 v29, 12, v239
    v_add_u32 v29, 163328, v29
    s_cmp_eq_u32 s78, 7
    s_cbranch_scc0 L_noknB15
    ds_write_b32 v29, v28
    s_nop 1
    v_max_f32_dpp v251, v251, v251 row_shr:1
    s_nop 1
    v_max_f32_dpp v251, v251, v251 row_shr:2
    s_nop 1
    v_max_f32_dpp v251, v251, v251 row_shr:4
    s_nop 1
    v_max_f32_dpp v251, v251, v251 row_shr:8
    s_nop 1
    v_max_f32_dpp v251, v251, v251 row_bcast:15 row_mask:0xa
    s_nop 1
    v_max_f32_dpp v251, v251, v251 row_bcast:31 row_mask:0xc
    s_mov_b32 s6, 163360
    v_mov_b32 v250, 163376
    v_writelane_b32 v250, s6, 63
    ds_write_b32 v250, v251
L_noknB15:
    s_add_u32 s96, s36, 0
    s_and_b32 s96, s96, 7
    s_lshl_b32 s96, s96, 10
    s_add_u32 s96, s96, s37
    buffer_load_dwordx4 v[0:3], v225, s[20:23], s96 offen sc1
    s_add_u32 s96, s36, 1
    s_and_b32 s96, s96, 7
    s_lshl_b32 s96, s96, 10
    s_add_u32 s96, s96, s37
    buffer_load_dwordx4 v[4:7], v225, s[20:23], s96 offen sc1
    s_add_u32 s96, s36, 0
    s_and_b32 s96, s96, 7
    s_lshl_b32 s96, s96, 10
    s_add_u32 s96, s96, s38
    s_mov_b64 exec, s[42:43]
    buffer_load_dwordx4 v[32:35], v254, s[20:23], s96 offen offset:0 sc1
    buffer_load_dwordx4 v[36:39], v254, s[20:23], s96 offen offset:512 sc1
    s_mov_b64 exec, -1
    s_add_u32 s96, s36, 2
    s_and_b32 s96, s96, 7
    s_lshl_b32 s96, s96, 10
    s_add_u32 s96, s96, s37
    buffer_load_dwordx4 v[8:11], v225, s[20:23], s96 offen sc1
    s_add_u32 s96, s36, 1
    s_and_b32 s96, s96, 7
    s_lshl_b32 s96, s96, 10
    s_add_u32 s96, s96, s38
    s_mov_b64 exec, s[42:43]
    buffer_load_dwordx4 v[40:43], v254, s[20:23], s96 offen offset:0 sc1
    buffer_load_dwordx4 v[44:47], v254, s[20:23], s96 offen offset:512 sc1
    s_mov_b64 exec, -1
    s_add_u32 s96, s36, 3
    s_and_b32 s96, s96, 7
    s_lshl_b32 s96, s96, 10
    s_add_u32 s96, s96, s37
    buffer_load_dwordx4 v[12:15], v225, s[20:23], s96 offen sc1
    s_add_u32 s96, s36, 2
    s_and_b32 s96, s96, 7
    s_lshl_b32 s96, s96, 10
    s_add_u32 s96, s96, s38
    s_mov_b64 exec, s[42:43]
    buffer_load_dwordx4 v[48:51], v254, s[20:23], s96 offen offset:0 sc1
    buffer_load_dwordx4 v[52:55], v254, s[20:23], s96 offen offset:512 sc1
    s_mov_b64 exec, -1
    s_add_u32 s96, s36, 4
    s_and_b32 s96, s96, 7
    s_lshl_b32 s96, s96, 10
    s_add_u32 s96, s96, s37
    buffer_load_dwordx4 v[16:19], v225, s[20:23], s96 offen sc1
    v_mov_b32 v222, 0x3eb8aa3b
    v_mov_b32 v223, 0x3eb8aa3b
    s_nop 9
    v_pk_mul_f32 v[128:129], v[128:129], v[222:223]
    v_pk_mul_f32 v[130:131], v[130:131], v[222:223]
    v_pk_mul_f32 v[132:133], v[132:133], v[222:223]
    v_pk_mul_f32 v[134:135], v[134:135], v[222:223]
    v_pk_mul_f32 v[136:137], v[136:137], v[222:223]
    v_pk_mul_f32 v[138:139], v[138:139], v[222:223]
    v_pk_mul_f32 v[140:141], v[140:141], v[222:223]
    v_pk_mul_f32 v[142:143], v[142:143], v[222:223]
    v_cvt_pk_bf16_f32 v168, v128, v129
    v_cvt_pk_bf16_f32 v169, v130, v131
    v_cvt_pk_bf16_f32 v170, v132, v133
    v_cvt_pk_bf16_f32 v171, v134, v135
    v_cvt_pk_bf16_f32 v172, v136, v137
    v_cvt_pk_bf16_f32 v173, v138, v139
    v_cvt_pk_bf16_f32 v174, v140, v141
    v_cvt_pk_bf16_f32 v175, v142, v143
    s_lshl_b32 s3, s82, 11
    s_add_u32 s3, s3, 151552
    v_add_u32 v252, s3, v225
    ds_write_b128 v252, v[168:171]
    ds_write_b128 v252, v[172:175] offset:1024
    v_pk_mul_f32 v[160:161], v[128:129], v[128:129]
    v_pk_fma_f32 v[160:161], v[130:131], v[130:131], v[160:161]
    v_pk_fma_f32 v[160:161], v[132:133], v[132:133], v[160:161]
    v_pk_fma_f32 v[160:161], v[134:135], v[134:135], v[160:161]
    v_pk_mul_f32 v[162:163], v[136:137], v[136:137]
    v_pk_fma_f32 v[162:163], v[138:139], v[138:139], v[162:163]
    v_pk_fma_f32 v[162:163], v[140:141], v[140:141], v[162:163]
    v_pk_fma_f32 v[162:163], v[142:143], v[142:143], v[162:163]
    v_add_f32 v160, v160, v161
    v_add_f32 v162, v162, v163
    v_mov_b32 v161, v160
    v_mov_b32 v163, v162
    s_nop 1
    v_permlane32_swap_b32 v160, v161
    v_permlane32_swap_b32 v162, v163
    s_nop 1
    v_add_f32 v160, v160, v161
    v_add_f32 v162, v162, v163
    v_max_f32 v160, v160, v162
    s_nop 1
    v_max_f32_dpp v160, v160, v160 row_shr:1
    s_nop 1
    v_max_f32_dpp v160, v160, v160 row_shr:2
    s_nop 1
    v_max_f32_dpp v160, v160, v160 row_shr:4
    s_nop 1
    v_max_f32_dpp v160, v160, v160 row_shr:8
    s_nop 1
    v_max_f32_dpp v160, v160, v160 row_bcast:15 row_mask:0xa
    s_lshl_b32 s3, s82, 2
    s_add_u32 s3, s3, 163344
    v_mov_b32 v161, 163376
    v_writelane_b32 v161, s3, 31
    ds_write_b32 v161, v160
    s_mov_b32 s44, 0x80000000
    s_mov_b32 s45, 0x80000000
    s_mov_b32 s46, 0x80000000
    s_waitcnt lgkmcnt(0)
    s_barrier
    s_add_u32 s96, s36, 3
    s_and_b32 s96, s96, 7
    s_lshl_b32 s96, s96, 10
    s_add_u32 s96, s96, s38
    s_mov_b64 exec, s[42:43]
    buffer_load_dwordx4 v[56:59], v254, s[20:23], s96 offen offset:0 sc1
    buffer_load_dwordx4 v[60:63], v254, s[20:23], s96 offen offset:512 sc1
    s_mov_b64 exec, -1
    s_add_u32 s96, s36, 5
    s_and_b32 s96, s96, 7
    s_lshl_b32 s96, s96, 10
    s_add_u32 s96, s96, s37
    buffer_load_dwordx4 v[20:23], v225, s[20:23], s96 offen sc1
    s_add_u32 s96, s36, 4
    s_and_b32 s96, s96, 7
    s_lshl_b32 s96, s96, 10
    s_add_u32 s96, s96, s38
    s_mov_b64 exec, s[42:43]
    buffer_load_dwordx4 v[64:67], v254, s[20:23], s96 offen offset:0 sc1
    buffer_load_dwordx4 v[68:71], v254, s[20:23], s96 offen offset:512 sc1
    s_mov_b64 exec, -1
    s_add_u32 s96, s36, 6
    s_and_b32 s96, s96, 7
    s_lshl_b32 s96, s96, 10
    s_add_u32 s96, s96, s37
    buffer_load_dwordx4 v[24:27], v225, s[20:23], s96 offen sc1
    s_add_u32 s96, s36, 5
    s_and_b32 s96, s96, 7
    s_lshl_b32 s96, s96, 10
    s_add_u32 s96, s96, s38
    s_mov_b64 exec, s[42:43]
    buffer_load_dwordx4 v[72:75], v254, s[20:23], s96 offen offset:0 sc1
    buffer_load_dwordx4 v[76:79], v254, s[20:23], s96 offen offset:512 sc1
    s_mov_b64 exec, -1
    s_add_u32 s96, s36, 7
    s_and_b32 s96, s96, 7
    s_lshl_b32 s96, s96, 10
    s_add_u32 s96, s96, s37
    buffer_load_dwordx4 v[28:31], v225, s[20:23], s96 offen sc1
    s_add_u32 s96, s36, 6
    s_and_b32 s96, s96, 7
    s_lshl_b32 s96, s96, 10
    s_add_u32 s96, s96, s38
    s_mov_b64 exec, s[42:43]
    buffer_load_dwordx4 v[80:83], v254, s[20:23], s96 offen offset:0 sc1
    buffer_load_dwordx4 v[84:87], v254, s[20:23], s96 offen offset:512 sc1
    s_mov_b64 exec, -1
    s_add_u32 s96, s36, 7
    s_and_b32 s96, s96, 7
    s_lshl_b32 s96, s96, 10
    s_add_u32 s96, s96, s38
    s_mov_b64 exec, s[42:43]
    buffer_load_dwordx4 v[88:91], v254, s[20:23], s96 offen offset:0 sc1
    buffer_load_dwordx4 v[92:95], v254, s[20:23], s96 offen offset:512 sc1
    s_mov_b64 exec, -1
    s_branch L_p1_done
L_hot_end:
L_slow:
    s_waitcnt vmcnt(0) lgkmcnt(0)
    v_and_b32 v236, 0x7c, v239
    v_add_u32 v236, 159744, v236
    s_lshl_b32 s3, s78, 7
    v_add_u32 v237, s3, v236
    v_mov_b32 v232, 0xff800000
    ds_write_b32 v237, v232
    s_waitcnt lgkmcnt(0)
    s_barrier
    v_add_u32 v237, 151552, v225
    s_mov_b32 s6, 0
L_slow_q:
    ds_read_b128 v[220:223], v237
    v_mov_b32 v232, 0xff800000
    s_waitcnt lgkmcnt(0)
    v_mfma_f32_32x32x16_bf16 v[96:111], v[0:3], v[220:223], 0
    s_nop 11
    v_max3_f32 v232, v96, v97, v232
    v_max3_f32 v232, v98, v99, v232
    v_max3_f32 v232, v100, v101, v232
    v_max3_f32 v232, v102, v103, v232
    v_max3_f32 v232, v104, v105, v232
    v_max3_f32 v232, v106, v107, v232
    v_max3_f32 v232, v108, v109, v232
    v_max3_f32 v232, v110, v111, v232
    v_mfma_f32_32x32x16_bf16 v[96:111], v[4:7], v[220:223], 0
    s_nop 11
    v_max3_f32 v232, v96, v97, v232
    v_max3_f32 v232, v98, v99, v232
    v_max3_f32 v232, v100, v101, v232
    v_max3_f32 v232, v102, v103, v232
    v_max3_f32 v232, v104, v105, v232
    v_max3_f32 v232, v106, v107, v232
    v_max3_f32 v232, v108, v109, v232
    v_max3_f32 v232, v110, v111, v232
    v_mfma_f32_32x32x16_bf16 v[96:111], v[8:11], v[220:223], 0
    s_nop 11
    v_max3_f32 v232, v96, v97, v232
    v_max3_f32 v232, v98, v99, v232
    v_max3_f32 v232, v100, v101, v232
    v_max3_f32 v232, v102, v103, v232
    v_max3_f32 v232, v104, v105, v232
    v_max3_f32 v232, v106, v107, v232
    v_max3_f32 v232, v108, v109, v232
    v_max3_f32 v232, v110, v111, v232
    v_mfma_f32_32x32x16_bf16 v[96:111], v[12:15], v[220:223], 0
    s_nop 11
    v_max3_f32 v232, v96, v97, v232
    v_max3_f32 v232, v98, v99, v232
    v_max3_f32 v232, v100, v101, v232
    v_max3_f32 v232, v102, v103, v232
    v_max3_f32 v232, v104, v105, v232
    v_max3_f32 v232, v106, v107, v232
    v_max3_f32 v232, v108, v109, v232
    v_max3_f32 v232, v110, v111, v232
    v_mfma_f32_32x32x16_bf16 v[96:111], v[16:19], v[220:223], 0
    s_nop 11
    v_max3_f32 v232, v96, v97, v232
    v_max3_f32 v232, v98, v99, v232
    v_max3_f32 v232, v100, v101, v232
    v_max3_f32 v232, v102, v103, v232
    v_max3_f32 v232, v104, v105, v232
    v_max3_f32 v232, v106, v107, v232
    v_max3_f32 v232, v108, v109, v232
    v_max3_f32 v232, v110, v111, v232
    v_mfma_f32_32x32x16_bf16 v[96:111], v[20:23], v[220:223], 0
    s_nop 11
    v_max3_f32 v232, v96, v97, v232
    v_max3_f32 v232, v98, v99, v232
    v_max3_f32 v232, v100, v101, v232
    v_max3_f32 v232, v102, v103, v232
    v_max3_f32 v232, v104, v105, v232
    v_max3_f32 v232, v106, v107, v232
    v_max3_f32 v232, v108, v109, v232
    v_max3_f32 v232, v110, v111, v232
    v_mfma_f32_32x32x16_bf16 v[96:111], v[24:27], v[220:223], 0
    s_nop 11
    v_max3_f32 v232, v96, v97, v232
    v_max3_f32 v232, v98, v99, v232
    v_max3_f32 v232, v100, v101, v232
    v_max3_f32 v232, v102, v103, v232
    v_max3_f32 v232, v104, v105, v232
    v_max3_f32 v232, v106, v107, v232
    v_max3_f32 v232, v108, v109, v232
    v_max3_f32 v232, v110, v111, v232
    v_mfma_f32_32x32x16_bf16 v[96:111], v[28:31], v[220:223], 0
    s_nop 11
    v_max3_f32 v232, v96, v97, v232
    v_max3_f32 v232, v98, v99, v232
    v_max3_f32 v232, v100, v101, v232
    v_max3_f32 v232, v102, v103, v232
    v_max3_f32 v232, v104, v105, v232
    v_max3_f32 v232, v106, v107, v232
    v_max3_f32 v232, v108, v109, v232
    v_max3_f32 v232, v110, v111, v232
    ds_max_f32 v236, v232
    v_add_u32 v236, 128, v236
    v_add_u32 v237, 1024, v237
    s_add_u32 s6, s6, 1
    s_cmp_lt_u32 s6, 8
    s_cbranch_scc1 L_slow_q
    s_waitcnt lgkmcnt(0)
    s_barrier
    v_and_b32 v236, 0x7c, v239
    v_add_u32 v236, 159744, v236
    s_lshl_b32 s3, s78, 7
    v_add_u32 v237, s3, v236
    ds_read_b32 v232, v237
    s_waitcnt lgkmcnt(0)
    s_waitcnt vmcnt(23)
    v_mfma_f32_32x32x16_bf16 v[96:111], v[0:3], v[216:219], 0
    s_nop 11
    v_sub_f32 v96, v96, v232
    v_exp_f32 v96, v96
    v_sub_f32 v97, v97, v232
    v_exp_f32 v97, v97
    v_sub_f32 v98, v98, v232
    v_exp_f32 v98, v98
    v_sub_f32 v99, v99, v232
    v_exp_f32 v99, v99
    v_sub_f32 v100, v100, v232
    v_exp_f32 v100, v100
    v_sub_f32 v101, v101, v232
    v_exp_f32 v101, v101
    s_waitcnt vmcnt(22)
    v_mfma_f32_32x32x16_bf16 v[112:127], v[4:7], v[216:219], 0
    v_sub_f32 v102, v102, v232
    v_exp_f32 v102, v102
    v_sub_f32 v103, v103, v232
    v_exp_f32 v103, v103
    v_sub_f32 v104, v104, v232
    v_exp_f32 v104, v104
    v_sub_f32 v105, v105, v232
    v_exp_f32 v105, v105
    s_waitcnt vmcnt(20)
    v_smfmac_f32_32x32x32_bf16 v[128:143], v[32:35], v[96:103], v246
    v_sub_f32 v106, v106, v232
    v_exp_f32 v106, v106
    v_sub_f32 v107, v107, v232
    v_exp_f32 v107, v107
    v_sub_f32 v108, v108, v232
    v_exp_f32 v108, v108
    v_sub_f32 v109, v109, v232
    v_exp_f32 v109, v109
    s_nop 0
    v_mov_b32 v160, -1
    v_mov_b32 v161, -1
    v_mov_b32 v162, -1
    v_mov_b32 v163, -1
    buffer_store_dwordx4 v[160:163], v225, s[20:23], s99 offen sc1
    v_sub_f32 v110, v110, v232
    v_exp_f32 v110, v110
    v_sub_f32 v111, v111, v232
    v_exp_f32 v111, v111
    v_sub_f32 v112, v112, v232
    v_exp_f32 v112, v112
    v_sub_f32 v113, v113, v232
    v_exp_f32 v113, v113
    v_smfmac_f32_32x32x32_bf16 v[128:143], v[36:39], v[104:111], v246
    v_sub_f32 v114, v114, v232
    v_exp_f32 v114, v114
    v_sub_f32 v115, v115, v232
    v_exp_f32 v115, v115
    v_sub_f32 v116, v116, v232
    v_exp_f32 v116, v116
    v_sub_f32 v117, v117, v232
    v_exp_f32 v117, v117
    s_waitcnt vmcnt(20)
    v_mfma_f32_32x32x16_bf16 v[96:111], v[8:11], v[216:219], 0
    v_sub_f32 v118, v118, v232
    v_exp_f32 v118, v118
    v_sub_f32 v119, v119, v232
    v_exp_f32 v119, v119
    v_sub_f32 v120, v120, v232
    v_exp_f32 v120, v120
    v_sub_f32 v121, v121, v232
    v_exp_f32 v121, v121
    s_waitcnt vmcnt(18)
    v_smfmac_f32_32x32x32_bf16 v[128:143], v[40:43], v[112:119], v246
    buffer_store_dwordx4 v[192:195], v225, s[20:23], s44 offen offset:0 sc1
    v_sub_f32 v122, v122, v232
    v_exp_f32 v122, v122
    v_sub_f32 v123, v123, v232
    v_exp_f32 v123, v123
    v_sub_f32 v124, v124, v232
    v_exp_f32 v124, v124
    v_sub_f32 v125, v125, v232
    v_exp_f32 v125, v125
    s_nop 0
    v_sub_f32 v126, v126, v232
    v_exp_f32 v126, v126
    v_sub_f32 v127, v127, v232
    v_exp_f32 v127, v127
    v_sub_f32 v96, v96, v232
    v_exp_f32 v96, v96
    v_sub_f32 v97, v97, v232
    v_exp_f32 v97, v97
    v_smfmac_f32_32x32x32_bf16 v[128:143], v[44:47], v[120:127], v246
    v_sub_f32 v98, v98, v232
    v_exp_f32 v98, v98
    v_sub_f32 v99, v99, v232
    v_exp_f32 v99, v99
    v_sub_f32 v100, v100, v232
    v_exp_f32 v100, v100
    v_sub_f32 v101, v101, v232
    v_exp_f32 v101, v101
    s_waitcnt vmcnt(18)
    v_mfma_f32_32x32x16_bf16 v[112:127], v[12:15], v[216:219], 0
    v_sub_f32 v102, v102, v232
    v_exp_f32 v102, v102
    v_sub_f32 v103, v103, v232
    v_exp_f32 v103, v103
    v_sub_f32 v104, v104, v232
    v_exp_f32 v104, v104
    v_sub_f32 v105, v105, v232
    v_exp_f32 v105, v105
    s_waitcnt vmcnt(16)
    v_smfmac_f32_32x32x32_bf16 v[128:143], v[48:51], v[96:103], v246
    buffer_store_dwordx4 v[196:199], v225, s[20:23], s44 offen offset:1024 sc1
    v_sub_f32 v106, v106, v232
    v_exp_f32 v106, v106
    v_sub_f32 v107, v107, v232
    v_exp_f32 v107, v107
    v_sub_f32 v108, v108, v232
    v_exp_f32 v108, v108
    v_sub_f32 v109, v109, v232
    v_exp_f32 v109, v109
    s_nop 0
    v_sub_f32 v110, v110, v232
    v_exp_f32 v110, v110
    v_sub_f32 v111, v111, v232
    v_exp_f32 v111, v111
    v_sub_f32 v112, v112, v232
    v_exp_f32 v112, v112
    v_sub_f32 v113, v113, v232
    v_exp_f32 v113, v113
    v_smfmac_f32_32x32x32_bf16 v[128:143], v[52:55], v[104:111], v246
    v_sub_f32 v114, v114, v232
    v_exp_f32 v114, v114
    v_sub_f32 v115, v115, v232
    v_exp_f32 v115, v115
    v_sub_f32 v116, v116, v232
    v_exp_f32 v116, v116
    v_sub_f32 v117, v117, v232
    v_exp_f32 v117, v117
    s_waitcnt vmcnt(16)
    v_mfma_f32_32x32x16_bf16 v[96:111], v[16:19], v[216:219], 0
    v_sub_f32 v118, v118, v232
    v_exp_f32 v118, v118
    v_sub_f32 v119, v119, v232
    v_exp_f32 v119, v119
    v_sub_f32 v120, v120, v232
    v_exp_f32 v120, v120
    v_sub_f32 v121, v121, v232
    v_exp_f32 v121, v121
    s_waitcnt vmcnt(14)
    v_smfmac_f32_32x32x32_bf16 v[128:143], v[56:59], v[112:119], v246
    buffer_store_dwordx4 v[200:203], v225, s[20:23], s45 offen offset:0 sc1
    v_sub_f32 v122, v122, v232
    v_exp_f32 v122, v122
    v_sub_f32 v123, v123, v232
    v_exp_f32 v123, v123
    v_sub_f32 v124, v124, v232
    v_exp_f32 v124, v124
    v_sub_f32 v125, v125, v232
    v_exp_f32 v125, v125
    s_nop 0
    v_sub_f32 v126, v126, v232
    v_exp_f32 v126, v126
    v_sub_f32 v127, v127, v232
    v_exp_f32 v127, v127
    v_sub_f32 v96, v96, v232
    v_exp_f32 v96, v96
    v_sub_f32 v97, v97, v232
    v_exp_f32 v97, v97
    v_smfmac_f32_32x32x32_bf16 v[128:143], v[60:63], v[120:127], v246
    v_sub_f32 v98, v98, v232
    v_exp_f32 v98, v98
    v_sub_f32 v99, v99, v232
    v_exp_f32 v99, v99
    v_sub_f32 v100, v100, v232
    v_exp_f32 v100, v100
    v_sub_f32 v101, v101, v232
    v_exp_f32 v101, v101
    s_waitcnt vmcnt(14)
    v_mfma_f32_32x32x16_bf16 v[112:127], v[20:23], v[216:219], 0
    v_sub_f32 v102, v102, v232
    v_exp_f32 v102, v102
    v_sub_f32 v103, v103, v232
    v_exp_f32 v103, v103
    v_sub_f32 v104, v104, v232
    v_exp_f32 v104, v104
    v_sub_f32 v105, v105, v232
    v_exp_f32 v105, v105
    s_waitcnt vmcnt(12)
    v_smfmac_f32_32x32x32_bf16 v[128:143], v[64:67], v[96:103], v246
    buffer_store_dwordx4 v[204:207], v225, s[20:23], s45 offen offset:1024 sc1
    s_add_u32 s3, s78, 1
    s_and_b32 s3, s3, 7
    s_lshl_b32 s6, s3, 7
    v_add_u32 v237, s6, v236
    ds_read_b32 v233, v237
    s_lshl_b32 s3, s3, 10
    s_add_u32 s3, s3, 151552
    v_add_u32 v230, s3, v225
    ds_read_b128 v[220:223], v230
    v_sub_f32 v106, v106, v232
    v_exp_f32 v106, v106
    v_sub_f32 v107, v107, v232
    v_exp_f32 v107, v107
    v_sub_f32 v108, v108, v232
    v_exp_f32 v108, v108
    v_sub_f32 v109, v109, v232
    v_exp_f32 v109, v109
    s_nop 0
    v_sub_f32 v110, v110, v232
    v_exp_f32 v110, v110
    v_sub_f32 v111, v111, v232
    v_exp_f32 v111, v111
    v_sub_f32 v112, v112, v232
    v_exp_f32 v112, v112
    v_sub_f32 v113, v113, v232
    v_exp_f32 v113, v113
    v_smfmac_f32_32x32x32_bf16 v[128:143], v[68:71], v[104:111], v246
    v_sub_f32 v114, v114, v232
    v_exp_f32 v114, v114
    v_sub_f32 v115, v115, v232
    v_exp_f32 v115, v115
    v_sub_f32 v116, v116, v232
    v_exp_f32 v116, v116
    v_sub_f32 v117, v117, v232
    v_exp_f32 v117, v117
    s_waitcnt vmcnt(12)
    v_mfma_f32_32x32x16_bf16 v[96:111], v[24:27], v[216:219], 0
    v_sub_f32 v118, v118, v232
    v_exp_f32 v118, v118
    v_sub_f32 v119, v119, v232
    v_exp_f32 v119, v119
    v_sub_f32 v120, v120, v232
    v_exp_f32 v120, v120
    v_sub_f32 v121, v121, v232
    v_exp_f32 v121, v121
    s_waitcnt vmcnt(10)
    v_smfmac_f32_32x32x32_bf16 v[128:143], v[72:75], v[112:119], v246
    buffer_store_dwordx4 v[208:211], v225, s[20:23], s46 offen offset:0 sc1
    v_sub_f32 v122, v122, v232
    v_exp_f32 v122, v122
    v_sub_f32 v123, v123, v232
    v_exp_f32 v123, v123
    v_sub_f32 v124, v124, v232
    v_exp_f32 v124, v124
    v_sub_f32 v125, v125, v232
    v_exp_f32 v125, v125
    s_nop 0
    s_add_u32 s3, s78, 0
    s_and_b32 s3, s3, 7
    s_mul_i32 s3, s3, 2304
    s_add_u32 s3, s3, 98304
    v_add_u32 v226, s3, v225
    v_add_u32 v228, s3, v239
    v_sub_f32 v126, v126, v232
    v_exp_f32 v126, v126
    v_sub_f32 v127, v127, v232
    v_exp_f32 v127, v127
    v_sub_f32 v96, v96, v232
    v_exp_f32 v96, v96
    v_sub_f32 v97, v97, v232
    v_exp_f32 v97, v97
    v_smfmac_f32_32x32x32_bf16 v[128:143], v[76:79], v[120:127], v246
    v_sub_f32 v98, v98, v232
    v_exp_f32 v98, v98
    v_sub_f32 v99, v99, v232
    v_exp_f32 v99, v99
    v_sub_f32 v100, v100, v232
    v_exp_f32 v100, v100
    v_sub_f32 v101, v101, v232
    v_exp_f32 v101, v101
    s_waitcnt vmcnt(10)
    v_mfma_f32_32x32x16_bf16 v[112:127], v[28:31], v[216:219], 0
    v_sub_f32 v102, v102, v232
    v_exp_f32 v102, v102
    v_sub_f32 v103, v103, v232
    v_exp_f32 v103, v103
    v_sub_f32 v104, v104, v232
    v_exp_f32 v104, v104
    v_sub_f32 v105, v105, v232
    v_exp_f32 v105, v105
    s_waitcnt vmcnt(8)
    v_smfmac_f32_32x32x32_bf16 v[128:143], v[80:83], v[96:103], v246
    buffer_store_dwordx4 v[212:215], v225, s[20:23], s46 offen offset:1024 sc1
    v_sub_f32 v106, v106, v232
    v_exp_f32 v106, v106
    v_sub_f32 v107, v107, v232
    v_exp_f32 v107, v107
    v_sub_f32 v108, v108, v232
    v_exp_f32 v108, v108
    v_sub_f32 v109, v109, v232
    v_exp_f32 v109, v109
    s_nop 0
    s_add_u32 s3, s78, 1
    s_and_b32 s3, s3, 7
    s_mul_i32 s3, s3, 2304
    s_add_u32 s3, s3, 116736
    v_add_u32 v227, s3, v225
    v_add_u32 v229, s3, v239
    v_sub_f32 v110, v110, v232
    v_exp_f32 v110, v110
    v_sub_f32 v111, v111, v232
    v_exp_f32 v111, v111
    s_setprio 3
    v_sub_f32 v112, v112, v232
    v_exp_f32 v112, v112
    v_sub_f32 v113, v113, v232
    v_exp_f32 v113, v113
    v_smfmac_f32_32x32x32_bf16 v[128:143], v[84:87], v[104:111], v246
    s_waitcnt lgkmcnt(0)
    s_barrier
    v_sub_f32 v114, v114, v232
    v_exp_f32 v114, v114
    v_sub_f32 v115, v115, v232
    v_exp_f32 v115, v115
    v_sub_f32 v116, v116, v232
    v_exp_f32 v116, v116
    v_sub_f32 v117, v117, v232
    v_exp_f32 v117, v117
    v_mfma_f32_32x32x16_bf16 v[96:111], v[0:3], v[220:223], 0
    v_sub_f32 v118, v118, v232
    v_exp_f32 v118, v118
    v_sub_f32 v119, v119, v232
    v_exp_f32 v119, v119
    v_sub_f32 v120, v120, v232
    v_exp_f32 v120, v120
    v_sub_f32 v121, v121, v232
    v_exp_f32 v121, v121
    s_waitcnt vmcnt(7)
    v_smfmac_f32_32x32x32_bf16 v[128:143], v[88:91], v[112:119], v246
    v_sub_f32 v122, v122, v232
    v_exp_f32 v122, v122
    v_sub_f32 v123, v123, v232
    v_exp_f32 v123, v123
    v_sub_f32 v124, v124, v232
    v_exp_f32 v124, v124
    v_sub_f32 v125, v125, v232
    v_exp_f32 v125, v125
    s_nop 0
    v_sub_f32 v126, v126, v232
    v_exp_f32 v126, v126
    v_sub_f32 v127, v127, v232
    v_exp_f32 v127, v127
    v_sub_f32 v96, v96, v233
    v_exp_f32 v96, v96
    v_sub_f32 v97, v97, v233
    v_exp_f32 v97, v97
    v_smfmac_f32_32x32x32_bf16 v[128:143], v[92:95], v[120:127], v246
    v_sub_f32 v98, v98, v233
    v_exp_f32 v98, v98
    v_sub_f32 v99, v99, v233
    v_exp_f32 v99, v99
    v_sub_f32 v100, v100, v233
    v_exp_f32 v100, v100
    v_sub_f32 v101, v101, v233
    v_exp_f32 v101, v101
    v_mfma_f32_32x32x16_bf16 v[112:127], v[4:7], v[220:223], 0
    v_sub_f32 v102, v102, v233
    v_exp_f32 v102, v102
    v_sub_f32 v103, v103, v233
    v_exp_f32 v103, v103
    v_sub_f32 v104, v104, v233
    v_exp_f32 v104, v104
    v_sub_f32 v105, v105, v233
    v_exp_f32 v105, v105
    v_smfmac_f32_32x32x32_bf16 v[144:159], v[32:35], v[96:103], v246
    s_lshl_b32 s3, s78, 12
    s_add_u32 m0, s3, 65536
    s_lshl_b32 s3, s78, 15
    s_add_u32 s3, s3, 262144
    buffer_load_dwordx4 v238, s[28:31], s3 offen lds
    v_sub_f32 v106, v106, v233
    v_exp_f32 v106, v106
    v_sub_f32 v107, v107, v233
    v_exp_f32 v107, v107
    v_sub_f32 v108, v108, v233
    v_exp_f32 v108, v108
    v_sub_f32 v109, v109, v233
    v_exp_f32 v109, v109
    s_nop 0
    v_sub_f32 v110, v110, v233
    v_exp_f32 v110, v110
    v_sub_f32 v111, v111, v233
    v_exp_f32 v111, v111
    v_sub_f32 v112, v112, v233
    v_exp_f32 v112, v112
    v_sub_f32 v113, v113, v233
    v_exp_f32 v113, v113
    v_smfmac_f32_32x32x32_bf16 v[144:159], v[36:39], v[104:111], v246
    ds_write_b128 v226, v[128:131] offset:0
    v_sub_f32 v114, v114, v233
    v_exp_f32 v114, v114
    v_sub_f32 v115, v115, v233
    v_exp_f32 v115, v115
    v_sub_f32 v116, v116, v233
    v_exp_f32 v116, v116
    v_sub_f32 v117, v117, v233
    v_exp_f32 v117, v117
    v_mfma_f32_32x32x16_bf16 v[96:111], v[8:11], v[220:223], 0
    ds_write_b128 v226, v[132:135] offset:1024
    v_sub_f32 v118, v118, v233
    v_exp_f32 v118, v118
    v_sub_f32 v119, v119, v233
    v_exp_f32 v119, v119
    v_sub_f32 v120, v120, v233
    v_exp_f32 v120, v120
    v_sub_f32 v121, v121, v233
    v_exp_f32 v121, v121
    v_smfmac_f32_32x32x32_bf16 v[144:159], v[40:43], v[112:119], v246
    s_lshl_b32 s3, s78, 12
    s_add_u32 m0, s3, 66560
    s_lshl_b32 s3, s78, 15
    s_add_u32 s3, s3, 270336
    buffer_load_dwordx4 v238, s[28:31], s3 offen lds
    v_sub_f32 v122, v122, v233
    v_exp_f32 v122, v122
    v_sub_f32 v123, v123, v233
    v_exp_f32 v123, v123
    v_sub_f32 v124, v124, v233
    v_exp_f32 v124, v124
    v_sub_f32 v125, v125, v233
    v_exp_f32 v125, v125
    s_nop 0
    ds_write_b32 v228, v136 offset:2048
    v_sub_f32 v126, v126, v233
    v_exp_f32 v126, v126
    v_sub_f32 v127, v127, v233
    v_exp_f32 v127, v127
    v_sub_f32 v96, v96, v233
    v_exp_f32 v96, v96
    v_sub_f32 v97, v97, v233
    v_exp_f32 v97, v97
    v_smfmac_f32_32x32x32_bf16 v[144:159], v[44:47], v[120:127], v246
    v_sub_f32 v98, v98, v233
    v_exp_f32 v98, v98
    v_sub_f32 v99, v99, v233
    v_exp_f32 v99, v99
    v_sub_f32 v100, v100, v233
    v_exp_f32 v100, v100
    v_sub_f32 v101, v101, v233
    v_exp_f32 v101, v101
    v_mfma_f32_32x32x16_bf16 v[112:127], v[12:15], v[220:223], 0
    v_sub_f32 v102, v102, v233
    v_exp_f32 v102, v102
    v_sub_f32 v103, v103, v233
    v_exp_f32 v103, v103
    v_sub_f32 v104, v104, v233
    v_exp_f32 v104, v104
    v_sub_f32 v105, v105, v233
    v_exp_f32 v105, v105
    v_smfmac_f32_32x32x32_bf16 v[144:159], v[48:51], v[96:103], v246
    s_lshl_b32 s3, s78, 12
    s_add_u32 m0, s3, 67584
    s_lshl_b32 s3, s78, 15
    s_add_u32 s3, s3, 278528
    buffer_load_dwordx4 v238, s[28:31], s3 offen lds
    v_sub_f32 v106, v106, v233
    v_exp_f32 v106, v106
    v_sub_f32 v107, v107, v233
    v_exp_f32 v107, v107
    v_sub_f32 v108, v108, v233
    v_exp_f32 v108, v108
    v_sub_f32 v109, v109, v233
    v_exp_f32 v109, v109
    s_nop 0
    v_sub_f32 v110, v110, v233
    v_exp_f32 v110, v110
    v_sub_f32 v111, v111, v233
    v_exp_f32 v111, v111
    s_setprio 2
    v_sub_f32 v112, v112, v233
    v_exp_f32 v112, v112
    v_sub_f32 v113, v113, v233
    v_exp_f32 v113, v113
    v_smfmac_f32_32x32x32_bf16 v[144:159], v[52:55], v[104:111], v246
    v_sub_f32 v114, v114, v233
    v_exp_f32 v114, v114
    v_sub_f32 v115, v115, v233
    v_exp_f32 v115, v115
    v_sub_f32 v116, v116, v233
    v_exp_f32 v116, v116
    v_sub_f32 v117, v117, v233
    v_exp_f32 v117, v117
    v_mfma_f32_32x32x16_bf16 v[96:111], v[16:19], v[220:223], 0
    v_sub_f32 v118, v118, v233
    v_exp_f32 v118, v118
    v_sub_f32 v119, v119, v233
    v_exp_f32 v119, v119
    v_sub_f32 v120, v120, v233
    v_exp_f32 v120, v120
    v_sub_f32 v121, v121, v233
    v_exp_f32 v121, v121
    v_smfmac_f32_32x32x32_bf16 v[144:159], v[56:59], v[112:119], v246
    s_lshl_b32 s3, s78, 12
    s_add_u32 m0, s3, 68608
    s_lshl_b32 s3, s78, 15
    s_add_u32 s3, s3, 286720
    buffer_load_dwordx4 v238, s[28:31], s3 offen lds
    v_sub_f32 v122, v122, v233
    v_exp_f32 v122, v122
    v_sub_f32 v123, v123, v233
    v_exp_f32 v123, v123
    v_sub_f32 v124, v124, v233
    v_exp_f32 v124, v124
    v_sub_f32 v125, v125, v233
    v_exp_f32 v125, v125
    s_nop 0
    v_sub_f32 v126, v126, v233
    v_exp_f32 v126, v126
    v_sub_f32 v127, v127, v233
    v_exp_f32 v127, v127
    v_sub_f32 v96, v96, v233
    v_exp_f32 v96, v96
    v_sub_f32 v97, v97, v233
    v_exp_f32 v97, v97
    v_smfmac_f32_32x32x32_bf16 v[144:159], v[60:63], v[120:127], v246
    s_waitcnt vmcnt(4)
    s_lshl4_add_u32 s3, s79, s80
    s_lshl_b32 s3, s3, 5
    s_add_u32 s3, s3, s78
    s_lshl_b32 s3, s3, 2
    s_add_u32 s3, s3, 212992
    buffer_store_dword v244, v243, s[20:23], s3 offen sc1
    v_sub_f32 v98, v98, v233
    v_exp_f32 v98, v98
    v_sub_f32 v99, v99, v233
    v_exp_f32 v99, v99
    v_sub_f32 v100, v100, v233
    v_exp_f32 v100, v100
    v_sub_f32 v101, v101, v233
    v_exp_f32 v101, v101
    v_mfma_f32_32x32x16_bf16 v[112:127], v[20:23], v[220:223], 0
    v_sub_f32 v102, v102, v233
    v_exp_f32 v102, v102
    v_sub_f32 v103, v103, v233
    v_exp_f32 v103, v103
    v_sub_f32 v104, v104, v233
    v_exp_f32 v104, v104
    v_sub_f32 v105, v105, v233
    v_exp_f32 v105, v105
    v_smfmac_f32_32x32x32_bf16 v[144:159], v[64:67], v[96:103], v246
    s_add_u32 s3, s78, 2
    s_and_b32 s3, s3, 7
    s_lshl_b32 s6, s3, 7
    v_add_u32 v237, s6, v236
    ds_read_b32 v232, v237
    s_lshl_b32 s3, s3, 10
    s_add_u32 s3, s3, 151552
    v_add_u32 v230, s3, v225
    ds_read_b128 v[216:219], v230
    v_sub_f32 v106, v106, v233
    v_exp_f32 v106, v106
    v_sub_f32 v107, v107, v233
    v_exp_f32 v107, v107
    v_sub_f32 v108, v108, v233
    v_exp_f32 v108, v108
    v_sub_f32 v109, v109, v233
    v_exp_f32 v109, v109
    s_nop 0
    v_sub_f32 v110, v110, v233
    v_exp_f32 v110, v110
    v_sub_f32 v111, v111, v233
    v_exp_f32 v111, v111
    s_setprio 1
    v_sub_f32 v112, v112, v233
    v_exp_f32 v112, v112
    v_sub_f32 v113, v113, v233
    v_exp_f32 v113, v113
    v_smfmac_f32_32x32x32_bf16 v[144:159], v[68:71], v[104:111], v246
    s_lshl_b32 s3, s78, 11
    s_add_u32 m0, s3, 135168
    s_lshl_b32 s3, s78, 14
    s_add_u32 s3, s3, 1310720
    buffer_load_dwordx4 v238, s[24:27], s3 offen lds
    v_sub_f32 v114, v114, v233
    v_exp_f32 v114, v114
    v_sub_f32 v115, v115, v233
    v_exp_f32 v115, v115
    v_sub_f32 v116, v116, v233
    v_exp_f32 v116, v116
    v_sub_f32 v117, v117, v233
    v_exp_f32 v117, v117
    v_mfma_f32_32x32x16_bf16 v[96:111], v[24:27], v[220:223], 0
    v_sub_f32 v118, v118, v233
    v_exp_f32 v118, v118
    v_sub_f32 v119, v119, v233
    v_exp_f32 v119, v119
    v_sub_f32 v120, v120, v233
    v_exp_f32 v120, v120
    v_sub_f32 v121, v121, v233
    v_exp_f32 v121, v121
    v_smfmac_f32_32x32x32_bf16 v[144:159], v[72:75], v[112:119], v246
    s_add_u32 s3, s78, 2
    s_and_b32 s3, s3, 7
    s_mul_i32 s3, s3, 2304
    s_add_u32 s3, s3, 98304
    v_add_u32 v226, s3, v225
    v_add_u32 v228, s3, v239
    v_sub_f32 v122, v122, v233
    v_exp_f32 v122, v122
    v_sub_f32 v123, v123, v233
    v_exp_f32 v123, v123
    v_sub_f32 v124, v124, v233
    v_exp_f32 v124, v124
    v_sub_f32 v125, v125, v233
    v_exp_f32 v125, v125
    s_nop 0
    v_sub_f32 v126, v126, v233
    v_exp_f32 v126, v126
    v_sub_f32 v127, v127, v233
    v_exp_f32 v127, v127
    s_setprio 0
    v_sub_f32 v96, v96, v233
    v_exp_f32 v96, v96
    v_sub_f32 v97, v97, v233
    v_exp_f32 v97, v97
    v_smfmac_f32_32x32x32_bf16 v[144:159], v[76:79], v[120:127], v246
    s_lshl_b32 s3, s78, 11
    s_add_u32 m0, s3, 136192
    s_lshl_b32 s3, s78, 14
    s_add_u32 s3, s3, 1318912
    buffer_load_dwordx4 v238, s[24:27], s3 offen lds
    v_sub_f32 v98, v98, v233
    v_exp_f32 v98, v98
    v_sub_f32 v99, v99, v233
    v_exp_f32 v99, v99
    v_sub_f32 v100, v100, v233
    v_exp_f32 v100, v100
    v_sub_f32 v101, v101, v233
    v_exp_f32 v101, v101
    v_mfma_f32_32x32x16_bf16 v[112:127], v[28:31], v[220:223], 0
    v_sub_f32 v102, v102, v233
    v_exp_f32 v102, v102
    v_sub_f32 v103, v103, v233
    v_exp_f32 v103, v103
    v_sub_f32 v104, v104, v233
    v_exp_f32 v104, v104
    v_sub_f32 v105, v105, v233
    v_exp_f32 v105, v105
    v_smfmac_f32_32x32x32_bf16 v[144:159], v[80:83], v[96:103], v246
    v_sub_f32 v106, v106, v233
    v_exp_f32 v106, v106
    v_sub_f32 v107, v107, v233
    v_exp_f32 v107, v107
    v_sub_f32 v108, v108, v233
    v_exp_f32 v108, v108
    v_sub_f32 v109, v109, v233
    v_exp_f32 v109, v109
    s_nop 0
    v_sub_f32 v110, v110, v233
    v_exp_f32 v110, v110
    v_sub_f32 v111, v111, v233
    v_exp_f32 v111, v111
    s_setprio 3
    v_sub_f32 v112, v112, v233
    v_exp_f32 v112, v112
    v_sub_f32 v113, v113, v233
    v_exp_f32 v113, v113
    v_smfmac_f32_32x32x32_bf16 v[144:159], v[84:87], v[104:111], v246
    s_waitcnt lgkmcnt(0)
    s_barrier
    v_sub_f32 v114, v114, v233
    v_exp_f32 v114, v114
    v_sub_f32 v115, v115, v233
    v_exp_f32 v115, v115
    v_sub_f32 v116, v116, v233
    v_exp_f32 v116, v116
    v_sub_f32 v117, v117, v233
    v_exp_f32 v117, v117
    v_mfma_f32_32x32x16_bf16 v[96:111], v[0:3], v[216:219], 0
    ds_read_b128 v[128:131], v226 offset:0
    v_sub_f32 v118, v118, v233
    v_exp_f32 v118, v118
    v_sub_f32 v119, v119, v233
    v_exp_f32 v119, v119
    v_sub_f32 v120, v120, v233
    v_exp_f32 v120, v120
    v_sub_f32 v121, v121, v233
    v_exp_f32 v121, v121
    v_smfmac_f32_32x32x32_bf16 v[144:159], v[88:91], v[112:119], v246
    s_lshl_b32 s3, s78, 12
    s_add_u32 m0, s3, 0
    s_lshl_b32 s3, s78, 15
    s_add_u32 s3, s3, 0
    buffer_load_dwordx4 v238, s[24:27], s3 offen lds
    ds_read_b128 v[132:135], v226 offset:1024
    v_sub_f32 v122, v122, v233
    v_exp_f32 v122, v122
    v_sub_f32 v123, v123, v233
    v_exp_f32 v123, v123
    v_sub_f32 v124, v124, v233
    v_exp_f32 v124, v124
    v_sub_f32 v125, v125, v233
    v_exp_f32 v125, v125
    s_nop 0
    ds_read_b32 v136, v228 offset:2048
    v_sub_f32 v126, v126, v233
    v_exp_f32 v126, v126
    v_sub_f32 v127, v127, v233
    v_exp_f32 v127, v127
    v_sub_f32 v96, v96, v232
    v_exp_f32 v96, v96
    v_sub_f32 v97, v97, v232
    v_exp_f32 v97, v97
    v_smfmac_f32_32x32x32_bf16 v[144:159], v[92:95], v[120:127], v246
    v_sub_f32 v98, v98, v232
    v_exp_f32 v98, v98
    v_sub_f32 v99, v99, v232
    v_exp_f32 v99, v99
    v_sub_f32 v100, v100, v232
    v_exp_f32 v100, v100
    v_sub_f32 v101, v101, v232
    v_exp_f32 v101, v101
    v_mfma_f32_32x32x16_bf16 v[112:127], v[4:7], v[216:219], 0
    v_sub_f32 v102, v102, v232
    v_exp_f32 v102, v102
    v_sub_f32 v103, v103, v232
    v_exp_f32 v103, v103
    v_sub_f32 v104, v104, v232
    v_exp_f32 v104, v104
    v_sub_f32 v105, v105, v232
    v_exp_f32 v105, v105
    s_waitcnt lgkmcnt(0)
    v_smfmac_f32_32x32x32_bf16 v[128:143], v[32:35], v[96:103], v246
    s_lshl_b32 s3, s78, 12
    s_add_u32 m0, s3, 1024
    s_lshl_b32 s3, s78, 15
    s_add_u32 s3, s3, 8192
    buffer_load_dwordx4 v238, s[24:27], s3 offen lds
    v_sub_f32 v106, v106, v232
    v_exp_f32 v106, v106
    v_sub_f32 v107, v107, v232
    v_exp_f32 v107, v107
    v_sub_f32 v108, v108, v232
    v_exp_f32 v108, v108
    v_sub_f32 v109, v109, v232
    v_exp_f32 v109, v109
    s_nop 0
    v_sub_f32 v110, v110, v232
    v_exp_f32 v110, v110
    v_sub_f32 v111, v111, v232
    v_exp_f32 v111, v111
    v_sub_f32 v112, v112, v232
    v_exp_f32 v112, v112
    v_sub_f32 v113, v113, v232
    v_exp_f32 v113, v113
    v_smfmac_f32_32x32x32_bf16 v[128:143], v[36:39], v[104:111], v246
    ds_write_b128 v227, v[144:147] offset:0
    v_sub_f32 v114, v114, v232
    v_exp_f32 v114, v114
    v_sub_f32 v115, v115, v232
    v_exp_f32 v115, v115
    v_sub_f32 v116, v116, v232
    v_exp_f32 v116, v116
    v_sub_f32 v117, v117, v232
    v_exp_f32 v117, v117
    v_mfma_f32_32x32x16_bf16 v[96:111], v[8:11], v[216:219], 0
    ds_write_b128 v227, v[148:151] offset:1024
    v_sub_f32 v118, v118, v232
    v_exp_f32 v118, v118
    v_sub_f32 v119, v119, v232
    v_exp_f32 v119, v119
    v_sub_f32 v120, v120, v232
    v_exp_f32 v120, v120
    v_sub_f32 v121, v121, v232
    v_exp_f32 v121, v121
    v_smfmac_f32_32x32x32_bf16 v[128:143], v[40:43], v[112:119], v246
    s_lshl_b32 s3, s78, 12
    s_add_u32 m0, s3, 2048
    s_lshl_b32 s3, s78, 15
    s_add_u32 s3, s3, 16384
    buffer_load_dwordx4 v238, s[24:27], s3 offen lds
    v_and_b32 v234, 0x3c, v224
    v_lshlrev_b32 v234, 5, v234
    v_and_b32 v249, 3, v224
    v_lshl_add_u32 v249, v249, 3, v234
    s_lshr_b32 s6, s85, 1
    s_lshl_b32 s6, s6, 11
    s_add_u32 s6, s6, 212992
    buffer_load_dwordx2 v[234:235], v249, s[20:23], s6 offen sc1
    v_and_b32 v250, 28, v239
    s_lshl_b32 s6, s79, 11
    s_add_u32 s6, s6, 214912
    buffer_load_dword v251, v250, s[20:23], s6 offen sc1
    v_sub_f32 v122, v122, v232
    v_exp_f32 v122, v122
    v_sub_f32 v123, v123, v232
    v_exp_f32 v123, v123
    v_sub_f32 v124, v124, v232
    v_exp_f32 v124, v124
    v_sub_f32 v125, v125, v232
    v_exp_f32 v125, v125
    s_nop 0
    ds_write_b32 v229, v152 offset:2048
    v_sub_f32 v126, v126, v232
    v_exp_f32 v126, v126
    v_sub_f32 v127, v127, v232
    v_exp_f32 v127, v127
    v_sub_f32 v96, v96, v232
    v_exp_f32 v96, v96
    v_sub_f32 v97, v97, v232
    v_exp_f32 v97, v97
    v_smfmac_f32_32x32x32_bf16 v[128:143], v[44:47], v[120:127], v246
    v_sub_f32 v98, v98, v232
    v_exp_f32 v98, v98
    v_sub_f32 v99, v99, v232
    v_exp_f32 v99, v99
    v_sub_f32 v100, v100, v232
    v_exp_f32 v100, v100
    v_sub_f32 v101, v101, v232
    v_exp_f32 v101, v101
    v_mfma_f32_32x32x16_bf16 v[112:127], v[12:15], v[216:219], 0
    v_sub_f32 v102, v102, v232
    v_exp_f32 v102, v102
    v_sub_f32 v103, v103, v232
    v_exp_f32 v103, v103
    v_sub_f32 v104, v104, v232
    v_exp_f32 v104, v104
    v_sub_f32 v105, v105, v232
    v_exp_f32 v105, v105
    v_smfmac_f32_32x32x32_bf16 v[128:143], v[48:51], v[96:103], v246
    s_lshl_b32 s3, s78, 12
    s_add_u32 m0, s3, 3072
    s_lshl_b32 s3, s78, 15
    s_add_u32 s3, s3, 24576
    buffer_load_dwordx4 v238, s[24:27], s3 offen lds
    v_sub_f32 v106, v106, v232
    v_exp_f32 v106, v106
    v_sub_f32 v107, v107, v232
    v_exp_f32 v107, v107
    v_sub_f32 v108, v108, v232
    v_exp_f32 v108, v108
    v_sub_f32 v109, v109, v232
    v_exp_f32 v109, v109
    s_nop 0
    v_sub_f32 v110, v110, v232
    v_exp_f32 v110, v110
    v_sub_f32 v111, v111, v232
    v_exp_f32 v111, v111
    s_setprio 2
    v_sub_f32 v112, v112, v232
    v_exp_f32 v112, v112
    v_sub_f32 v113, v113, v232
    v_exp_f32 v113, v113
    v_smfmac_f32_32x32x32_bf16 v[128:143], v[52:55], v[104:111], v246
    v_sub_f32 v114, v114, v232
    v_exp_f32 v114, v114
    v_sub_f32 v115, v115, v232
    v_exp_f32 v115, v115
    v_sub_f32 v116, v116, v232
    v_exp_f32 v116, v116
    v_sub_f32 v117, v117, v232
    v_exp_f32 v117, v117
    v_mfma_f32_32x32x16_bf16 v[96:111], v[16:19], v[216:219], 0
    v_sub_f32 v118, v118, v232
    v_exp_f32 v118, v118
    v_sub_f32 v119, v119, v232
    v_exp_f32 v119, v119
    v_sub_f32 v120, v120, v232
    v_exp_f32 v120, v120
    v_sub_f32 v121, v121, v232
    v_exp_f32 v121, v121
    v_smfmac_f32_32x32x32_bf16 v[128:143], v[56:59], v[112:119], v246
    v_sub_f32 v122, v122, v232
    v_exp_f32 v122, v122
    v_sub_f32 v123, v123, v232
    v_exp_f32 v123, v123
    v_sub_f32 v124, v124, v232
    v_exp_f32 v124, v124
    v_sub_f32 v125, v125, v232
    v_exp_f32 v125, v125
    s_nop 0
    v_sub_f32 v126, v126, v232
    v_exp_f32 v126, v126
    v_sub_f32 v127, v127, v232
    v_exp_f32 v127, v127
    v_sub_f32 v96, v96, v232
    v_exp_f32 v96, v96
    v_sub_f32 v97, v97, v232
    v_exp_f32 v97, v97
    v_smfmac_f32_32x32x32_bf16 v[128:143], v[60:63], v[120:127], v246
    s_waitcnt vmcnt(1)
    s_mov_b32 s92, 0
L_fh_s:
    v_cmp_eq_u32 vcc, s81, v234
    v_cmp_eq_u32 s[90:91], s81, v235
    s_and_b64 vcc, vcc, s[90:91]
    v_cmp_eq_u32 s[90:91], s81, v251
    s_and_b64 vcc, vcc, s[90:91]
    s_cmp_eq_u64 vcc, -1
    s_cbranch_scc1 L_fh_ok_s
    s_add_u32 s92, s92, 1
    s_cmp_gt_u32 s92, 0x100000
    s_cbranch_scc1 L_fh_ok_s
    s_sleep 4
    s_lshr_b32 s6, s85, 1
    s_lshl_b32 s6, s6, 11
    s_add_u32 s6, s6, 212992
    buffer_load_dwordx2 v[234:235], v249, s[20:23], s6 offen sc1
    s_lshl_b32 s6, s79, 11
    s_add_u32 s6, s6, 214912
    buffer_load_dword v251, v250, s[20:23], s6 offen sc1
    s_waitcnt vmcnt(0)
    s_branch L_fh_s
L_fh_ok_s:
    s_add_u32 s6, s78, 7
    s_bfe_u32 s6, s6, 0x20001
    s_lshl2_add_u32 s6, s79, s6
    s_lshl_b32 s6, s6, 7
    s_add_u32 s6, s6, 16384
    buffer_load_dword v250, v248, s[20:23], s6 offen sc1
    buffer_load_dword v248, v248, s[20:23], s40 offen sc1
    v_sub_f32 v98, v98, v232
    v_exp_f32 v98, v98
    v_sub_f32 v99, v99, v232
    v_exp_f32 v99, v99
    v_sub_f32 v100, v100, v232
    v_exp_f32 v100, v100
    v_sub_f32 v101, v101, v232
    v_exp_f32 v101, v101
    v_mfma_f32_32x32x16_bf16 v[112:127], v[20:23], v[216:219], 0
    v_sub_f32 v102, v102, v232
    v_exp_f32 v102, v102
    v_sub_f32 v103, v103, v232
    v_exp_f32 v103, v103
    v_sub_f32 v104, v104, v232
    v_exp_f32 v104, v104
    v_sub_f32 v105, v105, v232
    v_exp_f32 v105, v105
    v_smfmac_f32_32x32x32_bf16 v[128:143], v[64:67], v[96:103], v246
    s_add_u32 s3, s78, 3
    s_and_b32 s3, s3, 7
    s_lshl_b32 s6, s3, 7
    v_add_u32 v237, s6, v236
    ds_read_b32 v233, v237
    s_lshl_b32 s3, s3, 10
    s_add_u32 s3, s3, 151552
    v_add_u32 v230, s3, v225
    ds_read_b128 v[220:223], v230
    v_sub_f32 v106, v106, v232
    v_exp_f32 v106, v106
    v_sub_f32 v107, v107, v232
    v_exp_f32 v107, v107
    v_sub_f32 v108, v108, v232
    v_exp_f32 v108, v108
    v_sub_f32 v109, v109, v232
    v_exp_f32 v109, v109
    s_nop 0
    s_add_u32 s3, s98, 32768
    buffer_load_dwordx4 v[192:195], v225, s[20:23], s3 offen sc1
    v_sub_f32 v110, v110, v232
    v_exp_f32 v110, v110
    v_sub_f32 v111, v111, v232
    v_exp_f32 v111, v111
    s_setprio 1
    v_sub_f32 v112, v112, v232
    v_exp_f32 v112, v112
    v_sub_f32 v113, v113, v232
    v_exp_f32 v113, v113
    v_smfmac_f32_32x32x32_bf16 v[128:143], v[68:71], v[104:111], v246
    v_sub_f32 v114, v114, v232
    v_exp_f32 v114, v114
    v_sub_f32 v115, v115, v232
    v_exp_f32 v115, v115
    v_sub_f32 v116, v116, v232
    v_exp_f32 v116, v116
    v_sub_f32 v117, v117, v232
    v_exp_f32 v117, v117
    v_mfma_f32_32x32x16_bf16 v[96:111], v[24:27], v[216:219], 0
    v_sub_f32 v118, v118, v232
    v_exp_f32 v118, v118
    v_sub_f32 v119, v119, v232
    v_exp_f32 v119, v119
    v_sub_f32 v120, v120, v232
    v_exp_f32 v120, v120
    v_sub_f32 v121, v121, v232
    v_exp_f32 v121, v121
    v_smfmac_f32_32x32x32_bf16 v[128:143], v[72:75], v[112:119], v246
    s_add_u32 s3, s78, 3
    s_and_b32 s3, s3, 7
    s_mul_i32 s3, s3, 2304
    s_add_u32 s3, s3, 116736
    v_add_u32 v227, s3, v225
    v_add_u32 v229, s3, v239
    v_sub_f32 v122, v122, v232
    v_exp_f32 v122, v122
    v_sub_f32 v123, v123, v232
    v_exp_f32 v123, v123
    v_sub_f32 v124, v124, v232
    v_exp_f32 v124, v124
    v_sub_f32 v125, v125, v232
    v_exp_f32 v125, v125
    s_nop 0
    s_add_u32 s3, s98, 36864
    buffer_load_dwordx4 v[196:199], v225, s[20:23], s3 offen sc1
    v_sub_f32 v126, v126, v232
    v_exp_f32 v126, v126
    v_sub_f32 v127, v127, v232
    v_exp_f32 v127, v127
    s_setprio 0
    v_sub_f32 v96, v96, v232
    v_exp_f32 v96, v96
    v_sub_f32 v97, v97, v232
    v_exp_f32 v97, v97
    v_smfmac_f32_32x32x32_bf16 v[128:143], v[76:79], v[120:127], v246
    v_sub_f32 v98, v98, v232
    v_exp_f32 v98, v98
    v_sub_f32 v99, v99, v232
    v_exp_f32 v99, v99
    v_sub_f32 v100, v100, v232
    v_exp_f32 v100, v100
    v_sub_f32 v101, v101, v232
    v_exp_f32 v101, v101
    v_mfma_f32_32x32x16_bf16 v[112:127], v[28:31], v[216:219], 0
    v_sub_f32 v102, v102, v232
    v_exp_f32 v102, v102
    v_sub_f32 v103, v103, v232
    v_exp_f32 v103, v103
    v_sub_f32 v104, v104, v232
    v_exp_f32 v104, v104
    v_sub_f32 v105, v105, v232
    v_exp_f32 v105, v105
    v_smfmac_f32_32x32x32_bf16 v[128:143], v[80:83], v[96:103], v246
    v_sub_f32 v106, v106, v232
    v_exp_f32 v106, v106
    v_sub_f32 v107, v107, v232
    v_exp_f32 v107, v107
    v_sub_f32 v108, v108, v232
    v_exp_f32 v108, v108
    v_sub_f32 v109, v109, v232
    v_exp_f32 v109, v109
    s_nop 0
    s_add_u32 s3, s98, 40960
    buffer_load_dwordx4 v[200:203], v225, s[20:23], s3 offen sc1
    v_sub_f32 v110, v110, v232
    v_exp_f32 v110, v110
    v_sub_f32 v111, v111, v232
    v_exp_f32 v111, v111
    s_setprio 3
    v_sub_f32 v112, v112, v232
    v_exp_f32 v112, v112
    v_sub_f32 v113, v113, v232
    v_exp_f32 v113, v113
    v_smfmac_f32_32x32x32_bf16 v[128:143], v[84:87], v[104:111], v246
    s_waitcnt vmcnt(5) lgkmcnt(0)
    s_barrier
    ds_read_b64_tr_b16 v[208:209], v240 offset:0
    v_sub_f32 v114, v114, v232
    v_exp_f32 v114, v114
    v_sub_f32 v115, v115, v232
    v_exp_f32 v115, v115
    v_sub_f32 v116, v116, v232
    v_exp_f32 v116, v116
    v_sub_f32 v117, v117, v232
    v_exp_f32 v117, v117
    v_mfma_f32_32x32x16_bf16 v[96:111], v[0:3], v[220:223], 0
    ds_read_b64_tr_b16 v[210:211], v240 offset:512
    ds_read_b128 v[144:147], v227 offset:0
    v_sub_f32 v118, v118, v232
    v_exp_f32 v118, v118
    v_sub_f32 v119, v119, v232
    v_exp_f32 v119, v119
    v_sub_f32 v120, v120, v232
    v_exp_f32 v120, v120
    v_sub_f32 v121, v121, v232
    v_exp_f32 v121, v121
    v_smfmac_f32_32x32x32_bf16 v[128:143], v[88:91], v[112:119], v246
    s_lshl_b32 s3, s78, 12
    s_add_u32 m0, s3, 32768
    s_lshl_b32 s3, s78, 15
    s_add_u32 s3, s3, 262144
    buffer_load_dwordx4 v238, s[24:27], s3 offen lds
    ds_read_b128 v[148:151], v227 offset:1024
    v_sub_f32 v122, v122, v232
    v_exp_f32 v122, v122
    v_sub_f32 v123, v123, v232
    v_exp_f32 v123, v123
    v_sub_f32 v124, v124, v232
    v_exp_f32 v124, v124
    v_sub_f32 v125, v125, v232
    v_exp_f32 v125, v125
    s_nop 0
    s_add_u32 s3, s98, 45056
    buffer_load_dwordx4 v[204:207], v225, s[20:23], s3 offen sc1
    ds_read_b32 v152, v229 offset:2048
    v_sub_f32 v126, v126, v232
    v_exp_f32 v126, v126
    v_sub_f32 v127, v127, v232
    v_exp_f32 v127, v127
    v_sub_f32 v96, v96, v233
    v_exp_f32 v96, v96
    v_sub_f32 v97, v97, v233
    v_exp_f32 v97, v97
    v_smfmac_f32_32x32x32_bf16 v[128:143], v[92:95], v[120:127], v246
    ds_read_b64_tr_b16 v[212:213], v241 offset:0
    v_sub_f32 v98, v98, v233
    v_exp_f32 v98, v98
    v_sub_f32 v99, v99, v233
    v_exp_f32 v99, v99
    v_sub_f32 v100, v100, v233
    v_exp_f32 v100, v100
    v_sub_f32 v101, v101, v233
    v_exp_f32 v101, v101
    v_mfma_f32_32x32x16_bf16 v[112:127], v[4:7], v[220:223], 0
    ds_read_b64_tr_b16 v[214:215], v241 offset:512
    v_sub_f32 v102, v102, v233
    v_exp_f32 v102, v102
    v_sub_f32 v103, v103, v233
    v_exp_f32 v103, v103
    v_sub_f32 v104, v104, v233
    v_exp_f32 v104, v104
    v_sub_f32 v105, v105, v233
    v_exp_f32 v105, v105
    s_waitcnt lgkmcnt(2)
    v_smfmac_f32_32x32x32_bf16 v[144:159], v[32:35], v[96:103], v246
    s_lshl_b32 s3, s78, 12
    s_add_u32 m0, s3, 33792
    s_lshl_b32 s3, s78, 15
    s_add_u32 s3, s3, 270336
    buffer_load_dwordx4 v238, s[24:27], s3 offen lds
    v_sub_f32 v106, v106, v233
    v_exp_f32 v106, v106
    v_sub_f32 v107, v107, v233
    v_exp_f32 v107, v107
    v_sub_f32 v108, v108, v233
    v_exp_f32 v108, v108
    v_sub_f32 v109, v109, v233
    v_exp_f32 v109, v109
    s_waitcnt vmcnt(5)
    v_mfma_f32_32x32x16_bf16 v[160:175], v[208:211], v[192:195], 0
    v_sub_f32 v110, v110, v233
    v_exp_f32 v110, v110
    v_sub_f32 v111, v111, v233
    v_exp_f32 v111, v111
    v_sub_f32 v112, v112, v233
    v_exp_f32 v112, v112
    v_sub_f32 v113, v113, v233
    v_exp_f32 v113, v113
    v_smfmac_f32_32x32x32_bf16 v[144:159], v[36:39], v[104:111], v246
    ds_read_b64_tr_b16 v[208:209], v240 offset:8192
    ds_write_b128 v226, v[128:131] offset:0
    v_sub_f32 v114, v114, v233
    v_exp_f32 v114, v114
    v_sub_f32 v115, v115, v233
    v_exp_f32 v115, v115
    v_sub_f32 v116, v116, v233
    v_exp_f32 v116, v116
    v_sub_f32 v117, v117, v233
    v_exp_f32 v117, v117
    v_mfma_f32_32x32x16_bf16 v[96:111], v[8:11], v[220:223], 0
    ds_read_b64_tr_b16 v[210:211], v240 offset:8704
    ds_write_b128 v226, v[132:135] offset:1024
    v_sub_f32 v118, v118, v233
    v_exp_f32 v118, v118
    v_sub_f32 v119, v119, v233
    v_exp_f32 v119, v119
    v_sub_f32 v120, v120, v233
    v_exp_f32 v120, v120
    v_sub_f32 v121, v121, v233
    v_exp_f32 v121, v121
    v_smfmac_f32_32x32x32_bf16 v[144:159], v[40:43], v[112:119], v246
    s_lshl_b32 s3, s78, 12
    s_add_u32 m0, s3, 34816
    s_lshl_b32 s3, s78, 15
    s_add_u32 s3, s3, 278528
    buffer_load_dwordx4 v238, s[24:27], s3 offen lds
    v_sub_f32 v122, v122, v233
    v_exp_f32 v122, v122
    v_sub_f32 v123, v123, v233
    v_exp_f32 v123, v123
    v_sub_f32 v124, v124, v233
    v_exp_f32 v124, v124
    v_sub_f32 v125, v125, v233
    v_exp_f32 v125, v125
    s_waitcnt lgkmcnt(4)
    v_mfma_f32_32x32x16_bf16 v[176:191], v[212:215], v[192:195], 0
    s_add_u32 s3, s98, 49152
    buffer_load_dwordx4 v[192:195], v225, s[20:23], s3 offen sc1
    ds_write_b32 v228, v136 offset:2048
    v_sub_f32 v126, v126, v233
    v_exp_f32 v126, v126
    v_sub_f32 v127, v127, v233
    v_exp_f32 v127, v127
    v_sub_f32 v96, v96, v233
    v_exp_f32 v96, v96
    v_sub_f32 v97, v97, v233
    v_exp_f32 v97, v97
    v_smfmac_f32_32x32x32_bf16 v[144:159], v[44:47], v[120:127], v246
    ds_read_b64_tr_b16 v[212:213], v241 offset:8192
    v_sub_f32 v98, v98, v233
    v_exp_f32 v98, v98
    v_sub_f32 v99, v99, v233
    v_exp_f32 v99, v99
    v_sub_f32 v100, v100, v233
    v_exp_f32 v100, v100
    v_sub_f32 v101, v101, v233
    v_exp_f32 v101, v101
    v_mfma_f32_32x32x16_bf16 v[112:127], v[12:15], v[220:223], 0
    ds_read_b64_tr_b16 v[214:215], v241 offset:8704
    v_sub_f32 v102, v102, v233
    v_exp_f32 v102, v102
    v_sub_f32 v103, v103, v233
    v_exp_f32 v103, v103
    v_sub_f32 v104, v104, v233
    v_exp_f32 v104, v104
    v_sub_f32 v105, v105, v233
    v_exp_f32 v105, v105
    v_smfmac_f32_32x32x32_bf16 v[144:159], v[48:51], v[96:103], v246
    s_lshl_b32 s3, s78, 12
    s_add_u32 m0, s3, 35840
    s_lshl_b32 s3, s78, 15
    s_add_u32 s3, s3, 286720
    buffer_load_dwordx4 v238, s[24:27], s3 offen lds
    v_sub_f32 v106, v106, v233
    v_exp_f32 v106, v106
    v_sub_f32 v107, v107, v233
    v_exp_f32 v107, v107
    v_sub_f32 v108, v108, v233
    v_exp_f32 v108, v108
    v_sub_f32 v109, v109, v233
    v_exp_f32 v109, v109
    s_waitcnt lgkmcnt(4)
    s_waitcnt vmcnt(7)
    v_mfma_f32_32x32x16_bf16 v[160:175], v[208:211], v[196:199], v[160:175]
    v_sub_f32 v110, v110, v233
    v_exp_f32 v110, v110
    v_sub_f32 v111, v111, v233
    v_exp_f32 v111, v111
    s_setprio 2
    v_sub_f32 v112, v112, v233
    v_exp_f32 v112, v112
    v_sub_f32 v113, v113, v233
    v_exp_f32 v113, v113
    v_smfmac_f32_32x32x32_bf16 v[144:159], v[52:55], v[104:111], v246
    ds_read_b64_tr_b16 v[208:209], v240 offset:16384
    v_sub_f32 v114, v114, v233
    v_exp_f32 v114, v114
    v_sub_f32 v115, v115, v233
    v_exp_f32 v115, v115
    v_sub_f32 v116, v116, v233
    v_exp_f32 v116, v116
    v_sub_f32 v117, v117, v233
    v_exp_f32 v117, v117
    v_mfma_f32_32x32x16_bf16 v[96:111], v[16:19], v[220:223], 0
    ds_read_b64_tr_b16 v[210:211], v240 offset:16896
    v_sub_f32 v118, v118, v233
    v_exp_f32 v118, v118
    v_sub_f32 v119, v119, v233
    v_exp_f32 v119, v119
    v_sub_f32 v120, v120, v233
    v_exp_f32 v120, v120
    v_sub_f32 v121, v121, v233
    v_exp_f32 v121, v121
    v_smfmac_f32_32x32x32_bf16 v[144:159], v[56:59], v[112:119], v246
    v_sub_f32 v122, v122, v233
    v_exp_f32 v122, v122
    v_sub_f32 v123, v123, v233
    v_exp_f32 v123, v123
    v_sub_f32 v124, v124, v233
    v_exp_f32 v124, v124
    v_sub_f32 v125, v125, v233
    v_exp_f32 v125, v125
    s_waitcnt lgkmcnt(2)
    v_mfma_f32_32x32x16_bf16 v[176:191], v[212:215], v[196:199], v[176:191]
    s_add_u32 s3, s98, 53248
    buffer_load_dwordx4 v[196:199], v225, s[20:23], s3 offen sc1
    v_sub_f32 v126, v126, v233
    v_exp_f32 v126, v126
    v_sub_f32 v127, v127, v233
    v_exp_f32 v127, v127
    v_sub_f32 v96, v96, v233
    v_exp_f32 v96, v96
    v_sub_f32 v97, v97, v233
    v_exp_f32 v97, v97
    v_smfmac_f32_32x32x32_bf16 v[144:159], v[60:63], v[120:127], v246
    ds_read_b64_tr_b16 v[212:213], v241 offset:16384
    v_sub_f32 v98, v98, v233
    v_exp_f32 v98, v98
    v_sub_f32 v99, v99, v233
    v_exp_f32 v99, v99
    v_sub_f32 v100, v100, v233
    v_exp_f32 v100, v100
    v_sub_f32 v101, v101, v233
    v_exp_f32 v101, v101
    v_mfma_f32_32x32x16_bf16 v[112:127], v[20:23], v[220:223], 0
    ds_read_b64_tr_b16 v[214:215], v241 offset:16896
    v_sub_f32 v102, v102, v233
    v_exp_f32 v102, v102
    v_sub_f32 v103, v103, v233
    v_exp_f32 v103, v103
    v_sub_f32 v104, v104, v233
    v_exp_f32 v104, v104
    v_sub_f32 v105, v105, v233
    v_exp_f32 v105, v105
    v_smfmac_f32_32x32x32_bf16 v[144:159], v[64:67], v[96:103], v246
    s_add_u32 s3, s78, 4
    s_and_b32 s3, s3, 7
    s_lshl_b32 s6, s3, 7
    v_add_u32 v237, s6, v236
    ds_read_b32 v232, v237
    s_lshl_b32 s3, s3, 10
    s_add_u32 s3, s3, 151552
    v_add_u32 v230, s3, v225
    ds_read_b128 v[216:219], v230
    v_sub_f32 v106, v106, v233
    v_exp_f32 v106, v106
    v_sub_f32 v107, v107, v233
    v_exp_f32 v107, v107
    v_sub_f32 v108, v108, v233
    v_exp_f32 v108, v108
    v_sub_f32 v109, v109, v233
    v_exp_f32 v109, v109
    s_waitcnt lgkmcnt(4)
    s_waitcnt vmcnt(7)
    v_mfma_f32_32x32x16_bf16 v[160:175], v[208:211], v[200:203], v[160:175]
    v_sub_f32 v110, v110, v233
    v_exp_f32 v110, v110
    v_sub_f32 v111, v111, v233
    v_exp_f32 v111, v111
    s_setprio 1
    v_sub_f32 v112, v112, v233
    v_exp_f32 v112, v112
    v_sub_f32 v113, v113, v233
    v_exp_f32 v113, v113
    v_smfmac_f32_32x32x32_bf16 v[144:159], v[68:71], v[104:111], v246
    ds_read_b64_tr_b16 v[208:209], v240 offset:24576
    v_sub_f32 v114, v114, v233
    v_exp_f32 v114, v114
    v_sub_f32 v115, v115, v233
    v_exp_f32 v115, v115
    v_sub_f32 v116, v116, v233
    v_exp_f32 v116, v116
    v_sub_f32 v117, v117, v233
    v_exp_f32 v117, v117
    v_mfma_f32_32x32x16_bf16 v[96:111], v[24:27], v[220:223], 0
    ds_read_b64_tr_b16 v[210:211], v240 offset:25088
    v_sub_f32 v118, v118, v233
    v_exp_f32 v118, v118
    v_sub_f32 v119, v119, v233
    v_exp_f32 v119, v119
    v_sub_f32 v120, v120, v233
    v_exp_f32 v120, v120
    v_sub_f32 v121, v121, v233
    v_exp_f32 v121, v121
    v_smfmac_f32_32x32x32_bf16 v[144:159], v[72:75], v[112:119], v246
    s_add_u32 s3, s78, 4
    s_and_b32 s3, s3, 7
    s_mul_i32 s3, s3, 2304
    s_add_u32 s3, s3, 98304
    v_add_u32 v226, s3, v225
    v_add_u32 v228, s3, v239
    v_sub_f32 v122, v122, v233
    v_exp_f32 v122, v122
    v_sub_f32 v123, v123, v233
    v_exp_f32 v123, v123
    v_sub_f32 v124, v124, v233
    v_exp_f32 v124, v124
    v_sub_f32 v125, v125, v233
    v_exp_f32 v125, v125
    s_waitcnt lgkmcnt(4)
    v_mfma_f32_32x32x16_bf16 v[176:191], v[212:215], v[200:203], v[176:191]
    s_add_u32 s3, s98, 57344
    buffer_load_dwordx4 v[200:203], v225, s[20:23], s3 offen sc1
    v_sub_f32 v126, v126, v233
    v_exp_f32 v126, v126
    v_sub_f32 v127, v127, v233
    v_exp_f32 v127, v127
    s_setprio 0
    v_sub_f32 v96, v96, v233
    v_exp_f32 v96, v96
    v_sub_f32 v97, v97, v233
    v_exp_f32 v97, v97
    v_smfmac_f32_32x32x32_bf16 v[144:159], v[76:79], v[120:127], v246
    ds_read_b64_tr_b16 v[212:213], v241 offset:24576
    v_sub_f32 v98, v98, v233
    v_exp_f32 v98, v98
    v_sub_f32 v99, v99, v233
    v_exp_f32 v99, v99
    v_sub_f32 v100, v100, v233
    v_exp_f32 v100, v100
    v_sub_f32 v101, v101, v233
    v_exp_f32 v101, v101
    v_mfma_f32_32x32x16_bf16 v[112:127], v[28:31], v[220:223], 0
    ds_read_b64_tr_b16 v[214:215], v241 offset:25088
    v_sub_f32 v102, v102, v233
    v_exp_f32 v102, v102
    v_sub_f32 v103, v103, v233
    v_exp_f32 v103, v103
    v_sub_f32 v104, v104, v233
    v_exp_f32 v104, v104
    v_sub_f32 v105, v105, v233
    v_exp_f32 v105, v105
    v_smfmac_f32_32x32x32_bf16 v[144:159], v[80:83], v[96:103], v246
    v_sub_f32 v106, v106, v233
    v_exp_f32 v106, v106
    v_sub_f32 v107, v107, v233
    v_exp_f32 v107, v107
    v_sub_f32 v108, v108, v233
    v_exp_f32 v108, v108
    v_sub_f32 v109, v109, v233
    v_exp_f32 v109, v109
    s_waitcnt lgkmcnt(2)
    s_waitcnt vmcnt(6)
    v_mfma_f32_32x32x16_bf16 v[160:175], v[208:211], v[204:207], v[160:175]
    v_sub_f32 v110, v110, v233
    v_exp_f32 v110, v110
    v_sub_f32 v111, v111, v233
    v_exp_f32 v111, v111
    s_setprio 3
    v_sub_f32 v112, v112, v233
    v_exp_f32 v112, v112
    v_sub_f32 v113, v113, v233
    v_exp_f32 v113, v113
    v_smfmac_f32_32x32x32_bf16 v[144:159], v[84:87], v[104:111], v246
    s_waitcnt vmcnt(2) lgkmcnt(0)
    s_barrier
    ds_read_b64_tr_b16 v[208:209], v240 offset:32768
    v_sub_f32 v114, v114, v233
    v_exp_f32 v114, v114
    v_sub_f32 v115, v115, v233
    v_exp_f32 v115, v115
    v_sub_f32 v116, v116, v233
    v_exp_f32 v116, v116
    v_sub_f32 v117, v117, v233
    v_exp_f32 v117, v117
    v_mfma_f32_32x32x16_bf16 v[96:111], v[0:3], v[216:219], 0
    ds_read_b64_tr_b16 v[210:211], v240 offset:33280
    ds_read_b128 v[128:131], v226 offset:0
    v_sub_f32 v118, v118, v233
    v_exp_f32 v118, v118
    v_sub_f32 v119, v119, v233
    v_exp_f32 v119, v119
    v_sub_f32 v120, v120, v233
    v_exp_f32 v120, v120
    v_sub_f32 v121, v121, v233
    v_exp_f32 v121, v121
    v_smfmac_f32_32x32x32_bf16 v[144:159], v[88:91], v[112:119], v246
    s_lshl_b32 s3, s78, 12
    s_add_u32 m0, s3, 0
    s_lshl_b32 s3, s78, 15
    s_add_u32 s3, s3, 524288
    buffer_load_dwordx4 v238, s[24:27], s3 offen lds
    ds_read_b128 v[132:135], v226 offset:1024
    v_sub_f32 v122, v122, v233
    v_exp_f32 v122, v122
    v_sub_f32 v123, v123, v233
    v_exp_f32 v123, v123
    v_sub_f32 v124, v124, v233
    v_exp_f32 v124, v124
    v_sub_f32 v125, v125, v233
    v_exp_f32 v125, v125
    v_mfma_f32_32x32x16_bf16 v[176:191], v[212:215], v[204:207], v[176:191]
    s_add_u32 s3, s98, 61440
    buffer_load_dwordx4 v[204:207], v225, s[20:23], s3 offen sc1
    ds_read_b32 v136, v228 offset:2048
    v_sub_f32 v126, v126, v233
    v_exp_f32 v126, v126
    v_sub_f32 v127, v127, v233
    v_exp_f32 v127, v127
    v_sub_f32 v96, v96, v232
    v_exp_f32 v96, v96
    v_sub_f32 v97, v97, v232
    v_exp_f32 v97, v97
    v_smfmac_f32_32x32x32_bf16 v[144:159], v[92:95], v[120:127], v246
    ds_read_b64_tr_b16 v[212:213], v241 offset:32768
    v_sub_f32 v98, v98, v232
    v_exp_f32 v98, v98
    v_sub_f32 v99, v99, v232
    v_exp_f32 v99, v99
    v_sub_f32 v100, v100, v232
    v_exp_f32 v100, v100
    v_sub_f32 v101, v101, v232
    v_exp_f32 v101, v101
    v_mfma_f32_32x32x16_bf16 v[112:127], v[4:7], v[216:219], 0
    ds_read_b64_tr_b16 v[214:215], v241 offset:33280
    v_sub_f32 v102, v102, v232
    v_exp_f32 v102, v102
    v_sub_f32 v103, v103, v232
    v_exp_f32 v103, v103
    v_sub_f32 v104, v104, v232
    v_exp_f32 v104, v104
    v_sub_f32 v105, v105, v232
    v_exp_f32 v105, v105
    s_waitcnt lgkmcnt(2)
    v_smfmac_f32_32x32x32_bf16 v[128:143], v[32:35], v[96:103], v246
    s_lshl_b32 s3, s78, 12
    s_add_u32 m0, s3, 1024
    s_lshl_b32 s3, s78, 15
    s_add_u32 s3, s3, 532480
    buffer_load_dwordx4 v238, s[24:27], s3 offen lds
    v_sub_f32 v106, v106, v232
    v_exp_f32 v106, v106
    v_sub_f32 v107, v107, v232
    v_exp_f32 v107, v107
    v_sub_f32 v108, v108, v232
    v_exp_f32 v108, v108
    v_sub_f32 v109, v109, v232
    v_exp_f32 v109, v109
    v_mfma_f32_32x32x16_bf16 v[160:175], v[208:211], v[192:195], v[160:175]
    v_sub_f32 v110, v110, v232
    v_exp_f32 v110, v110
    v_sub_f32 v111, v111, v232
    v_exp_f32 v111, v111
    v_sub_f32 v112, v112, v232
    v_exp_f32 v112, v112
    v_sub_f32 v113, v113, v232
    v_exp_f32 v113, v113
    v_smfmac_f32_32x32x32_bf16 v[128:143], v[36:39], v[104:111], v246
    ds_read_b64_tr_b16 v[208:209], v240 offset:40960
    ds_write_b128 v227, v[144:147] offset:0
    v_sub_f32 v114, v114, v232
    v_exp_f32 v114, v114
    v_sub_f32 v115, v115, v232
    v_exp_f32 v115, v115
    v_sub_f32 v116, v116, v232
    v_exp_f32 v116, v116
    v_sub_f32 v117, v117, v232
    v_exp_f32 v117, v117
    v_mfma_f32_32x32x16_bf16 v[96:111], v[8:11], v[216:219], 0
    ds_read_b64_tr_b16 v[210:211], v240 offset:41472
    ds_write_b128 v227, v[148:151] offset:1024
    v_sub_f32 v118, v118, v232
    v_exp_f32 v118, v118
    v_sub_f32 v119, v119, v232
    v_exp_f32 v119, v119
    v_sub_f32 v120, v120, v232
    v_exp_f32 v120, v120
    v_sub_f32 v121, v121, v232
    v_exp_f32 v121, v121
    v_smfmac_f32_32x32x32_bf16 v[128:143], v[40:43], v[112:119], v246
    s_lshl_b32 s3, s78, 12
    s_add_u32 m0, s3, 2048
    s_lshl_b32 s3, s78, 15
    s_add_u32 s3, s3, 540672
    buffer_load_dwordx4 v238, s[24:27], s3 offen lds
    v_sub_f32 v122, v122, v232
    v_exp_f32 v122, v122
    v_sub_f32 v123, v123, v232
    v_exp_f32 v123, v123
    v_sub_f32 v124, v124, v232
    v_exp_f32 v124, v124
    v_sub_f32 v125, v125, v232
    v_exp_f32 v125, v125
    s_waitcnt lgkmcnt(4)
    v_mfma_f32_32x32x16_bf16 v[176:191], v[212:215], v[192:195], v[176:191]
    s_add_u32 s3, s98, 65536
    buffer_load_dwordx4 v[192:195], v225, s[20:23], s3 offen sc1
    ds_write_b32 v229, v152 offset:2048
    v_sub_f32 v126, v126, v232
    v_exp_f32 v126, v126
    v_sub_f32 v127, v127, v232
    v_exp_f32 v127, v127
    v_sub_f32 v96, v96, v232
    v_exp_f32 v96, v96
    v_sub_f32 v97, v97, v232
    v_exp_f32 v97, v97
    v_smfmac_f32_32x32x32_bf16 v[128:143], v[44:47], v[120:127], v246
    ds_read_b64_tr_b16 v[212:213], v241 offset:40960
    v_sub_f32 v98, v98, v232
    v_exp_f32 v98, v98
    v_sub_f32 v99, v99, v232
    v_exp_f32 v99, v99
    v_sub_f32 v100, v100, v232
    v_exp_f32 v100, v100
    v_sub_f32 v101, v101, v232
    v_exp_f32 v101, v101
    v_mfma_f32_32x32x16_bf16 v[112:127], v[12:15], v[216:219], 0
    ds_read_b64_tr_b16 v[214:215], v241 offset:41472
    v_sub_f32 v102, v102, v232
    v_exp_f32 v102, v102
    v_sub_f32 v103, v103, v232
    v_exp_f32 v103, v103
    v_sub_f32 v104, v104, v232
    v_exp_f32 v104, v104
    v_sub_f32 v105, v105, v232
    v_exp_f32 v105, v105
    v_smfmac_f32_32x32x32_bf16 v[128:143], v[48:51], v[96:103], v246
    s_lshl_b32 s3, s78, 12
    s_add_u32 m0, s3, 3072
    s_lshl_b32 s3, s78, 15
    s_add_u32 s3, s3, 548864
    buffer_load_dwordx4 v238, s[24:27], s3 offen lds
    v_sub_f32 v106, v106, v232
    v_exp_f32 v106, v106
    v_sub_f32 v107, v107, v232
    v_exp_f32 v107, v107
    v_sub_f32 v108, v108, v232
    v_exp_f32 v108, v108
    v_sub_f32 v109, v109, v232
    v_exp_f32 v109, v109
    s_waitcnt lgkmcnt(4)
    s_waitcnt vmcnt(7)
    v_mfma_f32_32x32x16_bf16 v[160:175], v[208:211], v[196:199], v[160:175]
    v_sub_f32 v110, v110, v232
    v_exp_f32 v110, v110
    v_sub_f32 v111, v111, v232
    v_exp_f32 v111, v111
    s_setprio 2
    v_sub_f32 v112, v112, v232
    v_exp_f32 v112, v112
    v_sub_f32 v113, v113, v232
    v_exp_f32 v113, v113
    v_smfmac_f32_32x32x32_bf16 v[128:143], v[52:55], v[104:111], v246
    ds_read_b64_tr_b16 v[208:209], v240 offset:49152
    v_sub_f32 v114, v114, v232
    v_exp_f32 v114, v114
    v_sub_f32 v115, v115, v232
    v_exp_f32 v115, v115
    v_sub_f32 v116, v116, v232
    v_exp_f32 v116, v116
    v_sub_f32 v117, v117, v232
    v_exp_f32 v117, v117
    v_mfma_f32_32x32x16_bf16 v[96:111], v[16:19], v[216:219], 0
    ds_read_b64_tr_b16 v[210:211], v240 offset:49664
    v_sub_f32 v118, v118, v232
    v_exp_f32 v118, v118
    v_sub_f32 v119, v119, v232
    v_exp_f32 v119, v119
    v_sub_f32 v120, v120, v232
    v_exp_f32 v120, v120
    v_sub_f32 v121, v121, v232
    v_exp_f32 v121, v121
    v_smfmac_f32_32x32x32_bf16 v[128:143], v[56:59], v[112:119], v246
    v_sub_f32 v122, v122, v232
    v_exp_f32 v122, v122
    v_sub_f32 v123, v123, v232
    v_exp_f32 v123, v123
    v_sub_f32 v124, v124, v232
    v_exp_f32 v124, v124
    v_sub_f32 v125, v125, v232
    v_exp_f32 v125, v125
    s_waitcnt lgkmcnt(2)
    v_mfma_f32_32x32x16_bf16 v[176:191], v[212:215], v[196:199], v[176:191]
    s_add_u32 s3, s98, 69632
    buffer_load_dwordx4 v[196:199], v225, s[20:23], s3 offen sc1
    v_sub_f32 v126, v126, v232
    v_exp_f32 v126, v126
    v_sub_f32 v127, v127, v232
    v_exp_f32 v127, v127
    v_sub_f32 v96, v96, v232
    v_exp_f32 v96, v96
    v_sub_f32 v97, v97, v232
    v_exp_f32 v97, v97
    v_smfmac_f32_32x32x32_bf16 v[128:143], v[60:63], v[120:127], v246
    ds_read_b64_tr_b16 v[212:213], v241 offset:49152
    v_sub_f32 v98, v98, v232
    v_exp_f32 v98, v98
    v_sub_f32 v99, v99, v232
    v_exp_f32 v99, v99
    v_sub_f32 v100, v100, v232
    v_exp_f32 v100, v100
    v_sub_f32 v101, v101, v232
    v_exp_f32 v101, v101
    v_mfma_f32_32x32x16_bf16 v[112:127], v[20:23], v[216:219], 0
    ds_read_b64_tr_b16 v[214:215], v241 offset:49664
    v_sub_f32 v102, v102, v232
    v_exp_f32 v102, v102
    v_sub_f32 v103, v103, v232
    v_exp_f32 v103, v103
    v_sub_f32 v104, v104, v232
    v_exp_f32 v104, v104
    v_sub_f32 v105, v105, v232
    v_exp_f32 v105, v105
    v_smfmac_f32_32x32x32_bf16 v[128:143], v[64:67], v[96:103], v246
    s_add_u32 s3, s78, 5
    s_and_b32 s3, s3, 7
    s_lshl_b32 s6, s3, 7
    v_add_u32 v237, s6, v236
    ds_read_b32 v233, v237
    s_lshl_b32 s3, s3, 10
    s_add_u32 s3, s3, 151552
    v_add_u32 v230, s3, v225
    ds_read_b128 v[220:223], v230
    v_sub_f32 v106, v106, v232
    v_exp_f32 v106, v106
    v_sub_f32 v107, v107, v232
    v_exp_f32 v107, v107
    v_sub_f32 v108, v108, v232
    v_exp_f32 v108, v108
    v_sub_f32 v109, v109, v232
    v_exp_f32 v109, v109
    s_waitcnt lgkmcnt(4)
    s_waitcnt vmcnt(7)
    v_mfma_f32_32x32x16_bf16 v[160:175], v[208:211], v[200:203], v[160:175]
    v_sub_f32 v110, v110, v232
    v_exp_f32 v110, v110
    v_sub_f32 v111, v111, v232
    v_exp_f32 v111, v111
    s_setprio 1
    v_sub_f32 v112, v112, v232
    v_exp_f32 v112, v112
    v_sub_f32 v113, v113, v232
    v_exp_f32 v113, v113
    v_smfmac_f32_32x32x32_bf16 v[128:143], v[68:71], v[104:111], v246
    ds_read_b64_tr_b16 v[208:209], v240 offset:57344
    v_sub_f32 v114, v114, v232
    v_exp_f32 v114, v114
    v_sub_f32 v115, v115, v232
    v_exp_f32 v115, v115
    v_sub_f32 v116, v116, v232
    v_exp_f32 v116, v116
    v_sub_f32 v117, v117, v232
    v_exp_f32 v117, v117
    v_mfma_f32_32x32x16_bf16 v[96:111], v[24:27], v[216:219], 0
    ds_read_b64_tr_b16 v[210:211], v240 offset:57856
    v_sub_f32 v118, v118, v232
    v_exp_f32 v118, v118
    v_sub_f32 v119, v119, v232
    v_exp_f32 v119, v119
    v_sub_f32 v120, v120, v232
    v_exp_f32 v120, v120
    v_sub_f32 v121, v121, v232
    v_exp_f32 v121, v121
    v_smfmac_f32_32x32x32_bf16 v[128:143], v[72:75], v[112:119], v246
    s_add_u32 s3, s78, 5
    s_and_b32 s3, s3, 7
    s_mul_i32 s3, s3, 2304
    s_add_u32 s3, s3, 116736
    v_add_u32 v227, s3, v225
    v_add_u32 v229, s3, v239
    v_sub_f32 v122, v122, v232
    v_exp_f32 v122, v122
    v_sub_f32 v123, v123, v232
    v_exp_f32 v123, v123
    v_sub_f32 v124, v124, v232
    v_exp_f32 v124, v124
    v_sub_f32 v125, v125, v232
    v_exp_f32 v125, v125
    s_waitcnt lgkmcnt(4)
    v_mfma_f32_32x32x16_bf16 v[176:191], v[212:215], v[200:203], v[176:191]
    s_add_u32 s3, s98, 73728
    buffer_load_dwordx4 v[200:203], v225, s[20:23], s3 offen sc1
    v_sub_f32 v126, v126, v232
    v_exp_f32 v126, v126
    v_sub_f32 v127, v127, v232
    v_exp_f32 v127, v127
    s_setprio 0
    v_sub_f32 v96, v96, v232
    v_exp_f32 v96, v96
    v_sub_f32 v97, v97, v232
    v_exp_f32 v97, v97
    v_smfmac_f32_32x32x32_bf16 v[128:143], v[76:79], v[120:127], v246
    ds_read_b64_tr_b16 v[212:213], v241 offset:57344
    v_sub_f32 v98, v98, v232
    v_exp_f32 v98, v98
    v_sub_f32 v99, v99, v232
    v_exp_f32 v99, v99
    v_sub_f32 v100, v100, v232
    v_exp_f32 v100, v100
    v_sub_f32 v101, v101, v232
    v_exp_f32 v101, v101
    v_mfma_f32_32x32x16_bf16 v[112:127], v[28:31], v[216:219], 0
    ds_read_b64_tr_b16 v[214:215], v241 offset:57856
    v_sub_f32 v102, v102, v232
    v_exp_f32 v102, v102
    v_sub_f32 v103, v103, v232
    v_exp_f32 v103, v103
    v_sub_f32 v104, v104, v232
    v_exp_f32 v104, v104
    v_sub_f32 v105, v105, v232
    v_exp_f32 v105, v105
    v_smfmac_f32_32x32x32_bf16 v[128:143], v[80:83], v[96:103], v246
    v_sub_f32 v106, v106, v232
    v_exp_f32 v106, v106
    v_sub_f32 v107, v107, v232
    v_exp_f32 v107, v107
    v_sub_f32 v108, v108, v232
    v_exp_f32 v108, v108
    v_sub_f32 v109, v109, v232
    v_exp_f32 v109, v109
    s_waitcnt lgkmcnt(2)
    s_waitcnt vmcnt(6)
    v_mfma_f32_32x32x16_bf16 v[160:175], v[208:211], v[204:207], v[160:175]
    v_sub_f32 v110, v110, v232
    v_exp_f32 v110, v110
    v_sub_f32 v111, v111, v232
    v_exp_f32 v111, v111
    s_setprio 3
    v_sub_f32 v112, v112, v232
    v_exp_f32 v112, v112
    v_sub_f32 v113, v113, v232
    v_exp_f32 v113, v113
    v_smfmac_f32_32x32x32_bf16 v[128:143], v[84:87], v[104:111], v246
    s_waitcnt vmcnt(2) lgkmcnt(0)
    s_barrier
    ds_read_b64_tr_b16 v[208:209], v240 offset:0
    v_sub_f32 v114, v114, v232
    v_exp_f32 v114, v114
    v_sub_f32 v115, v115, v232
    v_exp_f32 v115, v115
    v_sub_f32 v116, v116, v232
    v_exp_f32 v116, v116
    v_sub_f32 v117, v117, v232
    v_exp_f32 v117, v117
    v_mfma_f32_32x32x16_bf16 v[96:111], v[0:3], v[220:223], 0
    ds_read_b64_tr_b16 v[210:211], v240 offset:512
    ds_read_b128 v[144:147], v227 offset:0
    v_sub_f32 v118, v118, v232
    v_exp_f32 v118, v118
    v_sub_f32 v119, v119, v232
    v_exp_f32 v119, v119
    v_sub_f32 v120, v120, v232
    v_exp_f32 v120, v120
    v_sub_f32 v121, v121, v232
    v_exp_f32 v121, v121
    v_smfmac_f32_32x32x32_bf16 v[128:143], v[88:91], v[112:119], v246
    s_lshl_b32 s3, s78, 12
    s_add_u32 m0, s3, 32768
    s_lshl_b32 s3, s78, 15
    s_add_u32 s3, s3, 786432
    buffer_load_dwordx4 v238, s[24:27], s3 offen lds
    ds_read_b128 v[148:151], v227 offset:1024
    v_sub_f32 v122, v122, v232
    v_exp_f32 v122, v122
    v_sub_f32 v123, v123, v232
    v_exp_f32 v123, v123
    v_sub_f32 v124, v124, v232
    v_exp_f32 v124, v124
    v_sub_f32 v125, v125, v232
    v_exp_f32 v125, v125
    v_mfma_f32_32x32x16_bf16 v[176:191], v[212:215], v[204:207], v[176:191]
    s_add_u32 s3, s98, 77824
    buffer_load_dwordx4 v[204:207], v225, s[20:23], s3 offen sc1
    ds_read_b32 v152, v229 offset:2048
    v_sub_f32 v126, v126, v232
    v_exp_f32 v126, v126
    v_sub_f32 v127, v127, v232
    v_exp_f32 v127, v127
    v_sub_f32 v96, v96, v233
    v_exp_f32 v96, v96
    v_sub_f32 v97, v97, v233
    v_exp_f32 v97, v97
    v_smfmac_f32_32x32x32_bf16 v[128:143], v[92:95], v[120:127], v246
    ds_read_b64_tr_b16 v[212:213], v241 offset:0
    v_sub_f32 v98, v98, v233
    v_exp_f32 v98, v98
    v_sub_f32 v99, v99, v233
    v_exp_f32 v99, v99
    v_sub_f32 v100, v100, v233
    v_exp_f32 v100, v100
    v_sub_f32 v101, v101, v233
    v_exp_f32 v101, v101
    v_mfma_f32_32x32x16_bf16 v[112:127], v[4:7], v[220:223], 0
    ds_read_b64_tr_b16 v[214:215], v241 offset:512
    v_sub_f32 v102, v102, v233
    v_exp_f32 v102, v102
    v_sub_f32 v103, v103, v233
    v_exp_f32 v103, v103
    v_sub_f32 v104, v104, v233
    v_exp_f32 v104, v104
    v_sub_f32 v105, v105, v233
    v_exp_f32 v105, v105
    s_waitcnt lgkmcnt(2)
    v_smfmac_f32_32x32x32_bf16 v[144:159], v[32:35], v[96:103], v246
    s_lshl_b32 s3, s78, 12
    s_add_u32 m0, s3, 33792
    s_lshl_b32 s3, s78, 15
    s_add_u32 s3, s3, 794624
    buffer_load_dwordx4 v238, s[24:27], s3 offen lds
    v_sub_f32 v106, v106, v233
    v_exp_f32 v106, v106
    v_sub_f32 v107, v107, v233
    v_exp_f32 v107, v107
    v_sub_f32 v108, v108, v233
    v_exp_f32 v108, v108
    v_sub_f32 v109, v109, v233
    v_exp_f32 v109, v109
    v_mfma_f32_32x32x16_bf16 v[160:175], v[208:211], v[192:195], v[160:175]
    v_sub_f32 v110, v110, v233
    v_exp_f32 v110, v110
    v_sub_f32 v111, v111, v233
    v_exp_f32 v111, v111
    v_sub_f32 v112, v112, v233
    v_exp_f32 v112, v112
    v_sub_f32 v113, v113, v233
    v_exp_f32 v113, v113
    v_smfmac_f32_32x32x32_bf16 v[144:159], v[36:39], v[104:111], v246
    ds_read_b64_tr_b16 v[208:209], v240 offset:8192
    ds_write_b128 v226, v[128:131] offset:0
    v_sub_f32 v114, v114, v233
    v_exp_f32 v114, v114
    v_sub_f32 v115, v115, v233
    v_exp_f32 v115, v115
    v_sub_f32 v116, v116, v233
    v_exp_f32 v116, v116
    v_sub_f32 v117, v117, v233
    v_exp_f32 v117, v117
    v_mfma_f32_32x32x16_bf16 v[96:111], v[8:11], v[220:223], 0
    ds_read_b64_tr_b16 v[210:211], v240 offset:8704
    ds_write_b128 v226, v[132:135] offset:1024
    v_sub_f32 v118, v118, v233
    v_exp_f32 v118, v118
    v_sub_f32 v119, v119, v233
    v_exp_f32 v119, v119
    v_sub_f32 v120, v120, v233
    v_exp_f32 v120, v120
    v_sub_f32 v121, v121, v233
    v_exp_f32 v121, v121
    v_smfmac_f32_32x32x32_bf16 v[144:159], v[40:43], v[112:119], v246
    s_lshl_b32 s3, s78, 12
    s_add_u32 m0, s3, 34816
    s_lshl_b32 s3, s78, 15
    s_add_u32 s3, s3, 802816
    buffer_load_dwordx4 v238, s[24:27], s3 offen lds
    v_sub_f32 v122, v122, v233
    v_exp_f32 v122, v122
    v_sub_f32 v123, v123, v233
    v_exp_f32 v123, v123
    v_sub_f32 v124, v124, v233
    v_exp_f32 v124, v124
    v_sub_f32 v125, v125, v233
    v_exp_f32 v125, v125
    s_waitcnt lgkmcnt(4)
    v_mfma_f32_32x32x16_bf16 v[176:191], v[212:215], v[192:195], v[176:191]
    s_add_u32 s3, s98, 81920
    buffer_load_dwordx4 v[192:195], v225, s[20:23], s3 offen sc1
    ds_write_b32 v228, v136 offset:2048
    v_sub_f32 v126, v126, v233
    v_exp_f32 v126, v126
    v_sub_f32 v127, v127, v233
    v_exp_f32 v127, v127
    v_sub_f32 v96, v96, v233
    v_exp_f32 v96, v96
    v_sub_f32 v97, v97, v233
    v_exp_f32 v97, v97
    v_smfmac_f32_32x32x32_bf16 v[144:159], v[44:47], v[120:127], v246
    ds_read_b64_tr_b16 v[212:213], v241 offset:8192
    v_sub_f32 v98, v98, v233
    v_exp_f32 v98, v98
    v_sub_f32 v99, v99, v233
    v_exp_f32 v99, v99
    v_sub_f32 v100, v100, v233
    v_exp_f32 v100, v100
    v_sub_f32 v101, v101, v233
    v_exp_f32 v101, v101
    v_mfma_f32_32x32x16_bf16 v[112:127], v[12:15], v[220:223], 0
    ds_read_b64_tr_b16 v[214:215], v241 offset:8704
    v_sub_f32 v102, v102, v233
    v_exp_f32 v102, v102
    v_sub_f32 v103, v103, v233
    v_exp_f32 v103, v103
    v_sub_f32 v104, v104, v233
    v_exp_f32 v104, v104
    v_sub_f32 v105, v105, v233
    v_exp_f32 v105, v105
    v_smfmac_f32_32x32x32_bf16 v[144:159], v[48:51], v[96:103], v246
    s_lshl_b32 s3, s78, 12
    s_add_u32 m0, s3, 35840
    s_lshl_b32 s3, s78, 15
    s_add_u32 s3, s3, 811008
    buffer_load_dwordx4 v238, s[24:27], s3 offen lds
    v_sub_f32 v106, v106, v233
    v_exp_f32 v106, v106
    v_sub_f32 v107, v107, v233
    v_exp_f32 v107, v107
    v_sub_f32 v108, v108, v233
    v_exp_f32 v108, v108
    v_sub_f32 v109, v109, v233
    v_exp_f32 v109, v109
    s_waitcnt lgkmcnt(4)
    s_waitcnt vmcnt(7)
    v_mfma_f32_32x32x16_bf16 v[160:175], v[208:211], v[196:199], v[160:175]
    v_sub_f32 v110, v110, v233
    v_exp_f32 v110, v110
    v_sub_f32 v111, v111, v233
    v_exp_f32 v111, v111
    s_setprio 2
    v_sub_f32 v112, v112, v233
    v_exp_f32 v112, v112
    v_sub_f32 v113, v113, v233
    v_exp_f32 v113, v113
    v_smfmac_f32_32x32x32_bf16 v[144:159], v[52:55], v[104:111], v246
    ds_read_b64_tr_b16 v[208:209], v240 offset:16384
    v_sub_f32 v114, v114, v233
    v_exp_f32 v114, v114
    v_sub_f32 v115, v115, v233
    v_exp_f32 v115, v115
    v_sub_f32 v116, v116, v233
    v_exp_f32 v116, v116
    v_sub_f32 v117, v117, v233
    v_exp_f32 v117, v117
    v_mfma_f32_32x32x16_bf16 v[96:111], v[16:19], v[220:223], 0
    ds_read_b64_tr_b16 v[210:211], v240 offset:16896
    v_sub_f32 v118, v118, v233
    v_exp_f32 v118, v118
    v_sub_f32 v119, v119, v233
    v_exp_f32 v119, v119
    v_sub_f32 v120, v120, v233
    v_exp_f32 v120, v120
    v_sub_f32 v121, v121, v233
    v_exp_f32 v121, v121
    v_smfmac_f32_32x32x32_bf16 v[144:159], v[56:59], v[112:119], v246
    v_sub_f32 v122, v122, v233
    v_exp_f32 v122, v122
    v_sub_f32 v123, v123, v233
    v_exp_f32 v123, v123
    v_sub_f32 v124, v124, v233
    v_exp_f32 v124, v124
    v_sub_f32 v125, v125, v233
    v_exp_f32 v125, v125
    s_waitcnt lgkmcnt(2)
    v_mfma_f32_32x32x16_bf16 v[176:191], v[212:215], v[196:199], v[176:191]
    s_add_u32 s3, s98, 86016
    buffer_load_dwordx4 v[196:199], v225, s[20:23], s3 offen sc1
    v_sub_f32 v126, v126, v233
    v_exp_f32 v126, v126
    v_sub_f32 v127, v127, v233
    v_exp_f32 v127, v127
    v_sub_f32 v96, v96, v233
    v_exp_f32 v96, v96
    v_sub_f32 v97, v97, v233
    v_exp_f32 v97, v97
    v_smfmac_f32_32x32x32_bf16 v[144:159], v[60:63], v[120:127], v246
    ds_read_b64_tr_b16 v[212:213], v241 offset:16384
    v_sub_f32 v98, v98, v233
    v_exp_f32 v98, v98
    v_sub_f32 v99, v99, v233
    v_exp_f32 v99, v99
    v_sub_f32 v100, v100, v233
    v_exp_f32 v100, v100
    v_sub_f32 v101, v101, v233
    v_exp_f32 v101, v101
    v_mfma_f32_32x32x16_bf16 v[112:127], v[20:23], v[220:223], 0
    ds_read_b64_tr_b16 v[214:215], v241 offset:16896
    v_sub_f32 v102, v102, v233
    v_exp_f32 v102, v102
    v_sub_f32 v103, v103, v233
    v_exp_f32 v103, v103
    v_sub_f32 v104, v104, v233
    v_exp_f32 v104, v104
    v_sub_f32 v105, v105, v233
    v_exp_f32 v105, v105
    v_smfmac_f32_32x32x32_bf16 v[144:159], v[64:67], v[96:103], v246
    s_add_u32 s3, s78, 6
    s_and_b32 s3, s3, 7
    s_lshl_b32 s6, s3, 7
    v_add_u32 v237, s6, v236
    ds_read_b32 v232, v237
    s_lshl_b32 s3, s3, 10
    s_add_u32 s3, s3, 151552
    v_add_u32 v230, s3, v225
    ds_read_b128 v[216:219], v230
    v_sub_f32 v106, v106, v233
    v_exp_f32 v106, v106
    v_sub_f32 v107, v107, v233
    v_exp_f32 v107, v107
    v_sub_f32 v108, v108, v233
    v_exp_f32 v108, v108
    v_sub_f32 v109, v109, v233
    v_exp_f32 v109, v109
    s_waitcnt lgkmcnt(4)
    s_waitcnt vmcnt(7)
    v_mfma_f32_32x32x16_bf16 v[160:175], v[208:211], v[200:203], v[160:175]
    v_sub_f32 v110, v110, v233
    v_exp_f32 v110, v110
    v_sub_f32 v111, v111, v233
    v_exp_f32 v111, v111
    s_setprio 1
    v_sub_f32 v112, v112, v233
    v_exp_f32 v112, v112
    v_sub_f32 v113, v113, v233
    v_exp_f32 v113, v113
    v_smfmac_f32_32x32x32_bf16 v[144:159], v[68:71], v[104:111], v246
    ds_read_b64_tr_b16 v[208:209], v240 offset:24576
    v_sub_f32 v114, v114, v233
    v_exp_f32 v114, v114
    v_sub_f32 v115, v115, v233
    v_exp_f32 v115, v115
    v_sub_f32 v116, v116, v233
    v_exp_f32 v116, v116
    v_sub_f32 v117, v117, v233
    v_exp_f32 v117, v117
    v_mfma_f32_32x32x16_bf16 v[96:111], v[24:27], v[220:223], 0
    ds_read_b64_tr_b16 v[210:211], v240 offset:25088
    v_sub_f32 v118, v118, v233
    v_exp_f32 v118, v118
    v_sub_f32 v119, v119, v233
    v_exp_f32 v119, v119
    v_sub_f32 v120, v120, v233
    v_exp_f32 v120, v120
    v_sub_f32 v121, v121, v233
    v_exp_f32 v121, v121
    v_smfmac_f32_32x32x32_bf16 v[144:159], v[72:75], v[112:119], v246
    s_add_u32 s3, s78, 6
    s_and_b32 s3, s3, 7
    s_mul_i32 s3, s3, 2304
    s_add_u32 s3, s3, 98304
    v_add_u32 v226, s3, v225
    v_add_u32 v228, s3, v239
    v_sub_f32 v122, v122, v233
    v_exp_f32 v122, v122
    v_sub_f32 v123, v123, v233
    v_exp_f32 v123, v123
    v_sub_f32 v124, v124, v233
    v_exp_f32 v124, v124
    v_sub_f32 v125, v125, v233
    v_exp_f32 v125, v125
    s_waitcnt lgkmcnt(4)
    v_mfma_f32_32x32x16_bf16 v[176:191], v[212:215], v[200:203], v[176:191]
    s_add_u32 s3, s98, 90112
    buffer_load_dwordx4 v[200:203], v225, s[20:23], s3 offen sc1
    v_sub_f32 v126, v126, v233
    v_exp_f32 v126, v126
    v_sub_f32 v127, v127, v233
    v_exp_f32 v127, v127
    s_setprio 0
    v_sub_f32 v96, v96, v233
    v_exp_f32 v96, v96
    v_sub_f32 v97, v97, v233
    v_exp_f32 v97, v97
    v_smfmac_f32_32x32x32_bf16 v[144:159], v[76:79], v[120:127], v246
    ds_read_b64_tr_b16 v[212:213], v241 offset:24576
    v_sub_f32 v98, v98, v233
    v_exp_f32 v98, v98
    v_sub_f32 v99, v99, v233
    v_exp_f32 v99, v99
    v_sub_f32 v100, v100, v233
    v_exp_f32 v100, v100
    v_sub_f32 v101, v101, v233
    v_exp_f32 v101, v101
    v_mfma_f32_32x32x16_bf16 v[112:127], v[28:31], v[220:223], 0
    ds_read_b64_tr_b16 v[214:215], v241 offset:25088
    v_sub_f32 v102, v102, v233
    v_exp_f32 v102, v102
    v_sub_f32 v103, v103, v233
    v_exp_f32 v103, v103
    v_sub_f32 v104, v104, v233
    v_exp_f32 v104, v104
    v_sub_f32 v105, v105, v233
    v_exp_f32 v105, v105
    v_smfmac_f32_32x32x32_bf16 v[144:159], v[80:83], v[96:103], v246
    v_sub_f32 v106, v106, v233
    v_exp_f32 v106, v106
    v_sub_f32 v107, v107, v233
    v_exp_f32 v107, v107
    v_sub_f32 v108, v108, v233
    v_exp_f32 v108, v108
    v_sub_f32 v109, v109, v233
    v_exp_f32 v109, v109
    s_waitcnt lgkmcnt(2)
    s_waitcnt vmcnt(6)
    v_mfma_f32_32x32x16_bf16 v[160:175], v[208:211], v[204:207], v[160:175]
    v_sub_f32 v110, v110, v233
    v_exp_f32 v110, v110
    v_sub_f32 v111, v111, v233
    v_exp_f32 v111, v111
    s_setprio 3
    v_sub_f32 v112, v112, v233
    v_exp_f32 v112, v112
    v_sub_f32 v113, v113, v233
    v_exp_f32 v113, v113
    v_smfmac_f32_32x32x32_bf16 v[144:159], v[84:87], v[104:111], v246
    s_waitcnt vmcnt(2) lgkmcnt(0)
    s_barrier
    ds_read_b64_tr_b16 v[208:209], v240 offset:32768
    v_sub_f32 v114, v114, v233
    v_exp_f32 v114, v114
    v_sub_f32 v115, v115, v233
    v_exp_f32 v115, v115
    v_sub_f32 v116, v116, v233
    v_exp_f32 v116, v116
    v_sub_f32 v117, v117, v233
    v_exp_f32 v117, v117
    v_mfma_f32_32x32x16_bf16 v[96:111], v[0:3], v[216:219], 0
    ds_read_b64_tr_b16 v[210:211], v240 offset:33280
    ds_read_b128 v[128:131], v226 offset:0
    v_sub_f32 v118, v118, v233
    v_exp_f32 v118, v118
    v_sub_f32 v119, v119, v233
    v_exp_f32 v119, v119
    v_sub_f32 v120, v120, v233
    v_exp_f32 v120, v120
    v_sub_f32 v121, v121, v233
    v_exp_f32 v121, v121
    v_smfmac_f32_32x32x32_bf16 v[144:159], v[88:91], v[112:119], v246
    s_lshl_b32 s3, s78, 12
    s_add_u32 m0, s3, 0
    s_lshl_b32 s3, s78, 15
    s_add_u32 s3, s3, 1048576
    buffer_load_dwordx4 v238, s[24:27], s3 offen lds
    ds_read_b128 v[132:135], v226 offset:1024
    v_sub_f32 v122, v122, v233
    v_exp_f32 v122, v122
    v_sub_f32 v123, v123, v233
    v_exp_f32 v123, v123
    v_sub_f32 v124, v124, v233
    v_exp_f32 v124, v124
    v_sub_f32 v125, v125, v233
    v_exp_f32 v125, v125
    v_mfma_f32_32x32x16_bf16 v[176:191], v[212:215], v[204:207], v[176:191]
    s_add_u32 s3, s98, 94208
    buffer_load_dwordx4 v[204:207], v225, s[20:23], s3 offen sc1
    ds_read_b32 v136, v228 offset:2048
    v_sub_f32 v126, v126, v233
    v_exp_f32 v126, v126
    v_sub_f32 v127, v127, v233
    v_exp_f32 v127, v127
    v_sub_f32 v96, v96, v232
    v_exp_f32 v96, v96
    v_sub_f32 v97, v97, v232
    v_exp_f32 v97, v97
    v_smfmac_f32_32x32x32_bf16 v[144:159], v[92:95], v[120:127], v246
    ds_read_b64_tr_b16 v[212:213], v241 offset:32768
    v_sub_f32 v98, v98, v232
    v_exp_f32 v98, v98
    v_sub_f32 v99, v99, v232
    v_exp_f32 v99, v99
    v_sub_f32 v100, v100, v232
    v_exp_f32 v100, v100
    v_sub_f32 v101, v101, v232
    v_exp_f32 v101, v101
    v_mfma_f32_32x32x16_bf16 v[112:127], v[4:7], v[216:219], 0
    ds_read_b64_tr_b16 v[214:215], v241 offset:33280
    v_sub_f32 v102, v102, v232
    v_exp_f32 v102, v102
    v_sub_f32 v103, v103, v232
    v_exp_f32 v103, v103
    v_sub_f32 v104, v104, v232
    v_exp_f32 v104, v104
    v_sub_f32 v105, v105, v232
    v_exp_f32 v105, v105
    s_waitcnt lgkmcnt(2)
    v_smfmac_f32_32x32x32_bf16 v[128:143], v[32:35], v[96:103], v246
    s_lshl_b32 s3, s78, 12
    s_add_u32 m0, s3, 1024
    s_lshl_b32 s3, s78, 15
    s_add_u32 s3, s3, 1056768
    buffer_load_dwordx4 v238, s[24:27], s3 offen lds
    v_sub_f32 v106, v106, v232
    v_exp_f32 v106, v106
    v_sub_f32 v107, v107, v232
    v_exp_f32 v107, v107
    v_sub_f32 v108, v108, v232
    v_exp_f32 v108, v108
    v_sub_f32 v109, v109, v232
    v_exp_f32 v109, v109
    v_mfma_f32_32x32x16_bf16 v[160:175], v[208:211], v[192:195], v[160:175]
    v_sub_f32 v110, v110, v232
    v_exp_f32 v110, v110
    v_sub_f32 v111, v111, v232
    v_exp_f32 v111, v111
    v_sub_f32 v112, v112, v232
    v_exp_f32 v112, v112
    v_sub_f32 v113, v113, v232
    v_exp_f32 v113, v113
    v_smfmac_f32_32x32x32_bf16 v[128:143], v[36:39], v[104:111], v246
    ds_read_b64_tr_b16 v[208:209], v240 offset:40960
    ds_write_b128 v227, v[144:147] offset:0
    v_sub_f32 v114, v114, v232
    v_exp_f32 v114, v114
    v_sub_f32 v115, v115, v232
    v_exp_f32 v115, v115
    v_sub_f32 v116, v116, v232
    v_exp_f32 v116, v116
    v_sub_f32 v117, v117, v232
    v_exp_f32 v117, v117
    v_mfma_f32_32x32x16_bf16 v[96:111], v[8:11], v[216:219], 0
    ds_read_b64_tr_b16 v[210:211], v240 offset:41472
    ds_write_b128 v227, v[148:151] offset:1024
    v_sub_f32 v118, v118, v232
    v_exp_f32 v118, v118
    v_sub_f32 v119, v119, v232
    v_exp_f32 v119, v119
    v_sub_f32 v120, v120, v232
    v_exp_f32 v120, v120
    v_sub_f32 v121, v121, v232
    v_exp_f32 v121, v121
    v_smfmac_f32_32x32x32_bf16 v[128:143], v[40:43], v[112:119], v246
    s_lshl_b32 s3, s78, 12
    s_add_u32 m0, s3, 2048
    s_lshl_b32 s3, s78, 15
    s_add_u32 s3, s3, 1064960
    buffer_load_dwordx4 v238, s[24:27], s3 offen lds
    v_sub_f32 v122, v122, v232
    v_exp_f32 v122, v122
    v_sub_f32 v123, v123, v232
    v_exp_f32 v123, v123
    v_sub_f32 v124, v124, v232
    v_exp_f32 v124, v124
    v_sub_f32 v125, v125, v232
    v_exp_f32 v125, v125
    s_waitcnt lgkmcnt(4)
    v_mfma_f32_32x32x16_bf16 v[176:191], v[212:215], v[192:195], v[176:191]
    s_add_u32 s3, s98, 98304
    buffer_load_dwordx4 v[192:195], v225, s[20:23], s3 offen sc1
    ds_write_b32 v229, v152 offset:2048
    v_sub_f32 v126, v126, v232
    v_exp_f32 v126, v126
    v_sub_f32 v127, v127, v232
    v_exp_f32 v127, v127
    v_sub_f32 v96, v96, v232
    v_exp_f32 v96, v96
    v_sub_f32 v97, v97, v232
    v_exp_f32 v97, v97
    v_smfmac_f32_32x32x32_bf16 v[128:143], v[44:47], v[120:127], v246
    ds_read_b64_tr_b16 v[212:213], v241 offset:40960
    v_sub_f32 v98, v98, v232
    v_exp_f32 v98, v98
    v_sub_f32 v99, v99, v232
    v_exp_f32 v99, v99
    v_sub_f32 v100, v100, v232
    v_exp_f32 v100, v100
    v_sub_f32 v101, v101, v232
    v_exp_f32 v101, v101
    v_mfma_f32_32x32x16_bf16 v[112:127], v[12:15], v[216:219], 0
    ds_read_b64_tr_b16 v[214:215], v241 offset:41472
    v_sub_f32 v102, v102, v232
    v_exp_f32 v102, v102
    v_sub_f32 v103, v103, v232
    v_exp_f32 v103, v103
    v_sub_f32 v104, v104, v232
    v_exp_f32 v104, v104
    v_sub_f32 v105, v105, v232
    v_exp_f32 v105, v105
    v_smfmac_f32_32x32x32_bf16 v[128:143], v[48:51], v[96:103], v246
    s_lshl_b32 s3, s78, 12
    s_add_u32 m0, s3, 3072
    s_lshl_b32 s3, s78, 15
    s_add_u32 s3, s3, 1073152
    buffer_load_dwordx4 v238, s[24:27], s3 offen lds
    v_sub_f32 v106, v106, v232
    v_exp_f32 v106, v106
    v_sub_f32 v107, v107, v232
    v_exp_f32 v107, v107
    v_sub_f32 v108, v108, v232
    v_exp_f32 v108, v108
    v_sub_f32 v109, v109, v232
    v_exp_f32 v109, v109
    s_waitcnt lgkmcnt(4)
    s_waitcnt vmcnt(7)
    v_mfma_f32_32x32x16_bf16 v[160:175], v[208:211], v[196:199], v[160:175]
    v_sub_f32 v110, v110, v232
    v_exp_f32 v110, v110
    v_sub_f32 v111, v111, v232
    v_exp_f32 v111, v111
    s_setprio 2
    v_sub_f32 v112, v112, v232
    v_exp_f32 v112, v112
    v_sub_f32 v113, v113, v232
    v_exp_f32 v113, v113
    v_smfmac_f32_32x32x32_bf16 v[128:143], v[52:55], v[104:111], v246
    ds_read_b64_tr_b16 v[208:209], v240 offset:49152
    v_sub_f32 v114, v114, v232
    v_exp_f32 v114, v114
    v_sub_f32 v115, v115, v232
    v_exp_f32 v115, v115
    v_sub_f32 v116, v116, v232
    v_exp_f32 v116, v116
    v_sub_f32 v117, v117, v232
    v_exp_f32 v117, v117
    v_mfma_f32_32x32x16_bf16 v[96:111], v[16:19], v[216:219], 0
    ds_read_b64_tr_b16 v[210:211], v240 offset:49664
    v_sub_f32 v118, v118, v232
    v_exp_f32 v118, v118
    v_sub_f32 v119, v119, v232
    v_exp_f32 v119, v119
    v_sub_f32 v120, v120, v232
    v_exp_f32 v120, v120
    v_sub_f32 v121, v121, v232
    v_exp_f32 v121, v121
    v_smfmac_f32_32x32x32_bf16 v[128:143], v[56:59], v[112:119], v246
    v_sub_f32 v122, v122, v232
    v_exp_f32 v122, v122
    v_sub_f32 v123, v123, v232
    v_exp_f32 v123, v123
    v_sub_f32 v124, v124, v232
    v_exp_f32 v124, v124
    v_sub_f32 v125, v125, v232
    v_exp_f32 v125, v125
    s_waitcnt lgkmcnt(2)
    v_mfma_f32_32x32x16_bf16 v[176:191], v[212:215], v[196:199], v[176:191]
    s_add_u32 s3, s98, 102400
    buffer_load_dwordx4 v[196:199], v225, s[20:23], s3 offen sc1
    v_sub_f32 v126, v126, v232
    v_exp_f32 v126, v126
    v_sub_f32 v127, v127, v232
    v_exp_f32 v127, v127
    v_sub_f32 v96, v96, v232
    v_exp_f32 v96, v96
    v_sub_f32 v97, v97, v232
    v_exp_f32 v97, v97
    v_smfmac_f32_32x32x32_bf16 v[128:143], v[60:63], v[120:127], v246
    ds_read_b64_tr_b16 v[212:213], v241 offset:49152
    v_sub_f32 v98, v98, v232
    v_exp_f32 v98, v98
    v_sub_f32 v99, v99, v232
    v_exp_f32 v99, v99
    v_sub_f32 v100, v100, v232
    v_exp_f32 v100, v100
    v_sub_f32 v101, v101, v232
    v_exp_f32 v101, v101
    v_mfma_f32_32x32x16_bf16 v[112:127], v[20:23], v[216:219], 0
    ds_read_b64_tr_b16 v[214:215], v241 offset:49664
    v_sub_f32 v102, v102, v232
    v_exp_f32 v102, v102
    v_sub_f32 v103, v103, v232
    v_exp_f32 v103, v103
    v_sub_f32 v104, v104, v232
    v_exp_f32 v104, v104
    v_sub_f32 v105, v105, v232
    v_exp_f32 v105, v105
    v_smfmac_f32_32x32x32_bf16 v[128:143], v[64:67], v[96:103], v246
    s_add_u32 s3, s78, 7
    s_and_b32 s3, s3, 7
    s_lshl_b32 s6, s3, 7
    v_add_u32 v237, s6, v236
    ds_read_b32 v233, v237
    s_lshl_b32 s3, s3, 10
    s_add_u32 s3, s3, 151552
    v_add_u32 v230, s3, v225
    ds_read_b128 v[220:223], v230
    v_sub_f32 v106, v106, v232
    v_exp_f32 v106, v106
    v_sub_f32 v107, v107, v232
    v_exp_f32 v107, v107
    v_sub_f32 v108, v108, v232
    v_exp_f32 v108, v108
    v_sub_f32 v109, v109, v232
    v_exp_f32 v109, v109
    s_waitcnt lgkmcnt(4)
    s_waitcnt vmcnt(7)
    v_mfma_f32_32x32x16_bf16 v[160:175], v[208:211], v[200:203], v[160:175]
    v_sub_f32 v110, v110, v232
    v_exp_f32 v110, v110
    v_sub_f32 v111, v111, v232
    v_exp_f32 v111, v111
    s_setprio 1
    v_sub_f32 v112, v112, v232
    v_exp_f32 v112, v112
    v_sub_f32 v113, v113, v232
    v_exp_f32 v113, v113
    v_smfmac_f32_32x32x32_bf16 v[128:143], v[68:71], v[104:111], v246
    ds_read_b64_tr_b16 v[208:209], v240 offset:57344
    v_sub_f32 v114, v114, v232
    v_exp_f32 v114, v114
    v_sub_f32 v115, v115, v232
    v_exp_f32 v115, v115
    v_sub_f32 v116, v116, v232
    v_exp_f32 v116, v116
    v_sub_f32 v117, v117, v232
    v_exp_f32 v117, v117
    v_mfma_f32_32x32x16_bf16 v[96:111], v[24:27], v[216:219], 0
    ds_read_b64_tr_b16 v[210:211], v240 offset:57856
    v_sub_f32 v118, v118, v232
    v_exp_f32 v118, v118
    v_sub_f32 v119, v119, v232
    v_exp_f32 v119, v119
    v_sub_f32 v120, v120, v232
    v_exp_f32 v120, v120
    v_sub_f32 v121, v121, v232
    v_exp_f32 v121, v121
    v_smfmac_f32_32x32x32_bf16 v[128:143], v[72:75], v[112:119], v246
    s_add_u32 s3, s78, 7
    s_and_b32 s3, s3, 7
    s_mul_i32 s3, s3, 2304
    s_add_u32 s3, s3, 116736
    v_add_u32 v227, s3, v225
    v_add_u32 v229, s3, v239
    v_sub_f32 v122, v122, v232
    v_exp_f32 v122, v122
    v_sub_f32 v123, v123, v232
    v_exp_f32 v123, v123
    v_sub_f32 v124, v124, v232
    v_exp_f32 v124, v124
    v_sub_f32 v125, v125, v232
    v_exp_f32 v125, v125
    s_waitcnt lgkmcnt(4)
    v_mfma_f32_32x32x16_bf16 v[176:191], v[212:215], v[200:203], v[176:191]
    s_add_u32 s3, s98, 106496
    buffer_load_dwordx4 v[200:203], v225, s[20:23], s3 offen sc1
    v_sub_f32 v126, v126, v232
    v_exp_f32 v126, v126
    v_sub_f32 v127, v127, v232
    v_exp_f32 v127, v127
    s_setprio 0
    v_sub_f32 v96, v96, v232
    v_exp_f32 v96, v96
    v_sub_f32 v97, v97, v232
    v_exp_f32 v97, v97
    v_smfmac_f32_32x32x32_bf16 v[128:143], v[76:79], v[120:127], v246
    ds_read_b64_tr_b16 v[212:213], v241 offset:57344
    v_sub_f32 v98, v98, v232
    v_exp_f32 v98, v98
    v_sub_f32 v99, v99, v232
    v_exp_f32 v99, v99
    v_sub_f32 v100, v100, v232
    v_exp_f32 v100, v100
    v_sub_f32 v101, v101, v232
    v_exp_f32 v101, v101
    v_mfma_f32_32x32x16_bf16 v[112:127], v[28:31], v[216:219], 0
    ds_read_b64_tr_b16 v[214:215], v241 offset:57856
    v_sub_f32 v102, v102, v232
    v_exp_f32 v102, v102
    v_sub_f32 v103, v103, v232
    v_exp_f32 v103, v103
    v_sub_f32 v104, v104, v232
    v_exp_f32 v104, v104
    v_sub_f32 v105, v105, v232
    v_exp_f32 v105, v105
    v_smfmac_f32_32x32x32_bf16 v[128:143], v[80:83], v[96:103], v246
    v_sub_f32 v106, v106, v232
    v_exp_f32 v106, v106
    v_sub_f32 v107, v107, v232
    v_exp_f32 v107, v107
    v_sub_f32 v108, v108, v232
    v_exp_f32 v108, v108
    v_sub_f32 v109, v109, v232
    v_exp_f32 v109, v109
    s_waitcnt lgkmcnt(2)
    s_waitcnt vmcnt(6)
    v_mfma_f32_32x32x16_bf16 v[160:175], v[208:211], v[204:207], v[160:175]
    v_sub_f32 v110, v110, v232
    v_exp_f32 v110, v110
    v_sub_f32 v111, v111, v232
    v_exp_f32 v111, v111
    s_setprio 3
    v_sub_f32 v112, v112, v232
    v_exp_f32 v112, v112
    v_sub_f32 v113, v113, v232
    v_exp_f32 v113, v113
    v_smfmac_f32_32x32x32_bf16 v[128:143], v[84:87], v[104:111], v246
    s_waitcnt lgkmcnt(0)
    s_barrier
    v_sub_f32 v114, v114, v232
    v_exp_f32 v114, v114
    v_sub_f32 v115, v115, v232
    v_exp_f32 v115, v115
    v_sub_f32 v116, v116, v232
    v_exp_f32 v116, v116
    v_sub_f32 v117, v117, v232
    v_exp_f32 v117, v117
    v_mfma_f32_32x32x16_bf16 v[96:111], v[0:3], v[220:223], 0
    ds_read_b128 v[144:147], v227 offset:0
    v_sub_f32 v118, v118, v232
    v_exp_f32 v118, v118
    v_sub_f32 v119, v119, v232
    v_exp_f32 v119, v119
    v_sub_f32 v120, v120, v232
    v_exp_f32 v120, v120
    v_sub_f32 v121, v121, v232
    v_exp_f32 v121, v121
    v_smfmac_f32_32x32x32_bf16 v[128:143], v[88:91], v[112:119], v246
    ds_read_b128 v[148:151], v227 offset:1024
    s_lshl_b32 s3, s78, 12
    s_add_u32 m0, s3, 32768
    s_lshl_b32 s3, s78, 15
    s_add_u32 s3, s3, 0
    buffer_load_dwordx4 v238, s[28:31], s3 offen lds
    v_sub_f32 v122, v122, v232
    v_exp_f32 v122, v122
    v_sub_f32 v123, v123, v232
    v_exp_f32 v123, v123
    v_sub_f32 v124, v124, v232
    v_exp_f32 v124, v124
    v_sub_f32 v125, v125, v232
    v_exp_f32 v125, v125
    v_mfma_f32_32x32x16_bf16 v[176:191], v[212:215], v[204:207], v[176:191]
    s_add_u32 s3, s98, 110592
    buffer_load_dwordx4 v[204:207], v225, s[20:23], s3 offen sc1
    ds_read_b32 v152, v229 offset:2048
    v_sub_f32 v126, v126, v232
    v_exp_f32 v126, v126
    v_sub_f32 v127, v127, v232
    v_exp_f32 v127, v127
    v_sub_f32 v96, v96, v233
    v_exp_f32 v96, v96
    v_sub_f32 v97, v97, v233
    v_exp_f32 v97, v97
    v_smfmac_f32_32x32x32_bf16 v[128:143], v[92:95], v[120:127], v246
    v_sub_f32 v98, v98, v233
    v_exp_f32 v98, v98
    v_sub_f32 v99, v99, v233
    v_exp_f32 v99, v99
    v_sub_f32 v100, v100, v233
    v_exp_f32 v100, v100
    v_sub_f32 v101, v101, v233
    v_exp_f32 v101, v101
    v_mfma_f32_32x32x16_bf16 v[112:127], v[4:7], v[220:223], 0
    v_sub_f32 v102, v102, v233
    v_exp_f32 v102, v102
    v_sub_f32 v103, v103, v233
    v_exp_f32 v103, v103
    v_sub_f32 v104, v104, v233
    v_exp_f32 v104, v104
    v_sub_f32 v105, v105, v233
    v_exp_f32 v105, v105
    s_waitcnt lgkmcnt(0)
    v_smfmac_f32_32x32x32_bf16 v[144:159], v[32:35], v[96:103], v246
    s_lshl_b32 s3, s78, 12
    s_add_u32 m0, s3, 33792
    s_lshl_b32 s3, s78, 15
    s_add_u32 s3, s3, 8192
    buffer_load_dwordx4 v238, s[28:31], s3 offen lds
    v_sub_f32 v106, v106, v233
    v_exp_f32 v106, v106
    v_sub_f32 v107, v107, v233
    v_exp_f32 v107, v107
    v_sub_f32 v108, v108, v233
    v_exp_f32 v108, v108
    v_sub_f32 v109, v109, v233
    v_exp_f32 v109, v109
    s_nop 0
    v_sub_f32 v110, v110, v233
    v_exp_f32 v110, v110
    v_sub_f32 v111, v111, v233
    v_exp_f32 v111, v111
    v_sub_f32 v112, v112, v233
    v_exp_f32 v112, v112
    v_sub_f32 v113, v113, v233
    v_exp_f32 v113, v113
    v_smfmac_f32_32x32x32_bf16 v[144:159], v[36:39], v[104:111], v246
    ds_write_b128 v226, v[128:131] offset:0
    v_sub_f32 v114, v114, v233
    v_exp_f32 v114, v114
    v_sub_f32 v115, v115, v233
    v_exp_f32 v115, v115
    v_sub_f32 v116, v116, v233
    v_exp_f32 v116, v116
    v_sub_f32 v117, v117, v233
    v_exp_f32 v117, v117
    v_mfma_f32_32x32x16_bf16 v[96:111], v[8:11], v[220:223], 0
    ds_write_b128 v226, v[132:135] offset:1024
    v_sub_f32 v118, v118, v233
    v_exp_f32 v118, v118
    v_sub_f32 v119, v119, v233
    v_exp_f32 v119, v119
    v_sub_f32 v120, v120, v233
    v_exp_f32 v120, v120
    v_sub_f32 v121, v121, v233
    v_exp_f32 v121, v121
    v_smfmac_f32_32x32x32_bf16 v[144:159], v[40:43], v[112:119], v246
    s_lshl_b32 s3, s78, 12
    s_add_u32 m0, s3, 34816
    s_lshl_b32 s3, s78, 15
    s_add_u32 s3, s3, 16384
    buffer_load_dwordx4 v238, s[28:31], s3 offen lds
    v_sub_f32 v122, v122, v233
    v_exp_f32 v122, v122
    v_sub_f32 v123, v123, v233
    v_exp_f32 v123, v123
    v_sub_f32 v124, v124, v233
    v_exp_f32 v124, v124
    v_sub_f32 v125, v125, v233
    v_exp_f32 v125, v125
    s_nop 0
    ds_write_b32 v228, v136 offset:2048
    v_sub_f32 v126, v126, v233
    v_exp_f32 v126, v126
    v_sub_f32 v127, v127, v233
    v_exp_f32 v127, v127
    v_sub_f32 v96, v96, v233
    v_exp_f32 v96, v96
    v_sub_f32 v97, v97, v233
    v_exp_f32 v97, v97
    v_smfmac_f32_32x32x32_bf16 v[144:159], v[44:47], v[120:127], v246
    v_sub_f32 v98, v98, v233
    v_exp_f32 v98, v98
    v_sub_f32 v99, v99, v233
    v_exp_f32 v99, v99
    v_sub_f32 v100, v100, v233
    v_exp_f32 v100, v100
    v_sub_f32 v101, v101, v233
    v_exp_f32 v101, v101
    v_mfma_f32_32x32x16_bf16 v[112:127], v[12:15], v[220:223], 0
    v_sub_f32 v102, v102, v233
    v_exp_f32 v102, v102
    v_sub_f32 v103, v103, v233
    v_exp_f32 v103, v103
    v_sub_f32 v104, v104, v233
    v_exp_f32 v104, v104
    v_sub_f32 v105, v105, v233
    v_exp_f32 v105, v105
    v_smfmac_f32_32x32x32_bf16 v[144:159], v[48:51], v[96:103], v246
    s_lshl_b32 s3, s78, 12
    s_add_u32 m0, s3, 35840
    s_lshl_b32 s3, s78, 15
    s_add_u32 s3, s3, 24576
    buffer_load_dwordx4 v238, s[28:31], s3 offen lds
    v_sub_f32 v106, v106, v233
    v_exp_f32 v106, v106
    v_sub_f32 v107, v107, v233
    v_exp_f32 v107, v107
    v_sub_f32 v108, v108, v233
    v_exp_f32 v108, v108
    v_sub_f32 v109, v109, v233
    v_exp_f32 v109, v109
    s_nop 0
    v_sub_f32 v110, v110, v233
    v_exp_f32 v110, v110
    v_sub_f32 v111, v111, v233
    v_exp_f32 v111, v111
    s_setprio 2
    v_sub_f32 v112, v112, v233
    v_exp_f32 v112, v112
    v_sub_f32 v113, v113, v233
    v_exp_f32 v113, v113
    v_smfmac_f32_32x32x32_bf16 v[144:159], v[52:55], v[104:111], v246
    v_sub_f32 v114, v114, v233
    v_exp_f32 v114, v114
    v_sub_f32 v115, v115, v233
    v_exp_f32 v115, v115
    v_sub_f32 v116, v116, v233
    v_exp_f32 v116, v116
    v_sub_f32 v117, v117, v233
    v_exp_f32 v117, v117
    v_mfma_f32_32x32x16_bf16 v[96:111], v[16:19], v[220:223], 0
    v_sub_f32 v118, v118, v233
    v_exp_f32 v118, v118
    v_sub_f32 v119, v119, v233
    v_exp_f32 v119, v119
    v_sub_f32 v120, v120, v233
    v_exp_f32 v120, v120
    v_sub_f32 v121, v121, v233
    v_exp_f32 v121, v121
    v_smfmac_f32_32x32x32_bf16 v[144:159], v[56:59], v[112:119], v246
    v_sub_f32 v122, v122, v233
    v_exp_f32 v122, v122
    v_sub_f32 v123, v123, v233
    v_exp_f32 v123, v123
    v_sub_f32 v124, v124, v233
    v_exp_f32 v124, v124
    v_sub_f32 v125, v125, v233
    v_exp_f32 v125, v125
    s_nop 0
    v_sub_f32 v126, v126, v233
    v_exp_f32 v126, v126
    v_sub_f32 v127, v127, v233
    v_exp_f32 v127, v127
    v_sub_f32 v96, v96, v233
    v_exp_f32 v96, v96
    v_sub_f32 v97, v97, v233
    v_exp_f32 v97, v97
    v_smfmac_f32_32x32x32_bf16 v[144:159], v[60:63], v[120:127], v246
    v_sub_f32 v98, v98, v233
    v_exp_f32 v98, v98
    v_sub_f32 v99, v99, v233
    v_exp_f32 v99, v99
    v_sub_f32 v100, v100, v233
    v_exp_f32 v100, v100
    v_sub_f32 v101, v101, v233
    v_exp_f32 v101, v101
    v_mfma_f32_32x32x16_bf16 v[112:127], v[20:23], v[220:223], 0
    v_sub_f32 v102, v102, v233
    v_exp_f32 v102, v102
    v_sub_f32 v103, v103, v233
    v_exp_f32 v103, v103
    v_sub_f32 v104, v104, v233
    v_exp_f32 v104, v104
    v_sub_f32 v105, v105, v233
    v_exp_f32 v105, v105
    v_smfmac_f32_32x32x32_bf16 v[144:159], v[64:67], v[96:103], v246
    s_add_u32 s3, s98, 114688
    buffer_load_dwordx4 v[208:211], v225, s[20:23], s3 offen sc1
    v_sub_f32 v106, v106, v233
    v_exp_f32 v106, v106
    v_sub_f32 v107, v107, v233
    v_exp_f32 v107, v107
    v_sub_f32 v108, v108, v233
    v_exp_f32 v108, v108
    v_sub_f32 v109, v109, v233
    v_exp_f32 v109, v109
    s_nop 0
    v_sub_f32 v110, v110, v233
    v_exp_f32 v110, v110
    v_sub_f32 v111, v111, v233
    v_exp_f32 v111, v111
    s_setprio 1
    v_sub_f32 v112, v112, v233
    v_exp_f32 v112, v112
    v_sub_f32 v113, v113, v233
    v_exp_f32 v113, v113
    v_smfmac_f32_32x32x32_bf16 v[144:159], v[68:71], v[104:111], v246
    v_sub_f32 v114, v114, v233
    v_exp_f32 v114, v114
    v_sub_f32 v115, v115, v233
    v_exp_f32 v115, v115
    v_sub_f32 v116, v116, v233
    v_exp_f32 v116, v116
    v_sub_f32 v117, v117, v233
    v_exp_f32 v117, v117
    v_mfma_f32_32x32x16_bf16 v[96:111], v[24:27], v[220:223], 0
    v_sub_f32 v118, v118, v233
    v_exp_f32 v118, v118
    v_sub_f32 v119, v119, v233
    v_exp_f32 v119, v119
    v_sub_f32 v120, v120, v233
    v_exp_f32 v120, v120
    v_sub_f32 v121, v121, v233
    v_exp_f32 v121, v121
    v_smfmac_f32_32x32x32_bf16 v[144:159], v[72:75], v[112:119], v246
    s_add_u32 s3, s78, 7
    s_and_b32 s3, s3, 7
    s_mul_i32 s3, s3, 2304
    s_add_u32 s3, s3, 98304
    v_add_u32 v226, s3, v225
    v_add_u32 v228, s3, v239
    s_add_u32 s3, s98, 118784
    s_cmp_lt_u32 s78, 4
    s_cselect_b32 s3, s3, 0x80000000
    buffer_load_dwordx4 v[212:215], v225, s[20:23], s3 offen sc1
    v_sub_f32 v122, v122, v233
    v_exp_f32 v122, v122
    v_sub_f32 v123, v123, v233
    v_exp_f32 v123, v123
    v_sub_f32 v124, v124, v233
    v_exp_f32 v124, v124
    v_sub_f32 v125, v125, v233
    v_exp_f32 v125, v125
    s_nop 0
    v_sub_f32 v126, v126, v233
    v_exp_f32 v126, v126
    v_sub_f32 v127, v127, v233
    v_exp_f32 v127, v127
    s_setprio 0
    v_sub_f32 v96, v96, v233
    v_exp_f32 v96, v96
    v_sub_f32 v97, v97, v233
    v_exp_f32 v97, v97
    v_smfmac_f32_32x32x32_bf16 v[144:159], v[76:79], v[120:127], v246
    v_sub_f32 v98, v98, v233
    v_exp_f32 v98, v98
    v_sub_f32 v99, v99, v233
    v_exp_f32 v99, v99
    v_sub_f32 v100, v100, v233
    v_exp_f32 v100, v100
    v_sub_f32 v101, v101, v233
    v_exp_f32 v101, v101
    v_mfma_f32_32x32x16_bf16 v[112:127], v[28:31], v[220:223], 0
    v_sub_f32 v102, v102, v233
    v_exp_f32 v102, v102
    v_sub_f32 v103, v103, v233
    v_exp_f32 v103, v103
    v_sub_f32 v104, v104, v233
    v_exp_f32 v104, v104
    v_sub_f32 v105, v105, v233
    v_exp_f32 v105, v105
    v_smfmac_f32_32x32x32_bf16 v[144:159], v[80:83], v[96:103], v246
    v_sub_f32 v106, v106, v233
    v_exp_f32 v106, v106
    v_sub_f32 v107, v107, v233
    v_exp_f32 v107, v107
    v_sub_f32 v108, v108, v233
    v_exp_f32 v108, v108
    v_sub_f32 v109, v109, v233
    v_exp_f32 v109, v109
    s_nop 0
    v_sub_f32 v110, v110, v233
    v_exp_f32 v110, v110
    v_sub_f32 v111, v111, v233
    v_exp_f32 v111, v111
    s_setprio 3
    v_sub_f32 v112, v112, v233
    v_exp_f32 v112, v112
    v_sub_f32 v113, v113, v233
    v_exp_f32 v113, v113
    v_smfmac_f32_32x32x32_bf16 v[144:159], v[84:87], v[104:111], v246
    s_waitcnt vmcnt(2) lgkmcnt(0)
    s_barrier
    v_sub_f32 v114, v114, v233
    v_exp_f32 v114, v114
    v_sub_f32 v115, v115, v233
    v_exp_f32 v115, v115
    v_sub_f32 v116, v116, v233
    v_exp_f32 v116, v116
    v_sub_f32 v117, v117, v233
    v_exp_f32 v117, v117
    ds_read_b128 v[128:131], v226 offset:0
    v_sub_f32 v118, v118, v233
    v_exp_f32 v118, v118
    v_sub_f32 v119, v119, v233
    v_exp_f32 v119, v119
    v_sub_f32 v120, v120, v233
    v_exp_f32 v120, v120
    v_sub_f32 v121, v121, v233
    v_exp_f32 v121, v121
    v_smfmac_f32_32x32x32_bf16 v[144:159], v[88:91], v[112:119], v246
    ds_read_b128 v[132:135], v226 offset:1024
    v_sub_f32 v122, v122, v233
    v_exp_f32 v122, v122
    v_sub_f32 v123, v123, v233
    v_exp_f32 v123, v123
    v_sub_f32 v124, v124, v233
    v_exp_f32 v124, v124
    v_sub_f32 v125, v125, v233
    v_exp_f32 v125, v125
    s_nop 0
    ds_read_b32 v136, v228 offset:2048
    v_sub_f32 v126, v126, v233
    v_exp_f32 v126, v126
    v_sub_f32 v127, v127, v233
    v_exp_f32 v127, v127
    s_nop 1
    v_smfmac_f32_32x32x32_bf16 v[144:159], v[92:95], v[120:127], v246
    s_branch L_tail
.section .rodata,"a"
.p2align 6
.amdhsa_kernel gated_mix__grouped_kv_mqa__geglu_ffn__prompt_kernel
  .amdhsa_next_free_vgpr 256
  .amdhsa_next_free_sgpr 102
  .amdhsa_accum_offset 256
  .amdhsa_group_segment_fixed_size 0
  .amdhsa_kernarg_size 104
  .amdhsa_user_sgpr_count 2
  .amdhsa_user_sgpr_kernarg_segment_ptr 1
  .amdhsa_system_sgpr_workgroup_id_x 1
.end_amdhsa_kernel
```
